```python
import torch

def _softmax(x, axis=-1):
    return torch.softmax(x, dim=axis)
def _gelu(x):
    return torch.nn.functional.gelu(x, approximate="tanh")
def _silu(x):
    return torch.nn.functional.silu(x)
def _sigmoid(x):
    return torch.sigmoid(x)
def _layernorm(x, axis=-1, eps=1e-5):
    m = x.mean(dim=axis, keepdim=True)
    v = x.var(dim=axis, keepdim=True, unbiased=False)
    return (x - m) / torch.sqrt(v + eps)
def _scatter_add(tgt, idx, src, axis=0):
    return tgt.clone().index_add_(axis, idx, src)
def _segment_sum(src, seg, n):
    out = torch.zeros((n,) + src.shape[1:], dtype=src.dtype)
    return out.index_add_(0, seg, src)
def _pad(x, pw):
    flat = tuple(v for pair in reversed(pw) for v in pair)
    return torch.nn.functional.pad(x, flat)

kernel_name = 'standalone__gqa_softmax__near_ridge'

def setup_inputs():

    _w = (lambda a: (lambda t: t.to(torch.bfloat16) if t.is_floating_point() else t)(torch.as_tensor(a)))
    B, Hq, Hkv, Sq, Sk, D = 16, 32, 32, 624, 624, 128
    return {
        "q": _w((lambda *s: torch.randn(*s, dtype=torch.bfloat16) * 0.8)(B, Hq, Sq, D)),
        "k": _w((lambda *s: torch.randn(*s, dtype=torch.bfloat16) * 0.8)(B, Hkv, Sk, D)),
        "v": _w((lambda *s: torch.randn(*s, dtype=torch.bfloat16) * 0.05)(B, Hkv, Sk, D)),
    }

def reference(q, k, v):
    B, Hq, Sq, D = q.shape
    Hkv = k.shape[1]
    rep = Hq // Hkv
    k = (lambda x, n, axis: torch.repeat_interleave(x, n, dim=axis))(k, rep, axis=1)
    v = (lambda x, n, axis: torch.repeat_interleave(x, n, dim=axis))(v, rep, axis=1)
    scale = D ** -0.5
    scores = torch.einsum("bhqd,bhkd->bhqk", q, k) * scale
    p = _softmax(scores, axis=-1)
    return torch.einsum("bhqk,bhkd->bhqd", p, v)
```

```asm
; @launch grid=(256,1,1) block=(256,1,1) lds=163840
.amdgcn_target "amdgcn-amd-amdhsa--gfx950"
.text
.globl standalone__gqa_softmax__near_ridge_kernel
.p2align 8
.type standalone__gqa_softmax__near_ridge_kernel,@function
standalone__gqa_softmax__near_ridge_kernel:
    s_cmp_ge_u32 s2, 256
    s_cbranch_scc1 L_end
    s_load_dwordx4 s[20:23], s[0:1], 0
    s_load_dwordx4 s[44:47], s[0:1], 16
    v_lshrrev_b32 v1, 6, v0
    v_and_b32 v2, 63, v0
    v_readfirstlane_b32 s48, v1
    v_lshrrev_b32 v3, 4, v2
    v_and_b32 v4, 15, v2
    s_and_b32 s49, s2, 7
    s_lshr_b32 s50, s2, 4
    s_lshl_b32 s50, s50, 3
    s_add_u32 s49, s49, s50
    s_mul_i32 s51, s49, 159744
    s_lshr_b32 s50, s2, 3
    s_and_b32 s50, s50, 1
    s_mul_i32 s50, s50, 320
    s_mul_i32 s52, s48, 80
    s_add_u32 s50, s50, s52
    s_lshl_b32 s32, s48, 11
    s_lshl_b32 s53, s48, 3
    v_add_u32 v5, s53, v3
    v_add_u32 v6, 4, v5
    v_xor_b32 v7, v5, v4
    v_and_b32 v7, 15, v7
    v_lshlrev_b32 v7, 4, v7
    v_lshl_add_u32 v224, v5, 8, v7
    v_xor_b32 v7, v6, v4
    v_and_b32 v7, 15, v7
    v_lshlrev_b32 v7, 4, v7
    v_lshl_add_u32 v225, v5, 8, v7
    v_lshlrev_b32 v7, 1, v3
    v_xor_b32 v7, v7, v4
    v_lshlrev_b32 v7, 4, v7
    v_lshl_add_u32 v226, v5, 8, v7
    v_xor_b32 v7, 0x80, v7
    v_lshl_add_u32 v227, v5, 8, v7
    v_add_u32 v5, s50, v3
    v_lshlrev_b32 v5, 8, v5
    v_lshl_add_u32 v228, v4, 4, v5
    s_mov_b32 s26, 0x1000
    s_mov_b32 s27, 0x2000
    s_mov_b32 s28, 0x3000
    s_mov_b32 s29, 0x4000
    s_mov_b32 s7, 0x00020000
    s_mov_b32 s11, 0x00020000
    s_mov_b32 s15, 0x00020000
    s_mov_b32 s19, 0x00020000
    s_mov_b32 s34, s51
    s_mov_b32 s33, 4
    s_mov_b32 s43, 0
    s_mov_b32 s36, 0
    s_mov_b32 s42, 1
    s_waitcnt lgkmcnt(0)
    s_mov_b32 s4, s22
    s_mov_b32 s5, s23
    s_mov_b32 s8, s44
    s_mov_b32 s9, s45
    s_mov_b32 s22, s46
    s_mov_b32 s23, s47
    s_mov_b32 s16, s46
    s_mov_b32 s17, s47
L_start:
    s_add_u32 s12, s20, s34
    s_addc_u32 s13, s21, 0
    s_mov_b32 s14, 159744
    s_mov_b32 s6, 81788928
    s_mov_b32 s10, 81788928
    s_mov_b32 s24, s34
    s_mov_b64 s[40:41], 0
    s_mov_b32 s18, 0
    buffer_load_dwordx4 v[80:83], v228, s[12:15], 0 offen offset:0 nt
    buffer_load_dwordx4 v[84:87], v228, s[12:15], 0 offen offset:1024 nt
    buffer_load_dwordx4 v[88:91], v228, s[12:15], 0 offen offset:2048 nt
    buffer_load_dwordx4 v[92:95], v228, s[12:15], 0 offen offset:3072 nt
    s_add_u32 m0, s32, 0
    s_nop 0
    buffer_load_dwordx4 v224, s[4:7], s24 offen offset:0 lds
    buffer_load_dwordx4 v225, s[4:7], s24 offen offset:1024 lds
    s_add_u32 m0, s32, 40960
    s_nop 0
    buffer_load_dwordx4 v226, s[8:11], s24 offen offset:0 lds
    buffer_load_dwordx4 v227, s[8:11], s24 offen offset:1024 lds
    s_add_u32 s24, s24, 4096
    s_add_u32 m0, s32, 8192
    s_nop 0
    buffer_load_dwordx4 v224, s[4:7], s24 offen offset:0 lds
    buffer_load_dwordx4 v225, s[4:7], s24 offen offset:1024 lds
    s_add_u32 m0, s32, 49152
    s_nop 0
    buffer_load_dwordx4 v226, s[8:11], s24 offen offset:0 lds
    buffer_load_dwordx4 v227, s[8:11], s24 offen offset:1024 lds
    buffer_load_dwordx4 v[96:99], v228, s[12:15], s26 offen offset:0 nt
    buffer_load_dwordx4 v[100:103], v228, s[12:15], s26 offen offset:1024 nt
    buffer_load_dwordx4 v[104:107], v228, s[12:15], s26 offen offset:2048 nt
    buffer_load_dwordx4 v[108:111], v228, s[12:15], s26 offen offset:3072 nt
    v_mov_b32 v241, 0xff800000
    v_mov_b32 v242, 0xff800000
    v_mov_b32 v243, 0xff800000
    v_mov_b32 v244, 0xff800000
    v_mov_b32 v245, 0xff800000
    s_cmp_lg_u32 s43, 0
    s_cbranch_scc1 L_maxpass
    s_mul_i32 s52, s48, 20480
    s_mov_b32 s57, 0xff800000
    s_cmp_eq_u32 s50, 560
    s_cselect_b32 s57, 0x7f000000, s57
    s_mov_b32 s58, 0
    s_mov_b32 s59, -1
    s_add_u32 s52, s52, 81920
    s_mov_b32 s30, 1040356334
    s_mov_b32 s31, 0xffff0000
    s_mov_b32 s84, s30
    s_mov_b32 s86, 0x07060302
    s_mov_b32 s85, s30
    s_mov_b32 s37, 1333788672
    v_xor_b32 v5, v3, v4
    v_lshlrev_b32 v5, 4, v5
    v_lshl_add_u32 v212, v4, 8, v5
    v_lshl_add_u32 v5, v3, 8, v5
    v_add_u32 v230, s52, v5
    v_xor_b32 v213, 64, v212
    v_xor_b32 v214, 0x80, v212
    v_xor_b32 v215, 0xc0, v212
    v_lshrrev_b32 v5, 2, v2
    v_and_b32 v6, 7, v5
    v_lshlrev_b32 v6, 5, v6
    v_lshl_add_u32 v6, v5, 8, v6
    v_and_b32 v7, 1, v2
    v_lshl_add_u32 v6, v7, 4, v6
    v_and_b32 v7, 2, v2
    v_lshl_add_u32 v6, v7, 2, v6
    v_and_b32 v7, 3, v2
    v_add_u32 v216, 40960, v6
    v_cmp_eq_u32 vcc, 0, v7
    v_mov_b32 v5, 0x3f803f80
    v_mov_b32 v231, 0xeeeeeeee
    v_mov_b32 v8, 0x44444444
    v_cndmask_b32 v6, 0, v5, vcc
    v_cndmask_b32 v231, v231, v8, vcc
    v_cmp_gt_u32 vcc, 2, v7
    s_nop 1
    v_cndmask_b32 v5, 0, v5, vcc
    v_xor_b32 v217, 32, v216
    v_xor_b32 v218, 64, v216
    v_xor_b32 v219, 96, v216
    v_xor_b32 v220, 128, v216
    v_xor_b32 v221, 160, v216
    v_xor_b32 v222, 192, v216
    v_xor_b32 v223, 224, v216
    v_accvgpr_write_b32 a228, v6
    v_accvgpr_write_b32 a229, v6
    v_accvgpr_write_b32 a230, v6
    v_accvgpr_write_b32 a231, v6
    v_accvgpr_write_b32 a248, v5
    v_accvgpr_write_b32 a249, v5
    v_accvgpr_write_b32 a250, v5
    v_accvgpr_write_b32 a251, v5
L_go:
    v_add_u32 v232, s52, v212
    v_add_u32 v233, s52, v213
    v_add_u32 v234, s52, v214
    v_add_u32 v235, s52, v215
    s_waitcnt vmcnt(12)
    buffer_load_dwordx4 v[112:115], v228, s[12:15], s27 offen offset:0 nt
    buffer_load_dwordx4 v[116:119], v228, s[12:15], s27 offen offset:1024 nt
    buffer_load_dwordx4 v[120:123], v228, s[12:15], s27 offen offset:2048 nt
    buffer_load_dwordx4 v[124:127], v228, s[12:15], s27 offen offset:3072 nt
    v_lshlrev_b32 v248, 16, v80
    v_and_b32 v249, s31, v80
    v_lshlrev_b32 v250, 16, v81
    v_and_b32 v251, s31, v81
    v_lshlrev_b32 v252, 16, v82
    v_and_b32 v253, s31, v82
    v_lshlrev_b32 v254, 16, v83
    v_and_b32 v255, s31, v83
    v_pk_mul_f32 v[248:249], v[248:249], s[84:85]
    v_pk_mul_f32 v[250:251], v[250:251], s[84:85]
    v_pk_mul_f32 v[252:253], v[252:253], s[84:85]
    v_pk_mul_f32 v[254:255], v[254:255], s[84:85]
    v_cvt_pk_bf16_f32 v248, v248, v249
    v_cvt_pk_bf16_f32 v249, v250, v251
    v_cvt_pk_bf16_f32 v250, v252, v253
    v_cvt_pk_bf16_f32 v251, v254, v255
    ds_write_b128 v230, v[248:251] offset:0
    v_xor_b32 v229, 64, v230
    v_lshlrev_b32 v248, 16, v84
    v_and_b32 v249, s31, v84
    v_lshlrev_b32 v250, 16, v85
    v_and_b32 v251, s31, v85
    v_lshlrev_b32 v252, 16, v86
    v_and_b32 v253, s31, v86
    v_lshlrev_b32 v254, 16, v87
    v_and_b32 v255, s31, v87
    v_pk_mul_f32 v[248:249], v[248:249], s[84:85]
    v_pk_mul_f32 v[250:251], v[250:251], s[84:85]
    v_pk_mul_f32 v[252:253], v[252:253], s[84:85]
    v_pk_mul_f32 v[254:255], v[254:255], s[84:85]
    v_cvt_pk_bf16_f32 v248, v248, v249
    v_cvt_pk_bf16_f32 v249, v250, v251
    v_cvt_pk_bf16_f32 v250, v252, v253
    v_cvt_pk_bf16_f32 v251, v254, v255
    ds_write_b128 v229, v[248:251] offset:1024
    v_xor_b32 v229, 128, v230
    v_lshlrev_b32 v248, 16, v88
    v_and_b32 v249, s31, v88
    v_lshlrev_b32 v250, 16, v89
    v_and_b32 v251, s31, v89
    v_lshlrev_b32 v252, 16, v90
    v_and_b32 v253, s31, v90
    v_lshlrev_b32 v254, 16, v91
    v_and_b32 v255, s31, v91
    v_pk_mul_f32 v[248:249], v[248:249], s[84:85]
    v_pk_mul_f32 v[250:251], v[250:251], s[84:85]
    v_pk_mul_f32 v[252:253], v[252:253], s[84:85]
    v_pk_mul_f32 v[254:255], v[254:255], s[84:85]
    v_cvt_pk_bf16_f32 v248, v248, v249
    v_cvt_pk_bf16_f32 v249, v250, v251
    v_cvt_pk_bf16_f32 v250, v252, v253
    v_cvt_pk_bf16_f32 v251, v254, v255
    ds_write_b128 v229, v[248:251] offset:2048
    v_xor_b32 v229, 192, v230
    v_lshlrev_b32 v248, 16, v92
    v_and_b32 v249, s31, v92
    v_lshlrev_b32 v250, 16, v93
    v_and_b32 v251, s31, v93
    v_lshlrev_b32 v252, 16, v94
    v_and_b32 v253, s31, v94
    v_lshlrev_b32 v254, 16, v95
    v_and_b32 v255, s31, v95
    v_pk_mul_f32 v[248:249], v[248:249], s[84:85]
    v_pk_mul_f32 v[250:251], v[250:251], s[84:85]
    v_pk_mul_f32 v[252:253], v[252:253], s[84:85]
    v_pk_mul_f32 v[254:255], v[254:255], s[84:85]
    v_cvt_pk_bf16_f32 v248, v248, v249
    v_cvt_pk_bf16_f32 v249, v250, v251
    v_cvt_pk_bf16_f32 v250, v252, v253
    v_cvt_pk_bf16_f32 v251, v254, v255
    ds_write_b128 v229, v[248:251] offset:3072
    ds_read_b128 a[0:3], v232 offset:0
    ds_read_b128 a[4:7], v233 offset:0
    ds_read_b128 a[8:11], v234 offset:0
    ds_read_b128 a[12:15], v235 offset:0
    s_waitcnt lgkmcnt(0)
    s_waitcnt vmcnt(8)
    s_barrier
    buffer_load_dwordx4 v[128:131], v228, s[12:15], s28 offen offset:0 nt
    buffer_load_dwordx4 v[132:135], v228, s[12:15], s28 offen offset:1024 nt
    buffer_load_dwordx4 v[136:139], v228, s[12:15], s28 offen offset:2048 nt
    buffer_load_dwordx4 v[140:143], v228, s[12:15], s28 offen offset:3072 nt
    buffer_load_dwordx4 v[144:147], v228, s[12:15], s29 offen offset:0 nt
    buffer_load_dwordx4 v[148:151], v228, s[12:15], s29 offen offset:1024 nt
    buffer_load_dwordx4 v[152:155], v228, s[12:15], s29 offen offset:2048 nt
    buffer_load_dwordx4 v[156:159], v228, s[12:15], s29 offen offset:3072 nt
    ds_read_b128 a[80:83], v212 offset:0
    ds_read_b128 a[84:87], v213 offset:0
    ds_read_b128 a[88:91], v214 offset:0
    ds_read_b128 a[92:95], v215 offset:0
    ds_read_b128 a[112:115], v212 offset:8192
    ds_read_b128 a[116:119], v213 offset:8192
    ds_read_b128 a[120:123], v214 offset:8192
    ds_read_b128 a[124:127], v215 offset:8192
    s_waitcnt lgkmcnt(4)
    v_mfma_f32_16x16x32_bf16 v[160:163], a[80:83], a[0:3], 0
    v_mfma_f32_16x16x32_bf16 v[160:163], a[84:87], a[4:7], v[160:163]
    v_mfma_f32_16x16x32_bf16 v[160:163], a[88:91], a[8:11], v[160:163]
    ds_read_b128 a[128:131], v212 offset:12288
    ds_read_b128 a[132:135], v213 offset:12288
    v_mfma_f32_16x16x32_bf16 v[160:163], a[92:95], a[12:15], v[160:163]
    ds_read_b128 a[136:139], v214 offset:12288
    ds_read_b128 a[140:143], v215 offset:12288
    s_nop 5
    v_max3_f32 v236, v160, v161, v162
    v_max_f32 v236, v236, v163
    v_max_f32 v236, v236, v241
    v_mov_b32 v237, v236
    s_nop 1
    v_permlane32_swap_b32 v236, v237
    v_max_f32 v236, v236, v237
    v_mov_b32 v237, v236
    s_nop 1
    v_permlane16_swap_b32 v236, v237
    v_max_f32 v236, v236, v237
    v_sub_f32 v192, 0, v236
    v_sub_f32 v193, 0, v236
    v_sub_f32 v194, 0, v236
    v_sub_f32 v195, 0, v236
    s_waitcnt lgkmcnt(0)
    s_nop 0
    v_mfma_f32_16x16x32_bf16 v[168:171], a[112:115], a[0:3], v[192:195]
    v_add_f32 v160, v160, v192
    v_mfma_f32_16x16x32_bf16 v[168:171], a[116:119], a[4:7], v[168:171]
    v_add_f32 v161, v161, v192
    v_mfma_f32_16x16x32_bf16 v[168:171], a[120:123], a[8:11], v[168:171]
    v_mfma_f32_16x16x32_bf16 v[168:171], a[124:127], a[12:15], v[168:171]
    v_add_f32 v162, v162, v192
    v_mfma_f32_16x16x32_bf16 v[172:175], a[140:143], a[12:15], v[192:195]
    v_add_f32 v163, v163, v192
    v_mfma_f32_16x16x32_bf16 v[172:175], a[136:139], a[8:11], v[172:175]
    v_mfma_f32_16x16x32_bf16 v[172:175], a[132:135], a[4:7], v[172:175]
    v_exp_f32 v160, v160
    v_mfma_f32_16x16x32_bf16 v[172:175], a[128:131], a[0:3], v[172:175]
    v_exp_f32 v161, v161
    ds_read_b64_tr_b16 a[144:145], v216 offset:0
    v_exp_f32 v162, v162
    v_exp_f32 v163, v163
    ds_read_b64_tr_b16 a[148:149], v217 offset:0
    v_cvt_pk_bf16_f32 v176, v160, v161
    ds_read_b64_tr_b16 a[152:153], v218 offset:0
    v_cvt_pk_bf16_f32 v177, v162, v163
    s_waitcnt vmcnt(12)
    s_add_u32 s24, s24, 8192
    s_add_u32 m0, s32, 16384
    s_nop 0
    buffer_load_dwordx4 v224, s[4:7], s24 offen offset:0 lds
    buffer_load_dwordx4 v225, s[4:7], s24 offen offset:1024 lds
    s_add_u32 m0, s32, 57344
    s_nop 0
    buffer_load_dwordx4 v226, s[8:11], s24 offen offset:0 lds
    buffer_load_dwordx4 v227, s[8:11], s24 offen offset:1024 lds
    v_lshlrev_b32 v248, 16, v96
    v_and_b32 v249, s31, v96
    v_lshlrev_b32 v250, 16, v97
    v_and_b32 v251, s31, v97
    v_lshlrev_b32 v252, 16, v98
    v_and_b32 v253, s31, v98
    v_lshlrev_b32 v254, 16, v99
    v_and_b32 v255, s31, v99
    v_pk_mul_f32 v[248:249], v[248:249], s[84:85]
    v_pk_mul_f32 v[250:251], v[250:251], s[84:85]
    v_pk_mul_f32 v[252:253], v[252:253], s[84:85]
    v_pk_mul_f32 v[254:255], v[254:255], s[84:85]
    v_cvt_pk_bf16_f32 v248, v248, v249
    v_cvt_pk_bf16_f32 v249, v250, v251
    v_cvt_pk_bf16_f32 v250, v252, v253
    v_cvt_pk_bf16_f32 v251, v254, v255
    ds_write_b128 v230, v[248:251] offset:4096
    v_xor_b32 v229, 64, v230
    v_lshlrev_b32 v248, 16, v100
    v_and_b32 v249, s31, v100
    v_lshlrev_b32 v250, 16, v101
    v_and_b32 v251, s31, v101
    v_lshlrev_b32 v252, 16, v102
    v_and_b32 v253, s31, v102
    v_lshlrev_b32 v254, 16, v103
    v_and_b32 v255, s31, v103
    v_pk_mul_f32 v[248:249], v[248:249], s[84:85]
    v_pk_mul_f32 v[250:251], v[250:251], s[84:85]
    v_pk_mul_f32 v[252:253], v[252:253], s[84:85]
    v_pk_mul_f32 v[254:255], v[254:255], s[84:85]
    v_cvt_pk_bf16_f32 v248, v248, v249
    v_cvt_pk_bf16_f32 v249, v250, v251
    v_cvt_pk_bf16_f32 v250, v252, v253
    v_cvt_pk_bf16_f32 v251, v254, v255
    ds_write_b128 v229, v[248:251] offset:5120
    v_xor_b32 v229, 128, v230
    v_lshlrev_b32 v248, 16, v104
    v_and_b32 v249, s31, v104
    v_lshlrev_b32 v250, 16, v105
    v_and_b32 v251, s31, v105
    v_lshlrev_b32 v252, 16, v106
    v_and_b32 v253, s31, v106
    v_lshlrev_b32 v254, 16, v107
    v_and_b32 v255, s31, v107
    v_pk_mul_f32 v[248:249], v[248:249], s[84:85]
    v_pk_mul_f32 v[250:251], v[250:251], s[84:85]
    v_pk_mul_f32 v[252:253], v[252:253], s[84:85]
    v_pk_mul_f32 v[254:255], v[254:255], s[84:85]
    v_cvt_pk_bf16_f32 v248, v248, v249
    v_cvt_pk_bf16_f32 v249, v250, v251
    v_cvt_pk_bf16_f32 v250, v252, v253
    v_cvt_pk_bf16_f32 v251, v254, v255
    ds_write_b128 v229, v[248:251] offset:6144
    v_xor_b32 v229, 192, v230
    v_lshlrev_b32 v248, 16, v108
    v_and_b32 v249, s31, v108
    v_lshlrev_b32 v250, 16, v109
    v_and_b32 v251, s31, v109
    v_lshlrev_b32 v252, 16, v110
    v_and_b32 v253, s31, v110
    v_lshlrev_b32 v254, 16, v111
    v_and_b32 v255, s31, v111
    v_pk_mul_f32 v[248:249], v[248:249], s[84:85]
    v_pk_mul_f32 v[250:251], v[250:251], s[84:85]
    v_pk_mul_f32 v[252:253], v[252:253], s[84:85]
    v_pk_mul_f32 v[254:255], v[254:255], s[84:85]
    v_cvt_pk_bf16_f32 v248, v248, v249
    v_cvt_pk_bf16_f32 v249, v250, v251
    v_cvt_pk_bf16_f32 v250, v252, v253
    v_cvt_pk_bf16_f32 v251, v254, v255
    ds_write_b128 v229, v[248:251] offset:7168
    ds_read_b128 a[16:19], v232 offset:4096
    ds_read_b128 a[20:23], v233 offset:4096
    ds_read_b128 a[24:27], v234 offset:4096
    ds_read_b128 a[28:31], v235 offset:4096
    s_waitcnt lgkmcnt(0)
    v_mfma_f32_16x16x32_bf16 v[160:163], a[80:83], a[16:19], 0
    v_exp_f32 v168, v168
    v_mfma_f32_16x16x32_bf16 v[160:163], a[84:87], a[20:23], v[160:163]
    v_exp_f32 v169, v169
    v_mfma_f32_16x16x32_bf16 v[160:163], a[88:91], a[24:27], v[160:163]
    ds_read_b64_tr_b16 a[156:157], v219 offset:0
    ds_read_b64_tr_b16 a[176:177], v216 offset:8192
    v_mfma_f32_16x16x32_bf16 v[160:163], a[92:95], a[28:31], v[160:163]
    v_exp_f32 v170, v170
    v_exp_f32 v171, v171
    v_cvt_pk_bf16_f32 v180, v168, v169
    v_cvt_pk_bf16_f32 v181, v170, v171
    v_exp_f32 v172, v172
    s_nop 2
    v_max3_f32 v236, v160, v161, v162
    v_max_f32 v236, v236, v163
    v_max_f32 v236, v236, v242
    v_exp_f32 v173, v173
    v_mov_b32 v237, v236
    s_nop 1
    v_permlane32_swap_b32 v236, v237
    ds_read_b64_tr_b16 a[178:179], v216 offset:12288
    ds_read_b64_tr_b16 a[180:181], v217 offset:8192
    v_max_f32 v236, v236, v237
    v_mov_b32 v237, v236
    v_exp_f32 v174, v174
    s_nop 0
    v_permlane16_swap_b32 v236, v237
    v_max_f32 v236, v236, v237
    v_exp_f32 v175, v175
    v_sub_f32 v196, 0, v236
    v_sub_f32 v197, 0, v236
    v_cvt_pk_bf16_f32 v182, v172, v173
    v_cvt_pk_bf16_f32 v183, v174, v175
    v_sub_f32 v198, 0, v236
    v_sub_f32 v199, 0, v236
    ds_read_b64_tr_b16 a[182:183], v217 offset:12288
    s_nop 0
    v_mfma_f32_16x16x32_bf16 v[168:171], a[112:115], a[16:19], v[196:199]
    ds_read_b64_tr_b16 a[184:185], v218 offset:8192
    ds_read_b64_tr_b16 a[186:187], v218 offset:12288
    v_add_f32 v160, v160, v196
    v_mfma_f32_16x16x32_bf16 v[168:171], a[116:119], a[20:23], v[168:171]
    ds_read_b64_tr_b16 a[188:189], v219 offset:8192
    ds_read_b64_tr_b16 a[190:191], v219 offset:12288
    v_add_f32 v161, v161, v196
    v_mfma_f32_16x16x32_bf16 v[168:171], a[120:123], a[24:27], v[168:171]
    ds_read_b64_tr_b16 a[160:161], v220 offset:0
    ds_read_b64_tr_b16 a[164:165], v221 offset:0
    v_mfma_f32_16x16x32_bf16 v[168:171], a[124:127], a[28:31], v[168:171]
    ds_read_b64_tr_b16 a[168:169], v222 offset:0
    ds_read_b64_tr_b16 a[172:173], v223 offset:0
    v_add_f32 v162, v162, v196
    v_mfma_f32_16x16x32_bf16 v[172:175], a[140:143], a[28:31], v[196:199]
    ds_read_b64_tr_b16 a[192:193], v220 offset:8192
    ds_read_b64_tr_b16 a[194:195], v220 offset:12288
    v_mfma_f32_16x16x32_bf16 v[172:175], a[136:139], a[24:27], v[172:175]
    ds_read_b64_tr_b16 a[196:197], v221 offset:8192
    ds_read_b64_tr_b16 a[198:199], v221 offset:12288
    v_mfma_f32_16x16x32_bf16 v[172:175], a[132:135], a[20:23], v[172:175]
    ds_read_b64_tr_b16 a[200:201], v222 offset:8192
    ds_read_b64_tr_b16 a[202:203], v222 offset:12288
    v_mfma_f32_16x16x32_bf16 v[172:175], a[128:131], a[16:19], v[172:175]
    s_waitcnt lgkmcnt(14)
    ds_read_b64_tr_b16 a[204:205], v223 offset:8192
    ds_read_b64_tr_b16 a[206:207], v223 offset:12288
    v_mfma_f32_16x16x16_bf16 v[0:3], a[144:145], v[176:177], 0
    s_waitcnt lgkmcnt(14)
    v_add_f32 v163, v163, v196
    v_mfma_f32_16x16x16_bf16 v[4:7], a[148:149], v[176:177], 0
    v_exp_f32 v160, v160
    v_mfma_f32_16x16x16_bf16 v[8:11], a[152:153], v[176:177], 0
    v_exp_f32 v161, v161
    v_mfma_f32_16x16x16_bf16 v[12:15], a[156:157], v[176:177], 0
    v_exp_f32 v162, v162
    v_mfma_f32_16x16x16_bf16 a[208:211], a[228:229], v[176:177], 0
    v_exp_f32 v163, v163
    v_mfma_f32_16x16x32_bf16 v[0:3], a[176:179], v[180:183], v[0:3]
    v_cvt_pk_bf16_f32 v184, v160, v161
    v_mfma_f32_16x16x32_bf16 v[4:7], a[180:183], v[180:183], v[4:7]
    v_mfma_f32_16x16x32_bf16 v[8:11], a[184:187], v[180:183], v[8:11]
    s_waitcnt lgkmcnt(12)
    v_cvt_pk_bf16_f32 v185, v162, v163
    v_mfma_f32_16x16x32_bf16 v[12:15], a[188:191], v[180:183], v[12:15]
    s_waitcnt vmcnt(12)
    s_add_u32 s24, s24, 8192
    s_add_u32 m0, s32, 24576
    s_nop 0
    buffer_load_dwordx4 v224, s[4:7], s24 offen offset:0 lds
    buffer_load_dwordx4 v225, s[4:7], s24 offen offset:1024 lds
    s_add_u32 m0, s32, 65536
    s_nop 0
    buffer_load_dwordx4 v226, s[8:11], s24 offen offset:0 lds
    buffer_load_dwordx4 v227, s[8:11], s24 offen offset:1024 lds
    v_lshlrev_b32 v248, 16, v112
    v_and_b32 v249, s31, v112
    v_lshlrev_b32 v250, 16, v113
    v_and_b32 v251, s31, v113
    v_lshlrev_b32 v252, 16, v114
    v_and_b32 v253, s31, v114
    v_lshlrev_b32 v254, 16, v115
    v_and_b32 v255, s31, v115
    v_pk_mul_f32 v[248:249], v[248:249], s[84:85]
    v_pk_mul_f32 v[250:251], v[250:251], s[84:85]
    v_pk_mul_f32 v[252:253], v[252:253], s[84:85]
    v_pk_mul_f32 v[254:255], v[254:255], s[84:85]
    v_cvt_pk_bf16_f32 v248, v248, v249
    v_cvt_pk_bf16_f32 v249, v250, v251
    v_cvt_pk_bf16_f32 v250, v252, v253
    v_cvt_pk_bf16_f32 v251, v254, v255
    ds_write_b128 v230, v[248:251] offset:8192
    v_xor_b32 v229, 64, v230
    v_lshlrev_b32 v248, 16, v116
    v_and_b32 v249, s31, v116
    v_lshlrev_b32 v250, 16, v117
    v_and_b32 v251, s31, v117
    v_lshlrev_b32 v252, 16, v118
    v_and_b32 v253, s31, v118
    v_lshlrev_b32 v254, 16, v119
    v_and_b32 v255, s31, v119
    v_pk_mul_f32 v[248:249], v[248:249], s[84:85]
    v_pk_mul_f32 v[250:251], v[250:251], s[84:85]
    v_pk_mul_f32 v[252:253], v[252:253], s[84:85]
    v_pk_mul_f32 v[254:255], v[254:255], s[84:85]
    v_cvt_pk_bf16_f32 v248, v248, v249
    v_cvt_pk_bf16_f32 v249, v250, v251
    v_cvt_pk_bf16_f32 v250, v252, v253
    v_cvt_pk_bf16_f32 v251, v254, v255
    ds_write_b128 v229, v[248:251] offset:9216
    v_xor_b32 v229, 128, v230
    v_lshlrev_b32 v248, 16, v120
    v_and_b32 v249, s31, v120
    v_lshlrev_b32 v250, 16, v121
    v_and_b32 v251, s31, v121
    v_lshlrev_b32 v252, 16, v122
    v_and_b32 v253, s31, v122
    v_lshlrev_b32 v254, 16, v123
    v_and_b32 v255, s31, v123
    v_pk_mul_f32 v[248:249], v[248:249], s[84:85]
    v_pk_mul_f32 v[250:251], v[250:251], s[84:85]
    v_pk_mul_f32 v[252:253], v[252:253], s[84:85]
    v_pk_mul_f32 v[254:255], v[254:255], s[84:85]
    v_cvt_pk_bf16_f32 v248, v248, v249
    v_cvt_pk_bf16_f32 v249, v250, v251
    v_cvt_pk_bf16_f32 v250, v252, v253
    v_cvt_pk_bf16_f32 v251, v254, v255
    ds_write_b128 v229, v[248:251] offset:10240
    v_xor_b32 v229, 192, v230
    v_lshlrev_b32 v248, 16, v124
    v_and_b32 v249, s31, v124
    v_lshlrev_b32 v250, 16, v125
    v_and_b32 v251, s31, v125
    v_lshlrev_b32 v252, 16, v126
    v_and_b32 v253, s31, v126
    v_lshlrev_b32 v254, 16, v127
    v_and_b32 v255, s31, v127
    v_pk_mul_f32 v[248:249], v[248:249], s[84:85]
    v_pk_mul_f32 v[250:251], v[250:251], s[84:85]
    v_pk_mul_f32 v[252:253], v[252:253], s[84:85]
    v_pk_mul_f32 v[254:255], v[254:255], s[84:85]
    v_cvt_pk_bf16_f32 v248, v248, v249
    v_cvt_pk_bf16_f32 v249, v250, v251
    v_cvt_pk_bf16_f32 v250, v252, v253
    v_cvt_pk_bf16_f32 v251, v254, v255
    ds_write_b128 v229, v[248:251] offset:11264
    ds_read_b128 a[32:35], v232 offset:8192
    ds_read_b128 a[36:39], v233 offset:8192
    ds_read_b128 a[40:43], v234 offset:8192
    ds_read_b128 a[44:47], v235 offset:8192
    s_waitcnt lgkmcnt(0)
    v_mfma_f32_16x16x32_bf16 v[160:163], a[80:83], a[32:35], 0
    v_exp_f32 v168, v168
    v_mfma_f32_16x16x32_bf16 v[160:163], a[84:87], a[36:39], v[160:163]
    v_exp_f32 v169, v169
    v_mfma_f32_16x16x32_bf16 v[160:163], a[88:91], a[40:43], v[160:163]
    v_mfma_f32_16x16x32_bf16 v[160:163], a[92:95], a[44:47], v[160:163]
    v_exp_f32 v170, v170
    v_mfma_f32_16x16x16_bf16 v[16:19], a[160:161], v[176:177], 0
    v_exp_f32 v171, v171
    v_mfma_f32_16x16x16_bf16 v[20:23], a[164:165], v[176:177], 0
    v_cvt_pk_bf16_f32 v188, v168, v169
    v_cvt_pk_bf16_f32 v189, v170, v171
    v_mfma_f32_16x16x16_bf16 v[24:27], a[168:169], v[176:177], 0
    v_exp_f32 v172, v172
    v_max3_f32 v236, v160, v161, v162
    v_max_f32 v236, v236, v163
    v_max_f32 v236, v236, v243
    v_mfma_f32_16x16x16_bf16 v[28:31], a[172:173], v[176:177], 0
    v_exp_f32 v173, v173
    v_mov_b32 v237, v236
    s_nop 1
    v_permlane32_swap_b32 v236, v237
    v_mfma_f32_16x16x32_bf16 a[208:211], a[228:231], v[180:183], a[208:211]
    v_max_f32 v236, v236, v237
    v_mov_b32 v237, v236
    v_mfma_f32_16x16x32_bf16 v[16:19], a[192:195], v[180:183], v[16:19]
    v_exp_f32 v174, v174
    v_permlane16_swap_b32 v236, v237
    v_max_f32 v236, v236, v237
    v_mfma_f32_16x16x32_bf16 v[20:23], a[196:199], v[180:183], v[20:23]
    v_exp_f32 v175, v175
    v_sub_f32 v200, 0, v236
    v_sub_f32 v201, 0, v236
    v_mfma_f32_16x16x32_bf16 v[24:27], a[200:203], v[180:183], v[24:27]
    v_cvt_pk_bf16_f32 v190, v172, v173
    v_cvt_pk_bf16_f32 v191, v174, v175
    v_sub_f32 v202, 0, v236
    v_sub_f32 v203, 0, v236
    v_mfma_f32_16x16x32_bf16 v[28:31], a[204:207], v[180:183], v[28:31]
    s_nop 0
    v_mfma_f32_16x16x32_bf16 v[168:171], a[112:115], a[32:35], v[200:203]
    v_add_f32 v160, v160, v200
    v_mfma_f32_16x16x32_bf16 v[168:171], a[116:119], a[36:39], v[168:171]
    v_add_f32 v161, v161, v200
    v_mfma_f32_16x16x32_bf16 v[168:171], a[120:123], a[40:43], v[168:171]
    v_mfma_f32_16x16x32_bf16 v[168:171], a[124:127], a[44:47], v[168:171]
    v_add_f32 v162, v162, v200
    v_mfma_f32_16x16x32_bf16 v[172:175], a[140:143], a[44:47], v[200:203]
    v_mfma_f32_16x16x32_bf16 v[172:175], a[136:139], a[40:43], v[172:175]
    v_add_f32 v163, v163, v200
    v_mfma_f32_16x16x32_bf16 v[172:175], a[132:135], a[36:39], v[172:175]
    v_mfma_f32_16x16x32_bf16 v[172:175], a[128:131], a[32:35], v[172:175]
    v_exp_f32 v160, v160
    v_mfma_f32_16x16x16_bf16 v[32:35], a[144:145], v[184:185], 0
    v_exp_f32 v161, v161
    v_mfma_f32_16x16x16_bf16 v[36:39], a[148:149], v[184:185], 0
    v_mfma_f32_16x16x16_bf16 v[40:43], a[152:153], v[184:185], 0
    v_exp_f32 v162, v162
    v_mfma_f32_16x16x16_bf16 v[44:47], a[156:157], v[184:185], 0
    v_exp_f32 v163, v163
    v_mfma_f32_16x16x16_bf16 a[212:215], a[228:229], v[184:185], 0
    s_nop 0
    v_mfma_f32_16x16x32_bf16 v[32:35], a[176:179], v[188:191], v[32:35]
    v_cvt_pk_bf16_f32 v176, v160, v161
    v_mfma_f32_16x16x32_bf16 v[36:39], a[180:183], v[188:191], v[36:39]
    v_mfma_f32_16x16x32_bf16 v[40:43], a[184:187], v[188:191], v[40:43]
    s_nop 0
    v_mfma_f32_16x16x32_bf16 v[44:47], a[188:191], v[188:191], v[44:47]
    v_cvt_pk_bf16_f32 v177, v162, v163
    s_waitcnt vmcnt(12)
    s_add_u32 s24, s24, 8192
    s_add_u32 m0, s32, 32768
    s_nop 0
    buffer_load_dwordx4 v224, s[4:7], s24 offen offset:0 lds
    buffer_load_dwordx4 v225, s[4:7], s24 offen offset:1024 lds
    s_add_u32 m0, s32, 73728
    s_nop 0
    buffer_load_dwordx4 v226, s[8:11], s24 offen offset:0 lds
    buffer_load_dwordx4 v227, s[8:11], s24 offen offset:1024 lds
    v_lshlrev_b32 v248, 16, v128
    v_and_b32 v249, s31, v128
    v_lshlrev_b32 v250, 16, v129
    v_and_b32 v251, s31, v129
    v_lshlrev_b32 v252, 16, v130
    v_and_b32 v253, s31, v130
    v_lshlrev_b32 v254, 16, v131
    v_and_b32 v255, s31, v131
    v_pk_mul_f32 v[248:249], v[248:249], s[84:85]
    v_pk_mul_f32 v[250:251], v[250:251], s[84:85]
    v_pk_mul_f32 v[252:253], v[252:253], s[84:85]
    v_pk_mul_f32 v[254:255], v[254:255], s[84:85]
    v_cvt_pk_bf16_f32 v248, v248, v249
    v_cvt_pk_bf16_f32 v249, v250, v251
    v_cvt_pk_bf16_f32 v250, v252, v253
    v_cvt_pk_bf16_f32 v251, v254, v255
    ds_write_b128 v230, v[248:251] offset:12288
    v_xor_b32 v229, 64, v230
    v_lshlrev_b32 v248, 16, v132
    v_and_b32 v249, s31, v132
    v_lshlrev_b32 v250, 16, v133
    v_and_b32 v251, s31, v133
    v_lshlrev_b32 v252, 16, v134
    v_and_b32 v253, s31, v134
    v_lshlrev_b32 v254, 16, v135
    v_and_b32 v255, s31, v135
    v_pk_mul_f32 v[248:249], v[248:249], s[84:85]
    v_pk_mul_f32 v[250:251], v[250:251], s[84:85]
    v_pk_mul_f32 v[252:253], v[252:253], s[84:85]
    v_pk_mul_f32 v[254:255], v[254:255], s[84:85]
    v_cvt_pk_bf16_f32 v248, v248, v249
    v_cvt_pk_bf16_f32 v249, v250, v251
    v_cvt_pk_bf16_f32 v250, v252, v253
    v_cvt_pk_bf16_f32 v251, v254, v255
    ds_write_b128 v229, v[248:251] offset:13312
    v_xor_b32 v229, 128, v230
    v_lshlrev_b32 v248, 16, v136
    v_and_b32 v249, s31, v136
    v_lshlrev_b32 v250, 16, v137
    v_and_b32 v251, s31, v137
    v_lshlrev_b32 v252, 16, v138
    v_and_b32 v253, s31, v138
    v_lshlrev_b32 v254, 16, v139
    v_and_b32 v255, s31, v139
    v_pk_mul_f32 v[248:249], v[248:249], s[84:85]
    v_pk_mul_f32 v[250:251], v[250:251], s[84:85]
    v_pk_mul_f32 v[252:253], v[252:253], s[84:85]
    v_pk_mul_f32 v[254:255], v[254:255], s[84:85]
    v_cvt_pk_bf16_f32 v248, v248, v249
    v_cvt_pk_bf16_f32 v249, v250, v251
    v_cvt_pk_bf16_f32 v250, v252, v253
    v_cvt_pk_bf16_f32 v251, v254, v255
    ds_write_b128 v229, v[248:251] offset:14336
    v_xor_b32 v229, 192, v230
    v_lshlrev_b32 v248, 16, v140
    v_and_b32 v249, s31, v140
    v_lshlrev_b32 v250, 16, v141
    v_and_b32 v251, s31, v141
    v_lshlrev_b32 v252, 16, v142
    v_and_b32 v253, s31, v142
    v_lshlrev_b32 v254, 16, v143
    v_and_b32 v255, s31, v143
    v_pk_mul_f32 v[248:249], v[248:249], s[84:85]
    v_pk_mul_f32 v[250:251], v[250:251], s[84:85]
    v_pk_mul_f32 v[252:253], v[252:253], s[84:85]
    v_pk_mul_f32 v[254:255], v[254:255], s[84:85]
    v_cvt_pk_bf16_f32 v248, v248, v249
    v_cvt_pk_bf16_f32 v249, v250, v251
    v_cvt_pk_bf16_f32 v250, v252, v253
    v_cvt_pk_bf16_f32 v251, v254, v255
    ds_write_b128 v229, v[248:251] offset:15360
    ds_read_b128 a[48:51], v232 offset:12288
    ds_read_b128 a[52:55], v233 offset:12288
    ds_read_b128 a[56:59], v234 offset:12288
    ds_read_b128 a[60:63], v235 offset:12288
    s_waitcnt lgkmcnt(0)
    v_mfma_f32_16x16x32_bf16 v[160:163], a[80:83], a[48:51], 0
    v_exp_f32 v168, v168
    v_mfma_f32_16x16x32_bf16 v[160:163], a[84:87], a[52:55], v[160:163]
    v_exp_f32 v169, v169
    v_mfma_f32_16x16x32_bf16 v[160:163], a[88:91], a[56:59], v[160:163]
    v_mfma_f32_16x16x32_bf16 v[160:163], a[92:95], a[60:63], v[160:163]
    v_exp_f32 v170, v170
    v_mfma_f32_16x16x16_bf16 v[48:51], a[160:161], v[184:185], 0
    v_exp_f32 v171, v171
    v_mfma_f32_16x16x16_bf16 v[52:55], a[164:165], v[184:185], 0
    v_cvt_pk_bf16_f32 v180, v168, v169
    v_cvt_pk_bf16_f32 v181, v170, v171
    v_mfma_f32_16x16x16_bf16 v[56:59], a[168:169], v[184:185], 0
    v_exp_f32 v172, v172
    v_max3_f32 v236, v160, v161, v162
    v_max_f32 v236, v236, v163
    v_max_f32 v236, v236, v244
    v_mfma_f32_16x16x16_bf16 v[60:63], a[172:173], v[184:185], 0
    v_exp_f32 v173, v173
    v_mov_b32 v237, v236
    s_nop 1
    v_permlane32_swap_b32 v236, v237
    v_mfma_f32_16x16x32_bf16 a[212:215], a[228:231], v[188:191], a[212:215]
    v_max_f32 v236, v236, v237
    v_mov_b32 v237, v236
    v_mfma_f32_16x16x32_bf16 v[48:51], a[192:195], v[188:191], v[48:51]
    v_exp_f32 v174, v174
    v_permlane16_swap_b32 v236, v237
    v_max_f32 v236, v236, v237
    v_mfma_f32_16x16x32_bf16 v[52:55], a[196:199], v[188:191], v[52:55]
    v_exp_f32 v175, v175
    v_sub_f32 v204, 0, v236
    v_sub_f32 v205, 0, v236
    v_mfma_f32_16x16x32_bf16 v[56:59], a[200:203], v[188:191], v[56:59]
    v_cvt_pk_bf16_f32 v182, v172, v173
    v_cvt_pk_bf16_f32 v183, v174, v175
    v_sub_f32 v206, 0, v236
    v_sub_f32 v207, 0, v236
    v_mfma_f32_16x16x32_bf16 v[60:63], a[204:207], v[188:191], v[60:63]
    s_nop 0
    v_mfma_f32_16x16x32_bf16 v[168:171], a[112:115], a[48:51], v[204:207]
    v_mfma_f32_16x16x32_bf16 v[168:171], a[116:119], a[52:55], v[168:171]
    v_add_f32 v160, v160, v204
    v_add_f32 v161, v161, v204
    v_mfma_f32_16x16x32_bf16 v[168:171], a[120:123], a[56:59], v[168:171]
    v_mfma_f32_16x16x32_bf16 v[168:171], a[124:127], a[60:63], v[168:171]
    v_add_f32 v162, v162, v204
    v_mfma_f32_16x16x32_bf16 v[172:175], a[140:143], a[60:63], v[204:207]
    v_mfma_f32_16x16x32_bf16 v[172:175], a[136:139], a[56:59], v[172:175]
    v_add_f32 v163, v163, v204
    v_mfma_f32_16x16x32_bf16 v[172:175], a[132:135], a[52:55], v[172:175]
    v_exp_f32 v160, v160
    v_mfma_f32_16x16x32_bf16 v[172:175], a[128:131], a[48:51], v[172:175]
    v_mfma_f32_16x16x16_bf16 v[64:67], a[144:145], v[176:177], 0
    v_exp_f32 v161, v161
    v_mfma_f32_16x16x16_bf16 v[68:71], a[148:149], v[176:177], 0
    v_mfma_f32_16x16x16_bf16 v[72:75], a[152:153], v[176:177], 0
    v_exp_f32 v162, v162
    v_mfma_f32_16x16x16_bf16 v[76:79], a[156:157], v[176:177], 0
    v_exp_f32 v163, v163
    v_mfma_f32_16x16x16_bf16 a[216:219], a[228:229], v[176:177], 0
    s_nop 0
    v_mfma_f32_16x16x32_bf16 v[64:67], a[176:179], v[180:183], v[64:67]
    s_nop 0
    v_mfma_f32_16x16x32_bf16 v[68:71], a[180:183], v[180:183], v[68:71]
    v_cvt_pk_bf16_f32 v184, v160, v161
    v_mfma_f32_16x16x32_bf16 v[72:75], a[184:187], v[180:183], v[72:75]
    v_cvt_pk_bf16_f32 v185, v162, v163
    v_mfma_f32_16x16x32_bf16 v[76:79], a[188:191], v[180:183], v[76:79]
    s_waitcnt vmcnt(12)
    v_lshlrev_b32 v248, 16, v144
    v_and_b32 v249, s31, v144
    v_lshlrev_b32 v250, 16, v145
    v_and_b32 v251, s31, v145
    v_lshlrev_b32 v252, 16, v146
    v_and_b32 v253, s31, v146
    v_lshlrev_b32 v254, 16, v147
    v_and_b32 v255, s31, v147
    v_pk_mul_f32 v[248:249], v[248:249], s[84:85]
    v_pk_mul_f32 v[250:251], v[250:251], s[84:85]
    v_pk_mul_f32 v[252:253], v[252:253], s[84:85]
    v_pk_mul_f32 v[254:255], v[254:255], s[84:85]
    v_cvt_pk_bf16_f32 v248, v248, v249
    v_cvt_pk_bf16_f32 v249, v250, v251
    v_cvt_pk_bf16_f32 v250, v252, v253
    v_cvt_pk_bf16_f32 v251, v254, v255
    ds_write_b128 v230, v[248:251] offset:16384
    v_xor_b32 v229, 64, v230
    v_lshlrev_b32 v248, 16, v148
    v_and_b32 v249, s31, v148
    v_lshlrev_b32 v250, 16, v149
    v_and_b32 v251, s31, v149
    v_lshlrev_b32 v252, 16, v150
    v_and_b32 v253, s31, v150
    v_lshlrev_b32 v254, 16, v151
    v_and_b32 v255, s31, v151
    v_pk_mul_f32 v[248:249], v[248:249], s[84:85]
    v_pk_mul_f32 v[250:251], v[250:251], s[84:85]
    v_pk_mul_f32 v[252:253], v[252:253], s[84:85]
    v_pk_mul_f32 v[254:255], v[254:255], s[84:85]
    v_cvt_pk_bf16_f32 v248, v248, v249
    v_cvt_pk_bf16_f32 v249, v250, v251
    v_cvt_pk_bf16_f32 v250, v252, v253
    v_cvt_pk_bf16_f32 v251, v254, v255
    ds_write_b128 v229, v[248:251] offset:17408
    v_xor_b32 v229, 128, v230
    v_lshlrev_b32 v248, 16, v152
    v_and_b32 v249, s31, v152
    v_lshlrev_b32 v250, 16, v153
    v_and_b32 v251, s31, v153
    v_lshlrev_b32 v252, 16, v154
    v_and_b32 v253, s31, v154
    v_lshlrev_b32 v254, 16, v155
    v_and_b32 v255, s31, v155
    v_pk_mul_f32 v[248:249], v[248:249], s[84:85]
    v_pk_mul_f32 v[250:251], v[250:251], s[84:85]
    v_pk_mul_f32 v[252:253], v[252:253], s[84:85]
    v_pk_mul_f32 v[254:255], v[254:255], s[84:85]
    v_cvt_pk_bf16_f32 v248, v248, v249
    v_cvt_pk_bf16_f32 v249, v250, v251
    v_cvt_pk_bf16_f32 v250, v252, v253
    v_cvt_pk_bf16_f32 v251, v254, v255
    ds_write_b128 v229, v[248:251] offset:18432
    v_xor_b32 v229, 192, v230
    v_lshlrev_b32 v248, 16, v156
    v_and_b32 v249, s31, v156
    v_lshlrev_b32 v250, 16, v157
    v_and_b32 v251, s31, v157
    v_lshlrev_b32 v252, 16, v158
    v_and_b32 v253, s31, v158
    v_lshlrev_b32 v254, 16, v159
    v_and_b32 v255, s31, v159
    v_pk_mul_f32 v[248:249], v[248:249], s[84:85]
    v_pk_mul_f32 v[250:251], v[250:251], s[84:85]
    v_pk_mul_f32 v[252:253], v[252:253], s[84:85]
    v_pk_mul_f32 v[254:255], v[254:255], s[84:85]
    v_cvt_pk_bf16_f32 v248, v248, v249
    v_cvt_pk_bf16_f32 v249, v250, v251
    v_cvt_pk_bf16_f32 v250, v252, v253
    v_cvt_pk_bf16_f32 v251, v254, v255
    ds_write_b128 v229, v[248:251] offset:19456
    ds_read_b128 a[64:67], v232 offset:16384
    ds_read_b128 a[68:71], v233 offset:16384
    ds_read_b128 a[72:75], v234 offset:16384
    ds_read_b128 a[76:79], v235 offset:16384
    s_waitcnt lgkmcnt(0)
    v_mfma_f32_16x16x32_bf16 v[160:163], a[80:83], a[64:67], 0
    v_exp_f32 v168, v168
    v_mfma_f32_16x16x32_bf16 v[160:163], a[84:87], a[68:71], v[160:163]
    v_exp_f32 v169, v169
    v_mfma_f32_16x16x32_bf16 v[160:163], a[88:91], a[72:75], v[160:163]
    v_mfma_f32_16x16x32_bf16 v[160:163], a[92:95], a[76:79], v[160:163]
    v_exp_f32 v170, v170
    s_waitcnt vmcnt(4)
    s_barrier
    v_mfma_f32_16x16x16_bf16 v[80:83], a[160:161], v[176:177], 0
    v_exp_f32 v171, v171
    v_mfma_f32_16x16x16_bf16 v[84:87], a[164:165], v[176:177], 0
    v_cvt_pk_bf16_f32 v188, v168, v169
    v_cvt_pk_bf16_f32 v189, v170, v171
    v_mfma_f32_16x16x16_bf16 v[88:91], a[168:169], v[176:177], 0
    v_exp_f32 v172, v172
    v_max3_f32 v236, v160, v161, v162
    v_max3_f32 v236, v236, v163, s57
    v_max_f32 v236, v236, v245
    v_mfma_f32_16x16x16_bf16 v[92:95], a[172:173], v[176:177], 0
    v_exp_f32 v173, v173
    v_mov_b32 v237, v236
    s_nop 1
    v_permlane32_swap_b32 v236, v237
    v_mfma_f32_16x16x32_bf16 a[216:219], a[228:231], v[180:183], a[216:219]
    ds_read_b128 a[80:83], v212 offset:16384
    ds_read_b128 a[84:87], v213 offset:16384
    v_max_f32 v236, v236, v237
    v_mov_b32 v237, v236
    v_mfma_f32_16x16x32_bf16 v[80:83], a[192:195], v[180:183], v[80:83]
    v_exp_f32 v174, v174
    v_permlane16_swap_b32 v236, v237
    v_max_f32 v236, v236, v237
    v_mfma_f32_16x16x32_bf16 v[84:87], a[196:199], v[180:183], v[84:87]
    v_exp_f32 v175, v175
    v_sub_f32 v208, 0, v236
    v_sub_f32 v209, 0, v236
    v_mfma_f32_16x16x32_bf16 v[88:91], a[200:203], v[180:183], v[88:91]
    v_cvt_pk_bf16_f32 v190, v172, v173
    v_cvt_pk_bf16_f32 v191, v174, v175
    v_sub_f32 v210, 0, v236
    v_sub_f32 v211, 0, v236
    v_mfma_f32_16x16x32_bf16 v[92:95], a[204:207], v[180:183], v[92:95]
    ds_read_b128 a[88:91], v214 offset:16384
    ds_read_b128 a[92:95], v215 offset:16384
    s_add_u32 s24, s24, 8192
    s_add_u32 m0, s32, 0
    s_nop 0
    buffer_load_dwordx4 v224, s[4:7], s24 offen offset:0 lds
    buffer_load_dwordx4 v225, s[4:7], s24 offen offset:1024 lds
    s_add_u32 m0, s32, 40960
    s_nop 0
    buffer_load_dwordx4 v226, s[8:11], s24 offen offset:0 lds
    buffer_load_dwordx4 v227, s[8:11], s24 offen offset:1024 lds
    v_mfma_f32_16x16x32_bf16 v[168:171], a[112:115], a[64:67], v[208:211]
    v_add_f32 v160, v160, v208
    v_mfma_f32_16x16x32_bf16 v[168:171], a[116:119], a[68:71], v[168:171]
    ds_read_b128 a[96:99], v212 offset:20480
    v_add_f32 v161, v161, v208
    v_mfma_f32_16x16x32_bf16 v[168:171], a[120:123], a[72:75], v[168:171]
    v_mfma_f32_16x16x32_bf16 v[168:171], a[124:127], a[76:79], v[168:171]
    ds_read_b128 a[100:103], v213 offset:20480
    v_add_f32 v162, v162, v208
    v_mfma_f32_16x16x32_bf16 v[172:175], a[140:143], a[76:79], v[208:211]
    v_mfma_f32_16x16x32_bf16 v[172:175], a[136:139], a[72:75], v[172:175]
    v_add_f32 v163, v163, v208
    v_mfma_f32_16x16x32_bf16 v[172:175], a[132:135], a[68:71], v[172:175]
    ds_read_b128 a[104:107], v214 offset:20480
    v_mfma_f32_16x16x32_bf16 v[172:175], a[128:131], a[64:67], v[172:175]
    v_exp_f32 v160, v160
    v_mfma_f32_16x16x16_bf16 v[96:99], a[144:145], v[184:185], 0
    ds_read_b128 a[108:111], v215 offset:20480
    ds_read_b128 a[112:115], v212 offset:24576
    v_mfma_f32_16x16x16_bf16 v[100:103], a[148:149], v[184:185], 0
    v_exp_f32 v161, v161
    v_mfma_f32_16x16x16_bf16 v[104:107], a[152:153], v[184:185], 0
    ds_read_b128 a[116:119], v213 offset:24576
    v_mfma_f32_16x16x16_bf16 v[108:111], a[156:157], v[184:185], 0
    v_exp_f32 v162, v162
    v_mfma_f32_16x16x16_bf16 a[220:223], a[228:229], v[184:185], 0
    v_exp_f32 v163, v163
    v_mfma_f32_16x16x32_bf16 v[96:99], a[176:179], v[188:191], v[96:99]
    ds_read_b128 a[120:123], v214 offset:24576
    v_cvt_pk_bf16_f32 v176, v160, v161
    v_mfma_f32_16x16x32_bf16 v[100:103], a[180:183], v[188:191], v[100:103]
    v_mfma_f32_16x16x32_bf16 v[104:107], a[184:187], v[188:191], v[104:107]
    ds_read_b128 a[124:127], v215 offset:24576
    v_cvt_pk_bf16_f32 v177, v162, v163
    v_mfma_f32_16x16x32_bf16 v[108:111], a[188:191], v[188:191], v[108:111]
    s_waitcnt lgkmcnt(4)
    s_add_u32 s24, s24, 8192
    s_add_u32 m0, s32, 8192
    s_nop 0
    buffer_load_dwordx4 v224, s[4:7], s24 offen offset:0 lds
    buffer_load_dwordx4 v225, s[4:7], s24 offen offset:1024 lds
    s_add_u32 m0, s32, 49152
    s_nop 0
    buffer_load_dwordx4 v226, s[8:11], s24 offen offset:0 lds
    buffer_load_dwordx4 v227, s[8:11], s24 offen offset:1024 lds
    v_mfma_f32_16x16x32_bf16 v[160:163], a[80:83], a[0:3], v[192:195]
    v_exp_f32 v168, v168
    v_mfma_f32_16x16x32_bf16 v[160:163], a[84:87], a[4:7], v[160:163]
    ds_read_b128 a[128:131], v212 offset:28672
    v_mfma_f32_16x16x32_bf16 v[160:163], a[88:91], a[8:11], v[160:163]
    v_exp_f32 v169, v169
    v_mfma_f32_16x16x32_bf16 v[160:163], a[92:95], a[12:15], v[160:163]
    ds_read_b128 a[132:135], v213 offset:28672
    v_mfma_f32_16x16x32_bf16 v[164:167], a[108:111], a[12:15], v[192:195]
    v_exp_f32 v170, v170
    v_mfma_f32_16x16x32_bf16 v[164:167], a[104:107], a[8:11], v[164:167]
    v_mfma_f32_16x16x32_bf16 v[164:167], a[100:103], a[4:7], v[164:167]
    v_exp_f32 v171, v171
    v_mfma_f32_16x16x32_bf16 v[164:167], a[96:99], a[0:3], v[164:167]
    v_cvt_pk_bf16_f32 v180, v168, v169
    v_cvt_pk_bf16_f32 v181, v170, v171
    v_mfma_f32_16x16x16_bf16 v[112:115], a[160:161], v[184:185], 0
    v_exp_f32 v172, v172
    v_mfma_f32_16x16x16_bf16 v[116:119], a[164:165], v[184:185], 0
    ds_read_b128 a[136:139], v214 offset:28672
    ds_read_b128 a[140:143], v215 offset:28672
    v_mfma_f32_16x16x16_bf16 v[120:123], a[168:169], v[184:185], 0
    v_exp_f32 v173, v173
    v_mfma_f32_16x16x16_bf16 v[124:127], a[172:173], v[184:185], 0
    v_mfma_f32_16x16x32_bf16 a[220:223], a[228:231], v[188:191], a[220:223]
    v_exp_f32 v174, v174
    v_mfma_f32_16x16x32_bf16 v[112:115], a[192:195], v[188:191], v[112:115]
    v_mfma_f32_16x16x32_bf16 v[116:119], a[196:199], v[188:191], v[116:119]
    v_exp_f32 v175, v175
    s_nop 0
    v_mfma_f32_16x16x32_bf16 v[120:123], a[200:203], v[188:191], v[120:123]
    v_cvt_pk_bf16_f32 v182, v172, v173
    v_cvt_pk_bf16_f32 v183, v174, v175
    v_mfma_f32_16x16x32_bf16 v[124:127], a[204:207], v[188:191], v[124:127]
    s_waitcnt lgkmcnt(0)
    v_mfma_f32_16x16x32_bf16 v[168:171], a[112:115], a[0:3], v[192:195]
    v_exp_f32 v160, v160
    v_mfma_f32_16x16x32_bf16 v[168:171], a[116:119], a[4:7], v[168:171]
    v_mfma_f32_16x16x32_bf16 v[168:171], a[120:123], a[8:11], v[168:171]
    v_exp_f32 v161, v161
    v_mfma_f32_16x16x32_bf16 v[168:171], a[124:127], a[12:15], v[168:171]
    v_mfma_f32_16x16x32_bf16 v[172:175], a[140:143], a[12:15], v[192:195]
    v_exp_f32 v162, v162
    v_mfma_f32_16x16x32_bf16 v[172:175], a[136:139], a[8:11], v[172:175]
    v_mfma_f32_16x16x32_bf16 v[172:175], a[132:135], a[4:7], v[172:175]
    v_exp_f32 v163, v163
    v_mfma_f32_16x16x32_bf16 v[172:175], a[128:131], a[0:3], v[172:175]
    v_cvt_pk_bf16_f32 v184, v160, v161
    v_cvt_pk_bf16_f32 v185, v162, v163
    v_mfma_f32_16x16x16_bf16 v[128:131], a[144:145], v[176:177], 0
    v_exp_f32 v164, v164
    v_mfma_f32_16x16x16_bf16 v[132:135], a[148:149], v[176:177], 0
    v_mfma_f32_16x16x16_bf16 v[136:139], a[152:153], v[176:177], 0
    v_exp_f32 v165, v165
    v_mfma_f32_16x16x16_bf16 v[140:143], a[156:157], v[176:177], 0
    v_mfma_f32_16x16x16_bf16 a[224:227], a[228:229], v[176:177], 0
    v_exp_f32 v166, v166
    s_nop 0
    v_mfma_f32_16x16x32_bf16 v[128:131], a[176:179], v[180:183], v[128:131]
    s_nop 0
    v_mfma_f32_16x16x32_bf16 v[132:135], a[180:183], v[180:183], v[132:135]
    v_exp_f32 v167, v167
    v_mfma_f32_16x16x32_bf16 v[136:139], a[184:187], v[180:183], v[136:139]
    v_cvt_pk_bf16_f32 v186, v164, v165
    v_cvt_pk_bf16_f32 v187, v166, v167
    v_mfma_f32_16x16x32_bf16 v[140:143], a[188:191], v[180:183], v[140:143]
L_body:
    v_mfma_f32_16x16x32_bf16 v[160:163], a[80:83], a[16:19], v[196:199]
    s_mov_b32 s35, s34
    v_exp_f32 v168, v168
    v_mfma_f32_16x16x32_bf16 v[160:163], a[84:87], a[20:23], v[160:163]
    ds_read_b64_tr_b16 a[144:145], v216 offset:16384
    ds_read_b64_tr_b16 a[146:147], v216 offset:20480
    v_mfma_f32_16x16x32_bf16 v[160:163], a[88:91], a[24:27], v[160:163]
    s_add_u32 s34, s34, 20447232
    v_exp_f32 v169, v169
    v_mfma_f32_16x16x32_bf16 v[160:163], a[92:95], a[28:31], v[160:163]
    ds_read_b64_tr_b16 a[176:177], v216 offset:24576
    ds_read_b64_tr_b16 a[178:179], v216 offset:28672
    v_mfma_f32_16x16x32_bf16 v[164:167], a[108:111], a[28:31], v[196:199]
    s_add_u32 s12, s20, s34
    s_addc_u32 s13, s21, 0
    v_exp_f32 v170, v170
    v_mfma_f32_16x16x32_bf16 v[164:167], a[104:107], a[24:27], v[164:167]
    ds_read_b64_tr_b16 a[180:181], v217 offset:24576
    ds_read_b64_tr_b16 a[182:183], v217 offset:28672
    v_mfma_f32_16x16x32_bf16 v[164:167], a[100:103], a[20:23], v[164:167]
    s_sub_u32 s33, s33, 1
    v_exp_f32 v171, v171
    v_mfma_f32_16x16x32_bf16 v[164:167], a[96:99], a[16:19], v[164:167]
    v_cvt_pk_bf16_f32 v188, v168, v169
    v_cvt_pk_bf16_f32 v189, v170, v171
    v_mfma_f32_16x16x16_bf16 v[144:147], a[160:161], v[176:177], 0
    s_cmp_lg_u32 s33, 0
    s_cselect_b32 s14, 159744, 0
    s_cselect_b32 s38, 81788928, 0
    v_exp_f32 v172, v172
    v_mfma_f32_16x16x16_bf16 v[148:151], a[164:165], v[176:177], 0
    ds_read_b64_tr_b16 a[148:149], v217 offset:16384
    ds_read_b64_tr_b16 a[150:151], v217 offset:20480
    v_mfma_f32_16x16x16_bf16 v[152:155], a[168:169], v[176:177], 0
    v_exp_f32 v173, v173
    v_mfma_f32_16x16x16_bf16 v[156:159], a[172:173], v[176:177], 0
    ds_read_b64_tr_b16 a[152:153], v218 offset:16384
    ds_read_b64_tr_b16 a[154:155], v218 offset:20480
    v_mfma_f32_16x16x32_bf16 a[224:227], a[228:231], v[180:183], a[224:227]
    v_exp_f32 v174, v174
    v_mfma_f32_16x16x32_bf16 v[144:147], a[192:195], v[180:183], v[144:147]
    ds_read_b64_tr_b16 a[184:185], v218 offset:24576
    ds_read_b64_tr_b16 a[186:187], v218 offset:28672
    v_mfma_f32_16x16x32_bf16 v[148:151], a[196:199], v[180:183], v[148:151]
    v_exp_f32 v175, v175
    v_mfma_f32_16x16x32_bf16 v[152:155], a[200:203], v[180:183], v[152:155]
    v_cvt_pk_bf16_f32 v190, v172, v173
    v_cvt_pk_bf16_f32 v191, v174, v175
    v_mfma_f32_16x16x32_bf16 v[156:159], a[204:207], v[180:183], v[156:159]
    ds_read_b64_tr_b16 a[188:189], v219 offset:24576
    ds_read_b64_tr_b16 a[190:191], v219 offset:28672
    v_mfma_f32_16x16x32_bf16 v[168:171], a[112:115], a[16:19], v[196:199]
    v_exp_f32 v160, v160
    v_mfma_f32_16x16x32_bf16 v[168:171], a[116:119], a[20:23], v[168:171]
    buffer_load_dwordx4 v[232:235], v228, s[12:15], 0 offen offset:0 nt
    v_mfma_f32_16x16x32_bf16 v[168:171], a[120:123], a[24:27], v[168:171]
    v_exp_f32 v161, v161
    v_mfma_f32_16x16x32_bf16 v[168:171], a[124:127], a[28:31], v[168:171]
    ds_read_b64_tr_b16 a[156:157], v219 offset:16384
    ds_read_b64_tr_b16 a[158:159], v219 offset:20480
    v_mfma_f32_16x16x32_bf16 v[172:175], a[140:143], a[28:31], v[196:199]
    v_exp_f32 v162, v162
    v_mfma_f32_16x16x32_bf16 v[172:175], a[136:139], a[24:27], v[172:175]
    ds_read_b64_tr_b16 a[192:193], v220 offset:24576
    ds_read_b64_tr_b16 a[194:195], v220 offset:28672
    v_mfma_f32_16x16x32_bf16 v[172:175], a[132:135], a[20:23], v[172:175]
    v_exp_f32 v163, v163
    v_mfma_f32_16x16x32_bf16 v[172:175], a[128:131], a[16:19], v[172:175]
    s_waitcnt lgkmcnt(14)
    v_cvt_pk_bf16_f32 v176, v160, v161
    v_cvt_pk_bf16_f32 v177, v162, v163
    v_mfma_f32_16x16x32_bf16 v[0:3], a[144:147], v[184:187], v[0:3]
    v_exp_f32 v164, v164
    v_mfma_f32_16x16x32_bf16 v[0:3], a[176:179], v[188:191], v[0:3]
    s_waitcnt lgkmcnt(12)
    ds_read_b64_tr_b16 a[160:161], v220 offset:16384
    ds_read_b64_tr_b16 a[162:163], v220 offset:20480
    v_mfma_f32_16x16x32_bf16 v[4:7], a[180:183], v[188:191], v[4:7]
    s_waitcnt lgkmcnt(12)
    v_exp_f32 v165, v165
    v_mfma_f32_16x16x32_bf16 v[4:7], a[148:151], v[184:187], v[4:7]
    s_waitcnt lgkmcnt(10)
    ds_read_b64_tr_b16 a[164:165], v221 offset:16384
    ds_read_b64_tr_b16 a[166:167], v221 offset:20480
    v_mfma_f32_16x16x32_bf16 v[8:11], a[152:155], v[184:187], v[8:11]
    s_waitcnt lgkmcnt(10)
    v_exp_f32 v166, v166
    v_mfma_f32_16x16x32_bf16 v[8:11], a[184:187], v[188:191], v[8:11]
    s_waitcnt lgkmcnt(8)
    buffer_load_dwordx4 v[236:239], v228, s[12:15], 0 offen offset:1024 nt
    v_mfma_f32_16x16x32_bf16 v[12:15], a[188:191], v[188:191], v[12:15]
    s_waitcnt lgkmcnt(6)
    v_exp_f32 v167, v167
    v_mfma_f32_16x16x32_bf16 v[12:15], a[156:159], v[184:187], v[12:15]
    v_cvt_pk_bf16_f32 v178, v164, v165
    v_cvt_pk_bf16_f32 v179, v166, v167
    v_mfma_f32_16x16x32_bf16 v[160:163], a[80:83], a[32:35], v[200:203]
    v_exp_f32 v168, v168
    v_mfma_f32_16x16x32_bf16 v[160:163], a[84:87], a[36:39], v[160:163]
    ds_read_b64_tr_b16 a[196:197], v221 offset:24576
    ds_read_b64_tr_b16 a[198:199], v221 offset:28672
    v_mfma_f32_16x16x32_bf16 v[160:163], a[88:91], a[40:43], v[160:163]
    v_exp_f32 v169, v169
    v_mfma_f32_16x16x32_bf16 v[160:163], a[92:95], a[44:47], v[160:163]
    ds_read_b64_tr_b16 a[200:201], v222 offset:24576
    ds_read_b64_tr_b16 a[202:203], v222 offset:28672
    v_mfma_f32_16x16x32_bf16 v[164:167], a[108:111], a[44:47], v[200:203]
    v_exp_f32 v170, v170
    v_mfma_f32_16x16x32_bf16 v[164:167], a[104:107], a[40:43], v[164:167]
    ds_read_b64_tr_b16 a[168:169], v222 offset:16384
    ds_read_b64_tr_b16 a[170:171], v222 offset:20480
    ds_read_b64_tr_b16 a[172:173], v223 offset:16384
    v_mfma_f32_16x16x32_bf16 v[164:167], a[100:103], a[36:39], v[164:167]
    ds_read_b64_tr_b16 a[174:175], v223 offset:20480
    v_exp_f32 v171, v171
    v_mfma_f32_16x16x32_bf16 v[164:167], a[96:99], a[32:35], v[164:167]
    s_waitcnt lgkmcnt(12)
    ds_read_b64_tr_b16 a[204:205], v223 offset:24576
    v_cvt_pk_bf16_f32 v180, v168, v169
    v_cvt_pk_bf16_f32 v181, v170, v171
    v_mfma_f32_16x16x32_bf16 v[16:19], a[192:195], v[188:191], v[16:19]
    s_waitcnt lgkmcnt(11)
    ds_read_b64_tr_b16 a[206:207], v223 offset:28672
    v_exp_f32 v172, v172
    v_mfma_f32_16x16x32_bf16 v[16:19], a[160:163], v[184:187], v[16:19]
    s_waitcnt lgkmcnt(10)
    buffer_load_dwordx4 v[240:243], v228, s[12:15], 0 offen offset:2048 nt
    v_mfma_f32_16x16x32_bf16 v[20:23], a[164:167], v[184:187], v[20:23]
    s_waitcnt lgkmcnt(8)
    v_exp_f32 v173, v173
    v_mfma_f32_16x16x32_bf16 v[20:23], a[196:199], v[188:191], v[20:23]
    s_waitcnt lgkmcnt(6)
    v_mfma_f32_16x16x32_bf16 v[24:27], a[200:203], v[188:191], v[24:27]
    s_waitcnt lgkmcnt(4)
    v_exp_f32 v174, v174
    v_mfma_f32_16x16x32_bf16 v[24:27], a[168:171], v[184:187], v[24:27]
    s_waitcnt lgkmcnt(2)
    v_mfma_f32_16x16x32_bf16 v[28:31], a[172:175], v[184:187], v[28:31]
    s_waitcnt lgkmcnt(0)
    v_exp_f32 v175, v175
    v_mfma_f32_16x16x32_bf16 v[28:31], a[204:207], v[188:191], v[28:31]
    v_cvt_pk_bf16_f32 v182, v172, v173
    v_cvt_pk_bf16_f32 v183, v174, v175
    v_smfmac_f32_16x16x64_bf16 a[208:211], a[248:251], v[184:191], v231
    s_waitcnt vmcnt(7)
    s_barrier
    v_mfma_f32_16x16x32_bf16 v[168:171], a[112:115], a[32:35], v[200:203]
    s_add_u32 s24, s24, 8192
    v_exp_f32 v160, v160
    v_mfma_f32_16x16x32_bf16 v[168:171], a[116:119], a[36:39], v[168:171]
    v_mfma_f32_16x16x32_bf16 v[168:171], a[120:123], a[40:43], v[168:171]
    v_exp_f32 v161, v161
    v_mfma_f32_16x16x32_bf16 v[168:171], a[124:127], a[44:47], v[168:171]
    s_add_u32 m0, s32, 16384
    buffer_load_dwordx4 v[244:247], v228, s[12:15], 0 offen offset:3072 nt
    v_mfma_f32_16x16x32_bf16 v[172:175], a[140:143], a[44:47], v[200:203]
    v_exp_f32 v162, v162
    v_mfma_f32_16x16x32_bf16 v[172:175], a[136:139], a[40:43], v[172:175]
    v_mfma_f32_16x16x32_bf16 v[172:175], a[132:135], a[36:39], v[172:175]
    v_exp_f32 v163, v163
    v_mfma_f32_16x16x32_bf16 v[172:175], a[128:131], a[32:35], v[172:175]
    v_cvt_pk_bf16_f32 v184, v160, v161
    v_cvt_pk_bf16_f32 v185, v162, v163
    v_mfma_f32_16x16x32_bf16 v[32:35], a[144:147], v[176:179], v[32:35]
    v_exp_f32 v164, v164
    v_mfma_f32_16x16x32_bf16 v[32:35], a[176:179], v[180:183], v[32:35]
    buffer_load_dwordx4 v224, s[4:7], s24 offen offset:0 lds
    v_mfma_f32_16x16x32_bf16 v[36:39], a[180:183], v[180:183], v[36:39]
    v_exp_f32 v165, v165
    v_mfma_f32_16x16x32_bf16 v[36:39], a[148:151], v[176:179], v[36:39]
    buffer_load_dwordx4 v225, s[4:7], s24 offen offset:1024 lds
    v_mfma_f32_16x16x32_bf16 v[40:43], a[152:155], v[176:179], v[40:43]
    v_exp_f32 v166, v166
    v_mfma_f32_16x16x32_bf16 v[40:43], a[184:187], v[180:183], v[40:43]
    v_mfma_f32_16x16x32_bf16 v[44:47], a[188:191], v[180:183], v[44:47]
    s_add_u32 m0, s32, 57344
    v_exp_f32 v167, v167
    v_mfma_f32_16x16x32_bf16 v[44:47], a[156:159], v[176:179], v[44:47]
    v_cvt_pk_bf16_f32 v186, v164, v165
    v_cvt_pk_bf16_f32 v187, v166, v167
    v_mfma_f32_16x16x32_bf16 v[160:163], a[80:83], a[48:51], v[204:207]
    v_exp_f32 v168, v168
    v_mfma_f32_16x16x32_bf16 v[160:163], a[84:87], a[52:55], v[160:163]
    buffer_load_dwordx4 v226, s[8:11], s24 offen offset:0 lds
    v_mfma_f32_16x16x32_bf16 v[160:163], a[88:91], a[56:59], v[160:163]
    v_exp_f32 v169, v169
    v_mfma_f32_16x16x32_bf16 v[160:163], a[92:95], a[60:63], v[160:163]
    v_mfma_f32_16x16x32_bf16 v[164:167], a[108:111], a[60:63], v[204:207]
    v_exp_f32 v170, v170
    v_mfma_f32_16x16x32_bf16 v[164:167], a[104:107], a[56:59], v[164:167]
    buffer_load_dwordx4 v227, s[8:11], s24 offen offset:1024 lds
    v_mfma_f32_16x16x32_bf16 v[164:167], a[100:103], a[52:55], v[164:167]
    v_exp_f32 v171, v171
    v_mfma_f32_16x16x32_bf16 v[164:167], a[96:99], a[48:51], v[164:167]
    v_cvt_pk_bf16_f32 v188, v168, v169
    v_cvt_pk_bf16_f32 v189, v170, v171
    v_mfma_f32_16x16x32_bf16 v[48:51], a[192:195], v[180:183], v[48:51]
    v_exp_f32 v172, v172
    v_mfma_f32_16x16x32_bf16 v[48:51], a[160:163], v[176:179], v[48:51]
    s_add_u32 s24, s24, 8192
    v_mfma_f32_16x16x32_bf16 v[52:55], a[164:167], v[176:179], v[52:55]
    v_exp_f32 v173, v173
    v_mfma_f32_16x16x32_bf16 v[52:55], a[196:199], v[180:183], v[52:55]
    v_mfma_f32_16x16x32_bf16 v[56:59], a[200:203], v[180:183], v[56:59]
    v_exp_f32 v174, v174
    v_mfma_f32_16x16x32_bf16 v[56:59], a[168:171], v[176:179], v[56:59]
    s_add_u32 m0, s32, 24576
    v_mfma_f32_16x16x32_bf16 v[60:63], a[172:175], v[176:179], v[60:63]
    v_exp_f32 v175, v175
    v_mfma_f32_16x16x32_bf16 v[60:63], a[204:207], v[180:183], v[60:63]
    v_cvt_pk_bf16_f32 v190, v172, v173
    v_cvt_pk_bf16_f32 v191, v174, v175
    v_smfmac_f32_16x16x64_bf16 a[212:215], a[248:251], v[176:183], v231
    v_mfma_f32_16x16x32_bf16 v[168:171], a[112:115], a[48:51], v[204:207]
    s_waitcnt vmcnt(7)
    v_exp_f32 v160, v160
    v_mfma_f32_16x16x32_bf16 v[168:171], a[116:119], a[52:55], v[168:171]
    buffer_load_dwordx4 v224, s[4:7], s24 offen offset:0 lds
    v_mfma_f32_16x16x32_bf16 v[168:171], a[120:123], a[56:59], v[168:171]
    v_exp_f32 v161, v161
    v_mfma_f32_16x16x32_bf16 v[168:171], a[124:127], a[60:63], v[168:171]
    ds_read_b128 a[232:235], v230 offset:0
    v_lshlrev_b32 v248, 16, v232
    v_mfma_f32_16x16x32_bf16 v[172:175], a[140:143], a[60:63], v[204:207]
    v_exp_f32 v162, v162
    v_mfma_f32_16x16x32_bf16 v[172:175], a[136:139], a[56:59], v[172:175]
    v_and_b32 v249, s31, v232
    v_lshlrev_b32 v250, 16, v233
    v_mfma_f32_16x16x32_bf16 v[172:175], a[132:135], a[52:55], v[172:175]
    v_exp_f32 v163, v163
    v_mfma_f32_16x16x32_bf16 v[172:175], a[128:131], a[48:51], v[172:175]
    v_cvt_pk_bf16_f32 v176, v160, v161
    v_cvt_pk_bf16_f32 v177, v162, v163
    v_mfma_f32_16x16x32_bf16 v[64:67], a[144:147], v[184:187], v[64:67]
    v_exp_f32 v164, v164
    v_mfma_f32_16x16x32_bf16 v[64:67], a[176:179], v[188:191], v[64:67]
    buffer_load_dwordx4 v225, s[4:7], s24 offen offset:1024 lds
    v_mfma_f32_16x16x32_bf16 v[68:71], a[180:183], v[188:191], v[68:71]
    s_add_u32 m0, s32, 65536
    v_exp_f32 v165, v165
    v_mfma_f32_16x16x32_bf16 v[68:71], a[148:151], v[184:187], v[68:71]
    v_and_b32 v251, s31, v233
    v_lshlrev_b32 v252, 16, v234
    v_mfma_f32_16x16x32_bf16 v[72:75], a[152:155], v[184:187], v[72:75]
    v_exp_f32 v166, v166
    v_mfma_f32_16x16x32_bf16 v[72:75], a[184:187], v[188:191], v[72:75]
    v_and_b32 v253, s31, v234
    v_lshlrev_b32 v254, 16, v235
    v_mfma_f32_16x16x32_bf16 v[76:79], a[188:191], v[188:191], v[76:79]
    v_exp_f32 v167, v167
    v_mfma_f32_16x16x32_bf16 v[76:79], a[156:159], v[184:187], v[76:79]
    v_cvt_pk_bf16_f32 v178, v164, v165
    v_cvt_pk_bf16_f32 v179, v166, v167
    v_mfma_f32_16x16x32_bf16 v[160:163], a[80:83], a[64:67], v[208:211]
    v_exp_f32 v168, v168
    v_mfma_f32_16x16x32_bf16 v[160:163], a[84:87], a[68:71], v[160:163]
    buffer_load_dwordx4 v226, s[8:11], s24 offen offset:0 lds
    v_mfma_f32_16x16x32_bf16 v[160:163], a[88:91], a[72:75], v[160:163]
    v_exp_f32 v169, v169
    v_mfma_f32_16x16x32_bf16 v[160:163], a[92:95], a[76:79], v[160:163]
    s_waitcnt lgkmcnt(0)
    buffer_store_dwordx4 a[232:235], v228, s[16:19], 0 offen offset:0 nt
    v_mfma_f32_16x16x32_bf16 v[164:167], a[108:111], a[76:79], v[208:211]
    v_exp_f32 v170, v170
    v_mfma_f32_16x16x32_bf16 v[164:167], a[104:107], a[72:75], v[164:167]
    buffer_load_dwordx4 v227, s[8:11], s24 offen offset:1024 lds
    v_mfma_f32_16x16x32_bf16 v[164:167], a[100:103], a[68:71], v[164:167]
    v_exp_f32 v171, v171
    v_mfma_f32_16x16x32_bf16 v[164:167], a[96:99], a[64:67], v[164:167]
    v_cvt_pk_bf16_f32 v180, v168, v169
    v_cvt_pk_bf16_f32 v181, v170, v171
    v_mfma_f32_16x16x32_bf16 v[80:83], a[192:195], v[188:191], v[80:83]
    v_exp_f32 v172, v172
    v_mfma_f32_16x16x32_bf16 v[80:83], a[160:163], v[184:187], v[80:83]
    ds_read_b128 a[80:83], v212 offset:32768
    v_and_b32 v255, s31, v235
    v_pk_mul_f32 v[248:249], v[248:249], s[84:85]
    v_pk_mul_f32 v[250:251], v[250:251], s[84:85]
    v_pk_mul_f32 v[252:253], v[252:253], s[84:85]
    v_pk_mul_f32 v[254:255], v[254:255], s[84:85]
    v_mfma_f32_16x16x32_bf16 v[84:87], a[164:167], v[184:187], v[84:87]
    v_exp_f32 v173, v173
    v_mfma_f32_16x16x32_bf16 v[84:87], a[196:199], v[188:191], v[84:87]
    ds_read_b128 a[84:87], v213 offset:32768
    v_cvt_pk_bf16_f32 v248, v248, v249
    v_mfma_f32_16x16x32_bf16 v[88:91], a[200:203], v[188:191], v[88:91]
    v_exp_f32 v174, v174
    v_mfma_f32_16x16x32_bf16 v[88:91], a[168:171], v[184:187], v[88:91]
    ds_read_b128 a[88:91], v214 offset:32768
    v_cvt_pk_bf16_f32 v249, v250, v251
    v_mfma_f32_16x16x32_bf16 v[92:95], a[172:175], v[184:187], v[92:95]
    v_exp_f32 v175, v175
    v_mfma_f32_16x16x32_bf16 v[92:95], a[204:207], v[188:191], v[92:95]
    v_cvt_pk_bf16_f32 v182, v172, v173
    v_cvt_pk_bf16_f32 v183, v174, v175
    v_smfmac_f32_16x16x64_bf16 a[216:219], a[248:251], v[184:191], v231
    ds_read_b128 a[92:95], v215 offset:32768
    v_mfma_f32_16x16x32_bf16 v[168:171], a[112:115], a[64:67], v[208:211]
    v_exp_f32 v160, v160
    v_mfma_f32_16x16x32_bf16 v[168:171], a[116:119], a[68:71], v[168:171]
    ds_read_b128 a[96:99], v212 offset:36864
    v_cvt_pk_bf16_f32 v250, v252, v253
    v_mfma_f32_16x16x32_bf16 v[168:171], a[120:123], a[72:75], v[168:171]
    v_exp_f32 v161, v161
    v_mfma_f32_16x16x32_bf16 v[168:171], a[124:127], a[76:79], v[168:171]
    ds_read_b128 a[100:103], v213 offset:36864
    v_cvt_pk_bf16_f32 v251, v254, v255
    v_mfma_f32_16x16x32_bf16 v[172:175], a[140:143], a[76:79], v[208:211]
    v_exp_f32 v162, v162
    v_mfma_f32_16x16x32_bf16 v[172:175], a[136:139], a[72:75], v[172:175]
    ds_read_b128 a[104:107], v214 offset:36864
    v_mfma_f32_16x16x32_bf16 v[172:175], a[132:135], a[68:71], v[172:175]
    v_exp_f32 v163, v163
    v_mfma_f32_16x16x32_bf16 v[172:175], a[128:131], a[64:67], v[172:175]
    v_cvt_pk_bf16_f32 v184, v160, v161
    v_cvt_pk_bf16_f32 v185, v162, v163
    v_mfma_f32_16x16x32_bf16 v[96:99], a[144:147], v[176:179], v[96:99]
    v_exp_f32 v164, v164
    v_mfma_f32_16x16x32_bf16 v[96:99], a[176:179], v[180:183], v[96:99]
    ds_read_b128 a[108:111], v215 offset:36864
    ds_read_b128 a[112:115], v212 offset:0
    v_mfma_f32_16x16x32_bf16 v[100:103], a[180:183], v[180:183], v[100:103]
    v_exp_f32 v165, v165
    v_mfma_f32_16x16x32_bf16 v[100:103], a[148:151], v[176:179], v[100:103]
    ds_read_b128 a[116:119], v213 offset:0
    ds_write_b128 v230, v[248:251] offset:0
    v_mfma_f32_16x16x32_bf16 v[104:107], a[152:155], v[176:179], v[104:107]
    v_exp_f32 v166, v166
    v_mfma_f32_16x16x32_bf16 v[104:107], a[184:187], v[180:183], v[104:107]
    ds_read_b128 a[120:123], v214 offset:0
    v_mfma_f32_16x16x32_bf16 v[108:111], a[188:191], v[180:183], v[108:111]
    v_exp_f32 v167, v167
    v_mfma_f32_16x16x32_bf16 v[108:111], a[156:159], v[176:179], v[108:111]
    s_waitcnt lgkmcnt(4)
    v_cvt_pk_bf16_f32 v186, v164, v165
    v_cvt_pk_bf16_f32 v187, v166, v167
    v_mfma_f32_16x16x32_bf16 v[160:163], a[80:83], a[0:3], v[192:195]
    v_exp_f32 v168, v168
    v_mfma_f32_16x16x32_bf16 v[160:163], a[84:87], a[4:7], v[160:163]
    ds_read_b128 a[124:127], v215 offset:0
    ds_read_b128 a[128:131], v212 offset:4096
    v_mfma_f32_16x16x32_bf16 v[160:163], a[88:91], a[8:11], v[160:163]
    s_waitcnt vmcnt(11)
    v_exp_f32 v169, v169
    v_mfma_f32_16x16x32_bf16 v[160:163], a[92:95], a[12:15], v[160:163]
    ds_read_b128 a[132:135], v213 offset:4096
    v_xor_b32 v229, 64, v230
    v_mfma_f32_16x16x32_bf16 v[164:167], a[108:111], a[12:15], v[192:195]
    v_exp_f32 v170, v170
    v_mfma_f32_16x16x32_bf16 v[164:167], a[104:107], a[8:11], v[164:167]
    buffer_load_dwordx4 v[232:235], v228, s[12:15], s26 offen offset:0 nt
    v_mfma_f32_16x16x32_bf16 v[164:167], a[100:103], a[4:7], v[164:167]
    v_exp_f32 v171, v171
    v_mfma_f32_16x16x32_bf16 v[164:167], a[96:99], a[0:3], v[164:167]
    v_cvt_pk_bf16_f32 v188, v168, v169
    v_cvt_pk_bf16_f32 v189, v170, v171
    v_mfma_f32_16x16x32_bf16 v[112:115], a[192:195], v[180:183], v[112:115]
    v_exp_f32 v172, v172
    v_mfma_f32_16x16x32_bf16 v[112:115], a[160:163], v[176:179], v[112:115]
    ds_read_b128 a[136:139], v214 offset:4096
    ds_read_b128 a[140:143], v215 offset:4096
    v_mfma_f32_16x16x32_bf16 v[116:119], a[164:167], v[176:179], v[116:119]
    v_exp_f32 v173, v173
    v_mfma_f32_16x16x32_bf16 v[116:119], a[196:199], v[180:183], v[116:119]
    ds_read_b128 a[236:239], v229 offset:1024
    v_lshlrev_b32 v248, 16, v236
    v_mfma_f32_16x16x32_bf16 v[120:123], a[200:203], v[180:183], v[120:123]
    v_exp_f32 v174, v174
    v_mfma_f32_16x16x32_bf16 v[120:123], a[168:171], v[176:179], v[120:123]
    v_and_b32 v249, s31, v236
    v_lshlrev_b32 v250, 16, v237
    v_mfma_f32_16x16x32_bf16 v[124:127], a[172:175], v[176:179], v[124:127]
    v_exp_f32 v175, v175
    v_mfma_f32_16x16x32_bf16 v[124:127], a[204:207], v[180:183], v[124:127]
    v_cvt_pk_bf16_f32 v190, v172, v173
    v_cvt_pk_bf16_f32 v191, v174, v175
    v_smfmac_f32_16x16x64_bf16 a[220:223], a[248:251], v[176:183], v231
    s_waitcnt lgkmcnt(1)
    v_and_b32 v251, s31, v237
    v_mfma_f32_16x16x32_bf16 v[168:171], a[112:115], a[0:3], v[192:195]
    v_exp_f32 v160, v160
    v_mfma_f32_16x16x32_bf16 v[168:171], a[116:119], a[4:7], v[168:171]
    v_lshlrev_b32 v252, 16, v238
    v_and_b32 v253, s31, v238
    v_mfma_f32_16x16x32_bf16 v[168:171], a[120:123], a[8:11], v[168:171]
    v_exp_f32 v161, v161
    v_mfma_f32_16x16x32_bf16 v[168:171], a[124:127], a[12:15], v[168:171]
    v_lshlrev_b32 v254, 16, v239
    v_and_b32 v255, s31, v239
    v_pk_mul_f32 v[248:249], v[248:249], s[84:85]
    v_pk_mul_f32 v[250:251], v[250:251], s[84:85]
    v_pk_mul_f32 v[252:253], v[252:253], s[84:85]
    v_pk_mul_f32 v[254:255], v[254:255], s[84:85]
    v_mfma_f32_16x16x32_bf16 v[172:175], a[140:143], a[12:15], v[192:195]
    v_exp_f32 v162, v162
    v_mfma_f32_16x16x32_bf16 v[172:175], a[136:139], a[8:11], v[172:175]
    v_cvt_pk_bf16_f32 v248, v248, v249
    v_cvt_pk_bf16_f32 v249, v250, v251
    v_mfma_f32_16x16x32_bf16 v[172:175], a[132:135], a[4:7], v[172:175]
    s_waitcnt lgkmcnt(0)
    buffer_store_dwordx4 a[236:239], v228, s[16:19], 0 offen offset:1024 nt
    v_exp_f32 v163, v163
    v_mfma_f32_16x16x32_bf16 v[172:175], a[128:131], a[0:3], v[172:175]
    v_cvt_pk_bf16_f32 v176, v160, v161
    v_cvt_pk_bf16_f32 v177, v162, v163
    v_mfma_f32_16x16x32_bf16 v[128:131], a[144:147], v[184:187], v[128:131]
    v_exp_f32 v164, v164
    v_mfma_f32_16x16x32_bf16 v[128:131], a[176:179], v[188:191], v[128:131]
    ds_read_b64_tr_b16 a[144:145], v216 offset:32768
    ds_read_b64_tr_b16 a[146:147], v216 offset:36864
    v_mfma_f32_16x16x32_bf16 v[132:135], a[180:183], v[188:191], v[132:135]
    v_exp_f32 v165, v165
    v_mfma_f32_16x16x32_bf16 v[132:135], a[148:151], v[184:187], v[132:135]
    ds_read_b64_tr_b16 a[176:177], v216 offset:0
    ds_read_b64_tr_b16 a[178:179], v216 offset:4096
    v_mfma_f32_16x16x32_bf16 v[136:139], a[152:155], v[184:187], v[136:139]
    v_exp_f32 v166, v166
    v_mfma_f32_16x16x32_bf16 v[136:139], a[184:187], v[188:191], v[136:139]
    ds_read_b64_tr_b16 a[180:181], v217 offset:0
    ds_read_b64_tr_b16 a[182:183], v217 offset:4096
    v_mfma_f32_16x16x32_bf16 v[140:143], a[188:191], v[188:191], v[140:143]
    v_exp_f32 v167, v167
    v_mfma_f32_16x16x32_bf16 v[140:143], a[156:159], v[184:187], v[140:143]
    v_cvt_pk_bf16_f32 v178, v164, v165
    v_cvt_pk_bf16_f32 v179, v166, v167
    v_mfma_f32_16x16x32_bf16 v[160:163], a[80:83], a[16:19], v[196:199]
    v_exp_f32 v168, v168
    v_mfma_f32_16x16x32_bf16 v[160:163], a[84:87], a[20:23], v[160:163]
    ds_read_b64_tr_b16 a[148:149], v217 offset:32768
    ds_read_b64_tr_b16 a[150:151], v217 offset:36864
    v_mfma_f32_16x16x32_bf16 v[160:163], a[88:91], a[24:27], v[160:163]
    v_exp_f32 v169, v169
    v_mfma_f32_16x16x32_bf16 v[160:163], a[92:95], a[28:31], v[160:163]
    ds_read_b64_tr_b16 a[152:153], v218 offset:32768
    ds_read_b64_tr_b16 a[154:155], v218 offset:36864
    v_mfma_f32_16x16x32_bf16 v[164:167], a[108:111], a[28:31], v[196:199]
    v_exp_f32 v170, v170
    v_mfma_f32_16x16x32_bf16 v[164:167], a[104:107], a[24:27], v[164:167]
    ds_read_b64_tr_b16 a[184:185], v218 offset:0
    ds_read_b64_tr_b16 a[186:187], v218 offset:4096
    v_mfma_f32_16x16x32_bf16 v[164:167], a[100:103], a[20:23], v[164:167]
    v_exp_f32 v171, v171
    v_mfma_f32_16x16x32_bf16 v[164:167], a[96:99], a[16:19], v[164:167]
    v_cvt_pk_bf16_f32 v180, v168, v169
    v_cvt_pk_bf16_f32 v181, v170, v171
    v_mfma_f32_16x16x32_bf16 v[144:147], a[192:195], v[188:191], v[144:147]
    v_exp_f32 v172, v172
    v_mfma_f32_16x16x32_bf16 v[144:147], a[160:163], v[184:187], v[144:147]
    ds_read_b64_tr_b16 a[188:189], v219 offset:0
    ds_read_b64_tr_b16 a[190:191], v219 offset:4096
    v_mfma_f32_16x16x32_bf16 v[148:151], a[164:167], v[184:187], v[148:151]
    v_exp_f32 v173, v173
    v_mfma_f32_16x16x32_bf16 v[148:151], a[196:199], v[188:191], v[148:151]
    ds_read_b64_tr_b16 a[156:157], v219 offset:32768
    ds_read_b64_tr_b16 a[158:159], v219 offset:36864
    v_mfma_f32_16x16x32_bf16 v[152:155], a[200:203], v[188:191], v[152:155]
    v_exp_f32 v174, v174
    v_mfma_f32_16x16x32_bf16 v[152:155], a[168:171], v[184:187], v[152:155]
    ds_read_b64_tr_b16 a[192:193], v220 offset:0
    ds_read_b64_tr_b16 a[194:195], v220 offset:4096
    v_mfma_f32_16x16x32_bf16 v[156:159], a[172:175], v[184:187], v[156:159]
    v_exp_f32 v175, v175
    v_mfma_f32_16x16x32_bf16 v[156:159], a[204:207], v[188:191], v[156:159]
    v_cvt_pk_bf16_f32 v182, v172, v173
    v_cvt_pk_bf16_f32 v183, v174, v175
    v_smfmac_f32_16x16x64_bf16 a[224:227], a[248:251], v[184:191], v231
    ds_read_b64_tr_b16 a[160:161], v220 offset:32768
    v_mfma_f32_16x16x32_bf16 v[168:171], a[112:115], a[16:19], v[196:199]
    v_exp_f32 v160, v160
    v_mfma_f32_16x16x32_bf16 v[168:171], a[116:119], a[20:23], v[168:171]
    ds_read_b64_tr_b16 a[162:163], v220 offset:36864
    ds_read_b64_tr_b16 a[164:165], v221 offset:32768
    v_mfma_f32_16x16x32_bf16 v[168:171], a[120:123], a[24:27], v[168:171]
    v_exp_f32 v161, v161
    v_mfma_f32_16x16x32_bf16 v[168:171], a[124:127], a[28:31], v[168:171]
    ds_read_b64_tr_b16 a[166:167], v221 offset:36864
    ds_read_b64_tr_b16 a[196:197], v221 offset:0
    v_mfma_f32_16x16x32_bf16 v[172:175], a[140:143], a[28:31], v[196:199]
    v_exp_f32 v162, v162
    v_mfma_f32_16x16x32_bf16 v[172:175], a[136:139], a[24:27], v[172:175]
    ds_read_b64_tr_b16 a[198:199], v221 offset:4096
    ds_read_b64_tr_b16 a[200:201], v222 offset:0
    v_mfma_f32_16x16x32_bf16 v[172:175], a[132:135], a[20:23], v[172:175]
    v_exp_f32 v163, v163
    v_mfma_f32_16x16x32_bf16 v[172:175], a[128:131], a[16:19], v[172:175]
    s_waitcnt lgkmcnt(14)
    v_cvt_pk_bf16_f32 v184, v160, v161
    v_cvt_pk_bf16_f32 v185, v162, v163
    v_mfma_f32_16x16x32_bf16 v[0:3], a[144:147], v[176:179], v[0:3]
    v_exp_f32 v164, v164
    v_mfma_f32_16x16x32_bf16 v[0:3], a[176:179], v[180:183], v[0:3]
    ds_read_b64_tr_b16 a[202:203], v222 offset:4096
    ds_read_b64_tr_b16 a[168:169], v222 offset:32768
    v_mfma_f32_16x16x32_bf16 v[4:7], a[180:183], v[180:183], v[4:7]
    s_waitcnt lgkmcnt(14)
    v_exp_f32 v165, v165
    v_mfma_f32_16x16x32_bf16 v[4:7], a[148:151], v[176:179], v[4:7]
    ds_read_b64_tr_b16 a[170:171], v222 offset:36864
    ds_read_b64_tr_b16 a[172:173], v223 offset:32768
    v_mfma_f32_16x16x32_bf16 v[8:11], a[152:155], v[176:179], v[8:11]
    s_waitcnt lgkmcnt(14)
    v_exp_f32 v166, v166
    v_mfma_f32_16x16x32_bf16 v[8:11], a[184:187], v[180:183], v[8:11]
    ds_read_b64_tr_b16 a[174:175], v223 offset:36864
    ds_read_b64_tr_b16 a[204:205], v223 offset:0
    v_mfma_f32_16x16x32_bf16 v[12:15], a[188:191], v[180:183], v[12:15]
    s_waitcnt lgkmcnt(14)
    v_exp_f32 v167, v167
    v_mfma_f32_16x16x32_bf16 v[12:15], a[156:159], v[176:179], v[12:15]
    v_cvt_pk_bf16_f32 v186, v164, v165
    v_cvt_pk_bf16_f32 v187, v166, v167
    v_mfma_f32_16x16x32_bf16 v[160:163], a[80:83], a[32:35], v[200:203]
    v_exp_f32 v168, v168
    v_mfma_f32_16x16x32_bf16 v[160:163], a[84:87], a[36:39], v[160:163]
    ds_read_b64_tr_b16 a[206:207], v223 offset:4096
    v_cvt_pk_bf16_f32 v250, v252, v253
    v_mfma_f32_16x16x32_bf16 v[160:163], a[88:91], a[40:43], v[160:163]
    v_exp_f32 v169, v169
    v_mfma_f32_16x16x32_bf16 v[160:163], a[92:95], a[44:47], v[160:163]
    v_cvt_pk_bf16_f32 v251, v254, v255
    v_mfma_f32_16x16x32_bf16 v[164:167], a[108:111], a[44:47], v[200:203]
    v_exp_f32 v170, v170
    v_mfma_f32_16x16x32_bf16 v[164:167], a[104:107], a[40:43], v[164:167]
    v_mfma_f32_16x16x32_bf16 v[164:167], a[100:103], a[36:39], v[164:167]
    v_exp_f32 v171, v171
    v_mfma_f32_16x16x32_bf16 v[164:167], a[96:99], a[32:35], v[164:167]
    s_waitcnt lgkmcnt(14)
    v_cvt_pk_bf16_f32 v188, v168, v169
    v_cvt_pk_bf16_f32 v189, v170, v171
    v_mfma_f32_16x16x32_bf16 v[16:19], a[192:195], v[180:183], v[16:19]
    s_waitcnt lgkmcnt(12)
    v_exp_f32 v172, v172
    v_mfma_f32_16x16x32_bf16 v[16:19], a[160:163], v[176:179], v[16:19]
    s_waitcnt lgkmcnt(10)
    ds_write_b128 v229, v[248:251] offset:1024
    v_mfma_f32_16x16x32_bf16 v[20:23], a[164:167], v[176:179], v[20:23]
    s_waitcnt lgkmcnt(9)
    v_exp_f32 v173, v173
    v_mfma_f32_16x16x32_bf16 v[20:23], a[196:199], v[180:183], v[20:23]
    s_waitcnt lgkmcnt(7)
    buffer_load_dwordx4 v[236:239], v228, s[12:15], s26 offen offset:1024 nt
    v_mfma_f32_16x16x32_bf16 v[24:27], a[200:203], v[180:183], v[24:27]
    s_waitcnt lgkmcnt(5)
    v_exp_f32 v174, v174
    v_mfma_f32_16x16x32_bf16 v[24:27], a[168:171], v[176:179], v[24:27]
    s_waitcnt lgkmcnt(3)
    v_mfma_f32_16x16x32_bf16 v[28:31], a[172:175], v[176:179], v[28:31]
    s_waitcnt lgkmcnt(1)
    v_exp_f32 v175, v175
    v_mfma_f32_16x16x32_bf16 v[28:31], a[204:207], v[180:183], v[28:31]
    v_cvt_pk_bf16_f32 v190, v172, v173
    v_cvt_pk_bf16_f32 v191, v174, v175
    v_smfmac_f32_16x16x64_bf16 a[208:211], a[248:251], v[176:183], v231
    s_waitcnt vmcnt(8)
    s_barrier
    v_mfma_f32_16x16x32_bf16 v[168:171], a[112:115], a[32:35], v[200:203]
    s_add_u32 s24, s24, 8192
    v_exp_f32 v160, v160
    v_mfma_f32_16x16x32_bf16 v[168:171], a[116:119], a[36:39], v[168:171]
    v_xor_b32 v229, 128, v230
    v_lshlrev_b32 v248, 16, v240
    v_mfma_f32_16x16x32_bf16 v[168:171], a[120:123], a[40:43], v[168:171]
    v_exp_f32 v161, v161
    v_mfma_f32_16x16x32_bf16 v[168:171], a[124:127], a[44:47], v[168:171]
    s_add_u32 m0, s32, 32768
    ds_read_b128 a[240:243], v229 offset:2048
    v_and_b32 v249, s31, v240
    v_mfma_f32_16x16x32_bf16 v[172:175], a[140:143], a[44:47], v[200:203]
    v_exp_f32 v162, v162
    v_mfma_f32_16x16x32_bf16 v[172:175], a[136:139], a[40:43], v[172:175]
    v_lshlrev_b32 v250, 16, v241
    v_and_b32 v251, s31, v241
    v_mfma_f32_16x16x32_bf16 v[172:175], a[132:135], a[36:39], v[172:175]
    v_exp_f32 v163, v163
    v_mfma_f32_16x16x32_bf16 v[172:175], a[128:131], a[32:35], v[172:175]
    v_cvt_pk_bf16_f32 v176, v160, v161
    v_cvt_pk_bf16_f32 v177, v162, v163
    v_mfma_f32_16x16x32_bf16 v[32:35], a[144:147], v[184:187], v[32:35]
    v_exp_f32 v164, v164
    v_mfma_f32_16x16x32_bf16 v[32:35], a[176:179], v[188:191], v[32:35]
    buffer_load_dwordx4 v224, s[4:7], s24 offen offset:0 lds
    v_mfma_f32_16x16x32_bf16 v[36:39], a[180:183], v[188:191], v[36:39]
    v_exp_f32 v165, v165
    v_mfma_f32_16x16x32_bf16 v[36:39], a[148:151], v[184:187], v[36:39]
    buffer_load_dwordx4 v225, s[4:7], s24 offen offset:1024 lds
    v_mfma_f32_16x16x32_bf16 v[40:43], a[152:155], v[184:187], v[40:43]
    v_exp_f32 v166, v166
    v_mfma_f32_16x16x32_bf16 v[40:43], a[184:187], v[188:191], v[40:43]
    v_lshlrev_b32 v252, 16, v242
    v_and_b32 v253, s31, v242
    v_mfma_f32_16x16x32_bf16 v[44:47], a[188:191], v[188:191], v[44:47]
    s_add_u32 m0, s32, 73728
    v_exp_f32 v167, v167
    v_mfma_f32_16x16x32_bf16 v[44:47], a[156:159], v[184:187], v[44:47]
    v_cvt_pk_bf16_f32 v178, v164, v165
    v_cvt_pk_bf16_f32 v179, v166, v167
    v_mfma_f32_16x16x32_bf16 v[160:163], a[80:83], a[48:51], v[204:207]
    v_exp_f32 v168, v168
    v_mfma_f32_16x16x32_bf16 v[160:163], a[84:87], a[52:55], v[160:163]
    buffer_load_dwordx4 v226, s[8:11], s24 offen offset:0 lds
    v_mfma_f32_16x16x32_bf16 v[160:163], a[88:91], a[56:59], v[160:163]
    v_exp_f32 v169, v169
    v_mfma_f32_16x16x32_bf16 v[160:163], a[92:95], a[60:63], v[160:163]
    s_waitcnt lgkmcnt(0)
    buffer_store_dwordx4 a[240:243], v228, s[16:19], 0 offen offset:2048 nt
    v_mfma_f32_16x16x32_bf16 v[164:167], a[108:111], a[60:63], v[204:207]
    v_exp_f32 v170, v170
    v_mfma_f32_16x16x32_bf16 v[164:167], a[104:107], a[56:59], v[164:167]
    buffer_load_dwordx4 v227, s[8:11], s24 offen offset:1024 lds
    v_mfma_f32_16x16x32_bf16 v[164:167], a[100:103], a[52:55], v[164:167]
    v_exp_f32 v171, v171
    v_mfma_f32_16x16x32_bf16 v[164:167], a[96:99], a[48:51], v[164:167]
    v_cvt_pk_bf16_f32 v180, v168, v169
    v_cvt_pk_bf16_f32 v181, v170, v171
    v_mfma_f32_16x16x32_bf16 v[48:51], a[192:195], v[188:191], v[48:51]
    v_exp_f32 v172, v172
    v_mfma_f32_16x16x32_bf16 v[48:51], a[160:163], v[184:187], v[48:51]
    s_add_u32 s24, s24, 8192
    v_lshlrev_b32 v254, 16, v243
    v_and_b32 v255, s31, v243
    v_pk_mul_f32 v[248:249], v[248:249], s[84:85]
    v_pk_mul_f32 v[250:251], v[250:251], s[84:85]
    v_pk_mul_f32 v[252:253], v[252:253], s[84:85]
    v_pk_mul_f32 v[254:255], v[254:255], s[84:85]
    v_mfma_f32_16x16x32_bf16 v[52:55], a[164:167], v[184:187], v[52:55]
    v_exp_f32 v173, v173
    v_mfma_f32_16x16x32_bf16 v[52:55], a[196:199], v[188:191], v[52:55]
    v_cvt_pk_bf16_f32 v248, v248, v249
    v_cvt_pk_bf16_f32 v249, v250, v251
    v_mfma_f32_16x16x32_bf16 v[56:59], a[200:203], v[188:191], v[56:59]
    v_exp_f32 v174, v174
    v_mfma_f32_16x16x32_bf16 v[56:59], a[168:171], v[184:187], v[56:59]
    s_add_u32 m0, s32, 0
    v_cvt_pk_bf16_f32 v250, v252, v253
    v_cvt_pk_bf16_f32 v251, v254, v255
    v_mfma_f32_16x16x32_bf16 v[60:63], a[172:175], v[184:187], v[60:63]
    v_exp_f32 v175, v175
    v_mfma_f32_16x16x32_bf16 v[60:63], a[204:207], v[188:191], v[60:63]
    v_cvt_pk_bf16_f32 v182, v172, v173
    v_cvt_pk_bf16_f32 v183, v174, v175
    v_smfmac_f32_16x16x64_bf16 a[212:215], a[248:251], v[184:191], v231
    v_mfma_f32_16x16x32_bf16 v[168:171], a[112:115], a[48:51], v[204:207]
    v_exp_f32 v160, v160
    v_mfma_f32_16x16x32_bf16 v[168:171], a[116:119], a[52:55], v[168:171]
    buffer_load_dwordx4 v224, s[4:7], s24 offen offset:0 lds
    v_mfma_f32_16x16x32_bf16 v[168:171], a[120:123], a[56:59], v[168:171]
    v_exp_f32 v161, v161
    v_mfma_f32_16x16x32_bf16 v[168:171], a[124:127], a[60:63], v[168:171]
    v_mfma_f32_16x16x32_bf16 v[172:175], a[140:143], a[60:63], v[204:207]
    v_exp_f32 v162, v162
    v_mfma_f32_16x16x32_bf16 v[172:175], a[136:139], a[56:59], v[172:175]
    v_mfma_f32_16x16x32_bf16 v[172:175], a[132:135], a[52:55], v[172:175]
    v_exp_f32 v163, v163
    v_mfma_f32_16x16x32_bf16 v[172:175], a[128:131], a[48:51], v[172:175]
    v_cvt_pk_bf16_f32 v184, v160, v161
    v_cvt_pk_bf16_f32 v185, v162, v163
    v_mfma_f32_16x16x32_bf16 v[64:67], a[144:147], v[176:179], v[64:67]
    v_exp_f32 v164, v164
    v_mfma_f32_16x16x32_bf16 v[64:67], a[176:179], v[180:183], v[64:67]
    buffer_load_dwordx4 v225, s[4:7], s24 offen offset:1024 lds
    v_mfma_f32_16x16x32_bf16 v[68:71], a[180:183], v[180:183], v[68:71]
    s_add_u32 m0, s32, 40960
    v_exp_f32 v165, v165
    v_mfma_f32_16x16x32_bf16 v[68:71], a[148:151], v[176:179], v[68:71]
    ds_write_b128 v229, v[248:251] offset:2048
    v_mfma_f32_16x16x32_bf16 v[72:75], a[152:155], v[176:179], v[72:75]
    v_exp_f32 v166, v166
    v_mfma_f32_16x16x32_bf16 v[72:75], a[184:187], v[180:183], v[72:75]
    buffer_load_dwordx4 v[240:243], v228, s[12:15], s26 offen offset:2048 nt
    v_mfma_f32_16x16x32_bf16 v[76:79], a[188:191], v[180:183], v[76:79]
    v_exp_f32 v167, v167
    v_mfma_f32_16x16x32_bf16 v[76:79], a[156:159], v[176:179], v[76:79]
    v_cvt_pk_bf16_f32 v186, v164, v165
    v_cvt_pk_bf16_f32 v187, v166, v167
    v_mfma_f32_16x16x32_bf16 v[160:163], a[80:83], a[64:67], v[208:211]
    v_exp_f32 v168, v168
    v_mfma_f32_16x16x32_bf16 v[160:163], a[84:87], a[68:71], v[160:163]
    buffer_load_dwordx4 v226, s[8:11], s24 offen offset:0 lds
    v_mfma_f32_16x16x32_bf16 v[160:163], a[88:91], a[72:75], v[160:163]
    v_exp_f32 v169, v169
    v_mfma_f32_16x16x32_bf16 v[160:163], a[92:95], a[76:79], v[160:163]
    v_xor_b32 v229, 192, v230
    v_lshlrev_b32 v248, 16, v244
    v_mfma_f32_16x16x32_bf16 v[164:167], a[108:111], a[76:79], v[208:211]
    v_exp_f32 v170, v170
    v_mfma_f32_16x16x32_bf16 v[164:167], a[104:107], a[72:75], v[164:167]
    buffer_load_dwordx4 v227, s[8:11], s24 offen offset:1024 lds
    v_mfma_f32_16x16x32_bf16 v[164:167], a[100:103], a[68:71], v[164:167]
    v_exp_f32 v171, v171
    v_mfma_f32_16x16x32_bf16 v[164:167], a[96:99], a[64:67], v[164:167]
    v_cvt_pk_bf16_f32 v188, v168, v169
    v_cvt_pk_bf16_f32 v189, v170, v171
    v_mfma_f32_16x16x32_bf16 v[80:83], a[192:195], v[180:183], v[80:83]
    v_exp_f32 v172, v172
    v_mfma_f32_16x16x32_bf16 v[80:83], a[160:163], v[176:179], v[80:83]
    ds_read_b128 a[80:83], v212 offset:8192
    ds_read_b128 a[244:247], v229 offset:3072
    v_mfma_f32_16x16x32_bf16 v[84:87], a[164:167], v[176:179], v[84:87]
    v_exp_f32 v173, v173
    v_mfma_f32_16x16x32_bf16 v[84:87], a[196:199], v[180:183], v[84:87]
    ds_read_b128 a[84:87], v213 offset:8192
    v_and_b32 v249, s31, v244
    v_mfma_f32_16x16x32_bf16 v[88:91], a[200:203], v[180:183], v[88:91]
    v_exp_f32 v174, v174
    v_mfma_f32_16x16x32_bf16 v[88:91], a[168:171], v[176:179], v[88:91]
    ds_read_b128 a[88:91], v214 offset:8192
    v_lshlrev_b32 v250, 16, v245
    v_mfma_f32_16x16x32_bf16 v[92:95], a[172:175], v[176:179], v[92:95]
    v_exp_f32 v175, v175
    v_mfma_f32_16x16x32_bf16 v[92:95], a[204:207], v[180:183], v[92:95]
    v_cvt_pk_bf16_f32 v190, v172, v173
    v_cvt_pk_bf16_f32 v191, v174, v175
    v_smfmac_f32_16x16x64_bf16 a[216:219], a[248:251], v[176:183], v231
    ds_read_b128 a[92:95], v215 offset:8192
    v_mfma_f32_16x16x32_bf16 v[168:171], a[112:115], a[64:67], v[208:211]
    v_exp_f32 v160, v160
    v_mfma_f32_16x16x32_bf16 v[168:171], a[116:119], a[68:71], v[168:171]
    ds_read_b128 a[96:99], v212 offset:12288
    v_and_b32 v251, s31, v245
    v_mfma_f32_16x16x32_bf16 v[168:171], a[120:123], a[72:75], v[168:171]
    v_exp_f32 v161, v161
    v_mfma_f32_16x16x32_bf16 v[168:171], a[124:127], a[76:79], v[168:171]
    ds_read_b128 a[100:103], v213 offset:12288
    v_lshlrev_b32 v252, 16, v246
    v_mfma_f32_16x16x32_bf16 v[172:175], a[140:143], a[76:79], v[208:211]
    v_exp_f32 v162, v162
    v_mfma_f32_16x16x32_bf16 v[172:175], a[136:139], a[72:75], v[172:175]
    ds_read_b128 a[104:107], v214 offset:12288
    v_and_b32 v253, s31, v246
    v_mfma_f32_16x16x32_bf16 v[172:175], a[132:135], a[68:71], v[172:175]
    v_exp_f32 v163, v163
    v_mfma_f32_16x16x32_bf16 v[172:175], a[128:131], a[64:67], v[172:175]
    v_cvt_pk_bf16_f32 v176, v160, v161
    v_cvt_pk_bf16_f32 v177, v162, v163
    v_mfma_f32_16x16x32_bf16 v[96:99], a[144:147], v[184:187], v[96:99]
    v_exp_f32 v164, v164
    v_mfma_f32_16x16x32_bf16 v[96:99], a[176:179], v[188:191], v[96:99]
    ds_read_b128 a[108:111], v215 offset:12288
    ds_read_b128 a[112:115], v212 offset:16384
    v_mfma_f32_16x16x32_bf16 v[100:103], a[180:183], v[188:191], v[100:103]
    v_exp_f32 v165, v165
    v_mfma_f32_16x16x32_bf16 v[100:103], a[148:151], v[184:187], v[100:103]
    ds_read_b128 a[116:119], v213 offset:16384
    v_lshlrev_b32 v254, 16, v247
    v_mfma_f32_16x16x32_bf16 v[104:107], a[152:155], v[184:187], v[104:107]
    v_exp_f32 v166, v166
    v_mfma_f32_16x16x32_bf16 v[104:107], a[184:187], v[188:191], v[104:107]
    ds_read_b128 a[120:123], v214 offset:16384
    v_and_b32 v255, s31, v247
    v_pk_mul_f32 v[248:249], v[248:249], s[84:85]
    v_pk_mul_f32 v[250:251], v[250:251], s[84:85]
    v_pk_mul_f32 v[252:253], v[252:253], s[84:85]
    v_pk_mul_f32 v[254:255], v[254:255], s[84:85]
    v_mfma_f32_16x16x32_bf16 v[108:111], a[188:191], v[188:191], v[108:111]
    v_exp_f32 v167, v167
    v_mfma_f32_16x16x32_bf16 v[108:111], a[156:159], v[184:187], v[108:111]
    s_waitcnt lgkmcnt(3)
    v_cvt_pk_bf16_f32 v178, v164, v165
    v_cvt_pk_bf16_f32 v179, v166, v167
    v_mfma_f32_16x16x32_bf16 v[160:163], a[80:83], a[0:3], v[192:195]
    v_exp_f32 v168, v168
    v_mfma_f32_16x16x32_bf16 v[160:163], a[84:87], a[4:7], v[160:163]
    ds_read_b128 a[124:127], v215 offset:16384
    ds_read_b128 a[128:131], v212 offset:20480
    v_mfma_f32_16x16x32_bf16 v[160:163], a[88:91], a[8:11], v[160:163]
    v_exp_f32 v169, v169
    v_mfma_f32_16x16x32_bf16 v[160:163], a[92:95], a[12:15], v[160:163]
    ds_read_b128 a[132:135], v213 offset:20480
    v_cvt_pk_bf16_f32 v248, v248, v249
    v_cvt_pk_bf16_f32 v249, v250, v251
    v_mfma_f32_16x16x32_bf16 v[164:167], a[108:111], a[12:15], v[192:195]
    v_exp_f32 v170, v170
    v_cvt_pk_bf16_f32 v250, v252, v253
    v_mfma_f32_16x16x32_bf16 v[164:167], a[104:107], a[8:11], v[164:167]
    buffer_store_dwordx4 a[244:247], v228, s[16:19], 0 offen offset:3072 nt
    v_cvt_pk_bf16_f32 v251, v254, v255
    v_mfma_f32_16x16x32_bf16 v[164:167], a[100:103], a[4:7], v[164:167]
    v_exp_f32 v171, v171
    v_mfma_f32_16x16x32_bf16 v[164:167], a[96:99], a[0:3], v[164:167]
    v_cvt_pk_bf16_f32 v180, v168, v169
    v_cvt_pk_bf16_f32 v181, v170, v171
    v_mfma_f32_16x16x32_bf16 v[112:115], a[192:195], v[188:191], v[112:115]
    v_exp_f32 v172, v172
    v_mfma_f32_16x16x32_bf16 v[112:115], a[160:163], v[184:187], v[112:115]
    ds_read_b128 a[136:139], v214 offset:20480
    ds_read_b128 a[140:143], v215 offset:20480
    v_mfma_f32_16x16x32_bf16 v[116:119], a[164:167], v[184:187], v[116:119]
    v_exp_f32 v173, v173
    v_mfma_f32_16x16x32_bf16 v[116:119], a[196:199], v[188:191], v[116:119]
    ds_write_b128 v229, v[248:251] offset:3072
    v_mfma_f32_16x16x32_bf16 v[120:123], a[200:203], v[188:191], v[120:123]
    v_exp_f32 v174, v174
    v_mfma_f32_16x16x32_bf16 v[120:123], a[168:171], v[184:187], v[120:123]
    buffer_load_dwordx4 v[244:247], v228, s[12:15], s26 offen offset:3072 nt
    v_mfma_f32_16x16x32_bf16 v[124:127], a[172:175], v[184:187], v[124:127]
    v_exp_f32 v175, v175
    v_mfma_f32_16x16x32_bf16 v[124:127], a[204:207], v[188:191], v[124:127]
    v_cvt_pk_bf16_f32 v182, v172, v173
    v_cvt_pk_bf16_f32 v183, v174, v175
    v_smfmac_f32_16x16x64_bf16 a[220:223], a[248:251], v[184:191], v231
    s_waitcnt lgkmcnt(1)
    v_mfma_f32_16x16x32_bf16 v[168:171], a[112:115], a[0:3], v[192:195]
    v_exp_f32 v160, v160
    v_mfma_f32_16x16x32_bf16 v[168:171], a[116:119], a[4:7], v[168:171]
    v_mfma_f32_16x16x32_bf16 v[168:171], a[120:123], a[8:11], v[168:171]
    v_exp_f32 v161, v161
    v_mfma_f32_16x16x32_bf16 v[168:171], a[124:127], a[12:15], v[168:171]
    s_waitcnt vmcnt(14)
    ds_read_b128 a[232:235], v230 offset:4096
    v_lshlrev_b32 v248, 16, v232
    v_mfma_f32_16x16x32_bf16 v[172:175], a[140:143], a[12:15], v[192:195]
    v_exp_f32 v162, v162
    v_mfma_f32_16x16x32_bf16 v[172:175], a[136:139], a[8:11], v[172:175]
    v_and_b32 v249, s31, v232
    v_lshlrev_b32 v250, 16, v233
    v_mfma_f32_16x16x32_bf16 v[172:175], a[132:135], a[4:7], v[172:175]
    v_exp_f32 v163, v163
    v_mfma_f32_16x16x32_bf16 v[172:175], a[128:131], a[0:3], v[172:175]
    v_cvt_pk_bf16_f32 v184, v160, v161
    v_cvt_pk_bf16_f32 v185, v162, v163
    v_mfma_f32_16x16x32_bf16 v[128:131], a[144:147], v[176:179], v[128:131]
    v_exp_f32 v164, v164
    v_mfma_f32_16x16x32_bf16 v[128:131], a[176:179], v[180:183], v[128:131]
    ds_read_b64_tr_b16 a[144:145], v216 offset:8192
    ds_read_b64_tr_b16 a[146:147], v216 offset:12288
    v_mfma_f32_16x16x32_bf16 v[132:135], a[180:183], v[180:183], v[132:135]
    v_exp_f32 v165, v165
    v_mfma_f32_16x16x32_bf16 v[132:135], a[148:151], v[176:179], v[132:135]
    ds_read_b64_tr_b16 a[176:177], v216 offset:16384
    ds_read_b64_tr_b16 a[178:179], v216 offset:20480
    v_mfma_f32_16x16x32_bf16 v[136:139], a[152:155], v[176:179], v[136:139]
    v_exp_f32 v166, v166
    v_mfma_f32_16x16x32_bf16 v[136:139], a[184:187], v[180:183], v[136:139]
    ds_read_b64_tr_b16 a[180:181], v217 offset:16384
    ds_read_b64_tr_b16 a[182:183], v217 offset:20480
    v_mfma_f32_16x16x32_bf16 v[140:143], a[188:191], v[180:183], v[140:143]
    v_exp_f32 v167, v167
    v_mfma_f32_16x16x32_bf16 v[140:143], a[156:159], v[176:179], v[140:143]
    s_waitcnt lgkmcnt(6)
    buffer_store_dwordx4 a[232:235], v228, s[16:19], s26 offen offset:0 nt
    v_cvt_pk_bf16_f32 v186, v164, v165
    v_cvt_pk_bf16_f32 v187, v166, v167
    v_mfma_f32_16x16x32_bf16 v[160:163], a[80:83], a[16:19], v[196:199]
    v_exp_f32 v168, v168
    v_mfma_f32_16x16x32_bf16 v[160:163], a[84:87], a[20:23], v[160:163]
    ds_read_b64_tr_b16 a[148:149], v217 offset:8192
    ds_read_b64_tr_b16 a[150:151], v217 offset:12288
    v_mfma_f32_16x16x32_bf16 v[160:163], a[88:91], a[24:27], v[160:163]
    v_exp_f32 v169, v169
    v_mfma_f32_16x16x32_bf16 v[160:163], a[92:95], a[28:31], v[160:163]
    ds_read_b64_tr_b16 a[152:153], v218 offset:8192
    ds_read_b64_tr_b16 a[154:155], v218 offset:12288
    v_mfma_f32_16x16x32_bf16 v[164:167], a[108:111], a[28:31], v[196:199]
    v_exp_f32 v170, v170
    v_mfma_f32_16x16x32_bf16 v[164:167], a[104:107], a[24:27], v[164:167]
    ds_read_b64_tr_b16 a[184:185], v218 offset:16384
    ds_read_b64_tr_b16 a[186:187], v218 offset:20480
    v_mfma_f32_16x16x32_bf16 v[164:167], a[100:103], a[20:23], v[164:167]
    v_exp_f32 v171, v171
    v_mfma_f32_16x16x32_bf16 v[164:167], a[96:99], a[16:19], v[164:167]
    v_cvt_pk_bf16_f32 v188, v168, v169
    v_cvt_pk_bf16_f32 v189, v170, v171
    v_mfma_f32_16x16x32_bf16 v[144:147], a[192:195], v[180:183], v[144:147]
    v_exp_f32 v172, v172
    v_mfma_f32_16x16x32_bf16 v[144:147], a[160:163], v[176:179], v[144:147]
    ds_read_b64_tr_b16 a[188:189], v219 offset:16384
    ds_read_b64_tr_b16 a[190:191], v219 offset:20480
    v_mfma_f32_16x16x32_bf16 v[148:151], a[164:167], v[176:179], v[148:151]
    v_exp_f32 v173, v173
    v_mfma_f32_16x16x32_bf16 v[148:151], a[196:199], v[180:183], v[148:151]
    ds_read_b64_tr_b16 a[156:157], v219 offset:8192
    ds_read_b64_tr_b16 a[158:159], v219 offset:12288
    v_mfma_f32_16x16x32_bf16 v[152:155], a[200:203], v[180:183], v[152:155]
    v_exp_f32 v174, v174
    v_mfma_f32_16x16x32_bf16 v[152:155], a[168:171], v[176:179], v[152:155]
    ds_read_b64_tr_b16 a[192:193], v220 offset:16384
    ds_read_b64_tr_b16 a[194:195], v220 offset:20480
    v_mfma_f32_16x16x32_bf16 v[156:159], a[172:175], v[176:179], v[156:159]
    v_exp_f32 v175, v175
    v_mfma_f32_16x16x32_bf16 v[156:159], a[204:207], v[180:183], v[156:159]
    v_cvt_pk_bf16_f32 v190, v172, v173
    v_cvt_pk_bf16_f32 v191, v174, v175
    v_smfmac_f32_16x16x64_bf16 a[224:227], a[248:251], v[176:183], v231
    ds_read_b64_tr_b16 a[160:161], v220 offset:8192
    v_mfma_f32_16x16x32_bf16 v[168:171], a[112:115], a[16:19], v[196:199]
    v_exp_f32 v160, v160
    v_mfma_f32_16x16x32_bf16 v[168:171], a[116:119], a[20:23], v[168:171]
    ds_read_b64_tr_b16 a[162:163], v220 offset:12288
    ds_read_b64_tr_b16 a[164:165], v221 offset:8192
    v_mfma_f32_16x16x32_bf16 v[168:171], a[120:123], a[24:27], v[168:171]
    v_exp_f32 v161, v161
    v_mfma_f32_16x16x32_bf16 v[168:171], a[124:127], a[28:31], v[168:171]
    ds_read_b64_tr_b16 a[166:167], v221 offset:12288
    ds_read_b64_tr_b16 a[196:197], v221 offset:16384
    v_mfma_f32_16x16x32_bf16 v[172:175], a[140:143], a[28:31], v[196:199]
    v_exp_f32 v162, v162
    v_mfma_f32_16x16x32_bf16 v[172:175], a[136:139], a[24:27], v[172:175]
    ds_read_b64_tr_b16 a[198:199], v221 offset:20480
    ds_read_b64_tr_b16 a[200:201], v222 offset:16384
    v_mfma_f32_16x16x32_bf16 v[172:175], a[132:135], a[20:23], v[172:175]
    v_exp_f32 v163, v163
    v_mfma_f32_16x16x32_bf16 v[172:175], a[128:131], a[16:19], v[172:175]
    s_waitcnt lgkmcnt(14)
    v_cvt_pk_bf16_f32 v176, v160, v161
    v_cvt_pk_bf16_f32 v177, v162, v163
    v_mfma_f32_16x16x32_bf16 v[0:3], a[144:147], v[184:187], v[0:3]
    v_exp_f32 v164, v164
    v_mfma_f32_16x16x32_bf16 v[0:3], a[176:179], v[188:191], v[0:3]
    ds_read_b64_tr_b16 a[202:203], v222 offset:20480
    ds_read_b64_tr_b16 a[168:169], v222 offset:8192
    v_mfma_f32_16x16x32_bf16 v[4:7], a[180:183], v[188:191], v[4:7]
    s_waitcnt lgkmcnt(14)
    v_exp_f32 v165, v165
    v_mfma_f32_16x16x32_bf16 v[4:7], a[148:151], v[184:187], v[4:7]
    ds_read_b64_tr_b16 a[170:171], v222 offset:12288
    ds_read_b64_tr_b16 a[172:173], v223 offset:8192
    v_mfma_f32_16x16x32_bf16 v[8:11], a[152:155], v[184:187], v[8:11]
    s_waitcnt lgkmcnt(14)
    v_exp_f32 v166, v166
    v_mfma_f32_16x16x32_bf16 v[8:11], a[184:187], v[188:191], v[8:11]
    ds_read_b64_tr_b16 a[174:175], v223 offset:12288
    ds_read_b64_tr_b16 a[204:205], v223 offset:16384
    v_mfma_f32_16x16x32_bf16 v[12:15], a[188:191], v[188:191], v[12:15]
    s_waitcnt lgkmcnt(14)
    v_exp_f32 v167, v167
    v_mfma_f32_16x16x32_bf16 v[12:15], a[156:159], v[184:187], v[12:15]
    v_cvt_pk_bf16_f32 v178, v164, v165
    v_cvt_pk_bf16_f32 v179, v166, v167
    v_mfma_f32_16x16x32_bf16 v[160:163], a[80:83], a[32:35], v[200:203]
    v_exp_f32 v168, v168
    v_mfma_f32_16x16x32_bf16 v[160:163], a[84:87], a[36:39], v[160:163]
    ds_read_b64_tr_b16 a[206:207], v223 offset:20480
    v_and_b32 v251, s31, v233
    v_mfma_f32_16x16x32_bf16 v[160:163], a[88:91], a[40:43], v[160:163]
    v_exp_f32 v169, v169
    v_mfma_f32_16x16x32_bf16 v[160:163], a[92:95], a[44:47], v[160:163]
    v_lshlrev_b32 v252, 16, v234
    v_and_b32 v253, s31, v234
    v_mfma_f32_16x16x32_bf16 v[164:167], a[108:111], a[44:47], v[200:203]
    v_exp_f32 v170, v170
    v_mfma_f32_16x16x32_bf16 v[164:167], a[104:107], a[40:43], v[164:167]
    v_lshlrev_b32 v254, 16, v235
    v_and_b32 v255, s31, v235
    v_pk_mul_f32 v[248:249], v[248:249], s[84:85]
    v_pk_mul_f32 v[250:251], v[250:251], s[84:85]
    v_pk_mul_f32 v[252:253], v[252:253], s[84:85]
    v_pk_mul_f32 v[254:255], v[254:255], s[84:85]
    v_mfma_f32_16x16x32_bf16 v[164:167], a[100:103], a[36:39], v[164:167]
    v_exp_f32 v171, v171
    v_mfma_f32_16x16x32_bf16 v[164:167], a[96:99], a[32:35], v[164:167]
    s_waitcnt lgkmcnt(14)
    v_cvt_pk_bf16_f32 v180, v168, v169
    v_cvt_pk_bf16_f32 v181, v170, v171
    v_mfma_f32_16x16x32_bf16 v[16:19], a[192:195], v[188:191], v[16:19]
    s_waitcnt lgkmcnt(12)
    v_exp_f32 v172, v172
    v_mfma_f32_16x16x32_bf16 v[16:19], a[160:163], v[184:187], v[16:19]
    s_waitcnt lgkmcnt(10)
    v_cvt_pk_bf16_f32 v248, v248, v249
    v_cvt_pk_bf16_f32 v249, v250, v251
    v_mfma_f32_16x16x32_bf16 v[20:23], a[164:167], v[184:187], v[20:23]
    s_waitcnt lgkmcnt(8)
    v_exp_f32 v173, v173
    v_mfma_f32_16x16x32_bf16 v[20:23], a[196:199], v[188:191], v[20:23]
    s_waitcnt lgkmcnt(6)
    v_cvt_pk_bf16_f32 v250, v252, v253
    v_cvt_pk_bf16_f32 v251, v254, v255
    v_mfma_f32_16x16x32_bf16 v[24:27], a[200:203], v[188:191], v[24:27]
    s_waitcnt lgkmcnt(4)
    v_exp_f32 v174, v174
    v_mfma_f32_16x16x32_bf16 v[24:27], a[168:171], v[184:187], v[24:27]
    s_waitcnt lgkmcnt(2)
    v_mfma_f32_16x16x32_bf16 v[28:31], a[172:175], v[184:187], v[28:31]
    s_waitcnt lgkmcnt(0)
    v_exp_f32 v175, v175
    v_mfma_f32_16x16x32_bf16 v[28:31], a[204:207], v[188:191], v[28:31]
    v_cvt_pk_bf16_f32 v182, v172, v173
    v_cvt_pk_bf16_f32 v183, v174, v175
    v_smfmac_f32_16x16x64_bf16 a[208:211], a[248:251], v[184:191], v231
    s_waitcnt vmcnt(8)
    s_barrier
    v_mfma_f32_16x16x32_bf16 v[168:171], a[112:115], a[32:35], v[200:203]
    s_add_u32 s24, s24, 8192
    v_exp_f32 v160, v160
    v_mfma_f32_16x16x32_bf16 v[168:171], a[116:119], a[36:39], v[168:171]
    v_mfma_f32_16x16x32_bf16 v[168:171], a[120:123], a[40:43], v[168:171]
    v_exp_f32 v161, v161
    v_mfma_f32_16x16x32_bf16 v[168:171], a[124:127], a[44:47], v[168:171]
    s_add_u32 m0, s32, 8192
    v_mfma_f32_16x16x32_bf16 v[172:175], a[140:143], a[44:47], v[200:203]
    v_exp_f32 v162, v162
    v_mfma_f32_16x16x32_bf16 v[172:175], a[136:139], a[40:43], v[172:175]
    v_mfma_f32_16x16x32_bf16 v[172:175], a[132:135], a[36:39], v[172:175]
    v_exp_f32 v163, v163
    v_mfma_f32_16x16x32_bf16 v[172:175], a[128:131], a[32:35], v[172:175]
    v_cvt_pk_bf16_f32 v184, v160, v161
    v_cvt_pk_bf16_f32 v185, v162, v163
    v_mfma_f32_16x16x32_bf16 v[32:35], a[144:147], v[176:179], v[32:35]
    v_exp_f32 v164, v164
    v_mfma_f32_16x16x32_bf16 v[32:35], a[176:179], v[180:183], v[32:35]
    buffer_load_dwordx4 v224, s[4:7], s24 offen offset:0 lds
    v_mfma_f32_16x16x32_bf16 v[36:39], a[180:183], v[180:183], v[36:39]
    v_exp_f32 v165, v165
    v_mfma_f32_16x16x32_bf16 v[36:39], a[148:151], v[176:179], v[36:39]
    buffer_load_dwordx4 v225, s[4:7], s24 offen offset:1024 lds
    v_mfma_f32_16x16x32_bf16 v[40:43], a[152:155], v[176:179], v[40:43]
    v_exp_f32 v166, v166
    v_mfma_f32_16x16x32_bf16 v[40:43], a[184:187], v[180:183], v[40:43]
    ds_write_b128 v230, v[248:251] offset:4096
    v_mfma_f32_16x16x32_bf16 v[44:47], a[188:191], v[180:183], v[44:47]
    s_add_u32 m0, s32, 49152
    v_exp_f32 v167, v167
    v_mfma_f32_16x16x32_bf16 v[44:47], a[156:159], v[176:179], v[44:47]
    v_cvt_pk_bf16_f32 v186, v164, v165
    v_cvt_pk_bf16_f32 v187, v166, v167
    v_mfma_f32_16x16x32_bf16 v[160:163], a[80:83], a[48:51], v[204:207]
    v_exp_f32 v168, v168
    v_mfma_f32_16x16x32_bf16 v[160:163], a[84:87], a[52:55], v[160:163]
    buffer_load_dwordx4 v226, s[8:11], s24 offen offset:0 lds
    v_mfma_f32_16x16x32_bf16 v[160:163], a[88:91], a[56:59], v[160:163]
    v_exp_f32 v169, v169
    v_mfma_f32_16x16x32_bf16 v[160:163], a[92:95], a[60:63], v[160:163]
    buffer_load_dwordx4 v[232:235], v228, s[12:15], s27 offen offset:0 nt
    v_mfma_f32_16x16x32_bf16 v[164:167], a[108:111], a[60:63], v[204:207]
    v_exp_f32 v170, v170
    v_mfma_f32_16x16x32_bf16 v[164:167], a[104:107], a[56:59], v[164:167]
    buffer_load_dwordx4 v227, s[8:11], s24 offen offset:1024 lds
    v_mfma_f32_16x16x32_bf16 v[164:167], a[100:103], a[52:55], v[164:167]
    v_exp_f32 v171, v171
    v_mfma_f32_16x16x32_bf16 v[164:167], a[96:99], a[48:51], v[164:167]
    v_cvt_pk_bf16_f32 v188, v168, v169
    v_cvt_pk_bf16_f32 v189, v170, v171
    v_mfma_f32_16x16x32_bf16 v[48:51], a[192:195], v[180:183], v[48:51]
    v_exp_f32 v172, v172
    v_mfma_f32_16x16x32_bf16 v[48:51], a[160:163], v[176:179], v[48:51]
    s_add_u32 s24, s24, 8192
    v_xor_b32 v229, 64, v230
    v_lshlrev_b32 v248, 16, v236
    v_mfma_f32_16x16x32_bf16 v[52:55], a[164:167], v[176:179], v[52:55]
    v_exp_f32 v173, v173
    v_mfma_f32_16x16x32_bf16 v[52:55], a[196:199], v[180:183], v[52:55]
    ds_read_b128 a[236:239], v229 offset:5120
    v_and_b32 v249, s31, v236
    v_mfma_f32_16x16x32_bf16 v[56:59], a[200:203], v[180:183], v[56:59]
    v_exp_f32 v174, v174
    v_mfma_f32_16x16x32_bf16 v[56:59], a[168:171], v[176:179], v[56:59]
    s_add_u32 m0, s32, 16384
    v_lshlrev_b32 v250, 16, v237
    v_and_b32 v251, s31, v237
    v_mfma_f32_16x16x32_bf16 v[60:63], a[172:175], v[176:179], v[60:63]
    v_exp_f32 v175, v175
    v_mfma_f32_16x16x32_bf16 v[60:63], a[204:207], v[180:183], v[60:63]
    v_cvt_pk_bf16_f32 v190, v172, v173
    v_cvt_pk_bf16_f32 v191, v174, v175
    v_smfmac_f32_16x16x64_bf16 a[212:215], a[248:251], v[176:183], v231
    v_lshlrev_b32 v252, 16, v238
    v_mfma_f32_16x16x32_bf16 v[168:171], a[112:115], a[48:51], v[204:207]
    v_exp_f32 v160, v160
    v_mfma_f32_16x16x32_bf16 v[168:171], a[116:119], a[52:55], v[168:171]
    buffer_load_dwordx4 v224, s[4:7], s24 offen offset:0 lds
    v_mfma_f32_16x16x32_bf16 v[168:171], a[120:123], a[56:59], v[168:171]
    v_exp_f32 v161, v161
    v_mfma_f32_16x16x32_bf16 v[168:171], a[124:127], a[60:63], v[168:171]
    v_and_b32 v253, s31, v238
    v_lshlrev_b32 v254, 16, v239
    v_mfma_f32_16x16x32_bf16 v[172:175], a[140:143], a[60:63], v[204:207]
    v_exp_f32 v162, v162
    v_mfma_f32_16x16x32_bf16 v[172:175], a[136:139], a[56:59], v[172:175]
    v_and_b32 v255, s31, v239
    v_mfma_f32_16x16x32_bf16 v[172:175], a[132:135], a[52:55], v[172:175]
    v_exp_f32 v163, v163
    v_pk_mul_f32 v[248:249], v[248:249], s[84:85]
    v_pk_mul_f32 v[250:251], v[250:251], s[84:85]
    v_pk_mul_f32 v[252:253], v[252:253], s[84:85]
    v_pk_mul_f32 v[254:255], v[254:255], s[84:85]
    v_mfma_f32_16x16x32_bf16 v[172:175], a[128:131], a[48:51], v[172:175]
    v_cvt_pk_bf16_f32 v176, v160, v161
    v_cvt_pk_bf16_f32 v177, v162, v163
    v_mfma_f32_16x16x32_bf16 v[64:67], a[144:147], v[184:187], v[64:67]
    v_exp_f32 v164, v164
    v_mfma_f32_16x16x32_bf16 v[64:67], a[176:179], v[188:191], v[64:67]
    buffer_load_dwordx4 v225, s[4:7], s24 offen offset:1024 lds
    v_mfma_f32_16x16x32_bf16 v[68:71], a[180:183], v[188:191], v[68:71]
    s_add_u32 m0, s32, 57344
    v_exp_f32 v165, v165
    v_mfma_f32_16x16x32_bf16 v[68:71], a[148:151], v[184:187], v[68:71]
    s_waitcnt lgkmcnt(0)
    buffer_store_dwordx4 a[236:239], v228, s[16:19], s26 offen offset:1024 nt
    v_mfma_f32_16x16x32_bf16 v[72:75], a[152:155], v[184:187], v[72:75]
    v_exp_f32 v166, v166
    v_mfma_f32_16x16x32_bf16 v[72:75], a[184:187], v[188:191], v[72:75]
    v_cvt_pk_bf16_f32 v248, v248, v249
    v_cvt_pk_bf16_f32 v249, v250, v251
    v_mfma_f32_16x16x32_bf16 v[76:79], a[188:191], v[188:191], v[76:79]
    v_exp_f32 v167, v167
    v_mfma_f32_16x16x32_bf16 v[76:79], a[156:159], v[184:187], v[76:79]
    v_cvt_pk_bf16_f32 v178, v164, v165
    v_cvt_pk_bf16_f32 v179, v166, v167
    v_mfma_f32_16x16x32_bf16 v[160:163], a[80:83], a[64:67], v[208:211]
    v_exp_f32 v168, v168
    v_mfma_f32_16x16x32_bf16 v[160:163], a[84:87], a[68:71], v[160:163]
    buffer_load_dwordx4 v226, s[8:11], s24 offen offset:0 lds
    v_mfma_f32_16x16x32_bf16 v[160:163], a[88:91], a[72:75], v[160:163]
    v_exp_f32 v169, v169
    v_mfma_f32_16x16x32_bf16 v[160:163], a[92:95], a[76:79], v[160:163]
    v_cvt_pk_bf16_f32 v250, v252, v253
    v_cvt_pk_bf16_f32 v251, v254, v255
    v_mfma_f32_16x16x32_bf16 v[164:167], a[108:111], a[76:79], v[208:211]
    v_exp_f32 v170, v170
    v_mfma_f32_16x16x32_bf16 v[164:167], a[104:107], a[72:75], v[164:167]
    buffer_load_dwordx4 v227, s[8:11], s24 offen offset:1024 lds
    v_mfma_f32_16x16x32_bf16 v[164:167], a[100:103], a[68:71], v[164:167]
    v_exp_f32 v171, v171
    v_mfma_f32_16x16x32_bf16 v[164:167], a[96:99], a[64:67], v[164:167]
    v_cvt_pk_bf16_f32 v180, v168, v169
    v_cvt_pk_bf16_f32 v181, v170, v171
    v_mfma_f32_16x16x32_bf16 v[80:83], a[192:195], v[188:191], v[80:83]
    v_exp_f32 v172, v172
    v_mfma_f32_16x16x32_bf16 v[80:83], a[160:163], v[184:187], v[80:83]
    ds_read_b128 a[80:83], v212 offset:24576
    ds_write_b128 v229, v[248:251] offset:5120
    v_mfma_f32_16x16x32_bf16 v[84:87], a[164:167], v[184:187], v[84:87]
    v_exp_f32 v173, v173
    v_mfma_f32_16x16x32_bf16 v[84:87], a[196:199], v[188:191], v[84:87]
    ds_read_b128 a[84:87], v213 offset:24576
    v_mfma_f32_16x16x32_bf16 v[88:91], a[200:203], v[188:191], v[88:91]
    v_exp_f32 v174, v174
    v_mfma_f32_16x16x32_bf16 v[88:91], a[168:171], v[184:187], v[88:91]
    ds_read_b128 a[88:91], v214 offset:24576
    v_mfma_f32_16x16x32_bf16 v[92:95], a[172:175], v[184:187], v[92:95]
    v_exp_f32 v175, v175
    v_mfma_f32_16x16x32_bf16 v[92:95], a[204:207], v[188:191], v[92:95]
    v_cvt_pk_bf16_f32 v182, v172, v173
    v_cvt_pk_bf16_f32 v183, v174, v175
    v_smfmac_f32_16x16x64_bf16 a[216:219], a[248:251], v[184:191], v231
    ds_read_b128 a[92:95], v215 offset:24576
    v_mfma_f32_16x16x32_bf16 v[168:171], a[112:115], a[64:67], v[208:211]
    v_exp_f32 v160, v160
    v_mfma_f32_16x16x32_bf16 v[168:171], a[116:119], a[68:71], v[168:171]
    ds_read_b128 a[96:99], v212 offset:28672
    v_mfma_f32_16x16x32_bf16 v[168:171], a[120:123], a[72:75], v[168:171]
    v_exp_f32 v161, v161
    v_mfma_f32_16x16x32_bf16 v[168:171], a[124:127], a[76:79], v[168:171]
    s_waitcnt vmcnt(15)
    ds_read_b128 a[100:103], v213 offset:28672
    v_xor_b32 v229, 128, v230
    v_mfma_f32_16x16x32_bf16 v[172:175], a[140:143], a[76:79], v[208:211]
    v_exp_f32 v162, v162
    v_mfma_f32_16x16x32_bf16 v[172:175], a[136:139], a[72:75], v[172:175]
    ds_read_b128 a[104:107], v214 offset:28672
    ds_read_b128 a[240:243], v229 offset:6144
    v_mfma_f32_16x16x32_bf16 v[172:175], a[132:135], a[68:71], v[172:175]
    v_exp_f32 v163, v163
    v_mfma_f32_16x16x32_bf16 v[172:175], a[128:131], a[64:67], v[172:175]
    v_cvt_pk_bf16_f32 v184, v160, v161
    v_cvt_pk_bf16_f32 v185, v162, v163
    v_mfma_f32_16x16x32_bf16 v[96:99], a[144:147], v[176:179], v[96:99]
    v_exp_f32 v164, v164
    v_mfma_f32_16x16x32_bf16 v[96:99], a[176:179], v[180:183], v[96:99]
    ds_read_b128 a[108:111], v215 offset:28672
    ds_read_b128 a[112:115], v212 offset:32768
    v_mfma_f32_16x16x32_bf16 v[100:103], a[180:183], v[180:183], v[100:103]
    v_exp_f32 v165, v165
    v_mfma_f32_16x16x32_bf16 v[100:103], a[148:151], v[176:179], v[100:103]
    ds_read_b128 a[116:119], v213 offset:32768
    v_lshlrev_b32 v248, 16, v240
    v_mfma_f32_16x16x32_bf16 v[104:107], a[152:155], v[176:179], v[104:107]
    v_exp_f32 v166, v166
    v_mfma_f32_16x16x32_bf16 v[104:107], a[184:187], v[180:183], v[104:107]
    ds_read_b128 a[120:123], v214 offset:32768
    v_and_b32 v249, s31, v240
    v_mfma_f32_16x16x32_bf16 v[108:111], a[188:191], v[180:183], v[108:111]
    v_exp_f32 v167, v167
    v_mfma_f32_16x16x32_bf16 v[108:111], a[156:159], v[176:179], v[108:111]
    s_waitcnt lgkmcnt(3)
    v_cvt_pk_bf16_f32 v186, v164, v165
    v_cvt_pk_bf16_f32 v187, v166, v167
    v_mfma_f32_16x16x32_bf16 v[160:163], a[80:83], a[0:3], v[192:195]
    v_exp_f32 v168, v168
    v_mfma_f32_16x16x32_bf16 v[160:163], a[84:87], a[4:7], v[160:163]
    ds_read_b128 a[124:127], v215 offset:32768
    ds_read_b128 a[128:131], v212 offset:36864
    v_mfma_f32_16x16x32_bf16 v[160:163], a[88:91], a[8:11], v[160:163]
    v_exp_f32 v169, v169
    v_mfma_f32_16x16x32_bf16 v[160:163], a[92:95], a[12:15], v[160:163]
    ds_read_b128 a[132:135], v213 offset:36864
    v_lshlrev_b32 v250, 16, v241
    v_mfma_f32_16x16x32_bf16 v[164:167], a[108:111], a[12:15], v[192:195]
    v_exp_f32 v170, v170
    v_mfma_f32_16x16x32_bf16 v[164:167], a[104:107], a[8:11], v[164:167]
    buffer_load_dwordx4 v[236:239], v228, s[12:15], s27 offen offset:1024 nt
    v_mfma_f32_16x16x32_bf16 v[164:167], a[100:103], a[4:7], v[164:167]
    v_exp_f32 v171, v171
    v_mfma_f32_16x16x32_bf16 v[164:167], a[96:99], a[0:3], v[164:167]
    v_cvt_pk_bf16_f32 v188, v168, v169
    v_cvt_pk_bf16_f32 v189, v170, v171
    v_mfma_f32_16x16x32_bf16 v[112:115], a[192:195], v[180:183], v[112:115]
    v_exp_f32 v172, v172
    v_mfma_f32_16x16x32_bf16 v[112:115], a[160:163], v[176:179], v[112:115]
    ds_read_b128 a[136:139], v214 offset:36864
    ds_read_b128 a[140:143], v215 offset:36864
    v_mfma_f32_16x16x32_bf16 v[116:119], a[164:167], v[176:179], v[116:119]
    v_exp_f32 v173, v173
    v_mfma_f32_16x16x32_bf16 v[116:119], a[196:199], v[180:183], v[116:119]
    buffer_store_dwordx4 a[240:243], v228, s[16:19], s26 offen offset:2048 nt
    v_mfma_f32_16x16x32_bf16 v[120:123], a[200:203], v[180:183], v[120:123]
    v_exp_f32 v174, v174
    v_mfma_f32_16x16x32_bf16 v[120:123], a[168:171], v[176:179], v[120:123]
    v_and_b32 v251, s31, v241
    v_lshlrev_b32 v252, 16, v242
    v_mfma_f32_16x16x32_bf16 v[124:127], a[172:175], v[176:179], v[124:127]
    v_exp_f32 v175, v175
    v_mfma_f32_16x16x32_bf16 v[124:127], a[204:207], v[180:183], v[124:127]
    v_cvt_pk_bf16_f32 v190, v172, v173
    v_cvt_pk_bf16_f32 v191, v174, v175
    v_smfmac_f32_16x16x64_bf16 a[220:223], a[248:251], v[176:183], v231
    s_waitcnt lgkmcnt(0)
    v_and_b32 v253, s31, v242
    v_mfma_f32_16x16x32_bf16 v[168:171], a[112:115], a[0:3], v[192:195]
    v_exp_f32 v160, v160
    v_mfma_f32_16x16x32_bf16 v[168:171], a[116:119], a[4:7], v[168:171]
    v_lshlrev_b32 v254, 16, v243
    v_and_b32 v255, s31, v243
    v_pk_mul_f32 v[248:249], v[248:249], s[84:85]
    v_pk_mul_f32 v[250:251], v[250:251], s[84:85]
    v_pk_mul_f32 v[252:253], v[252:253], s[84:85]
    v_pk_mul_f32 v[254:255], v[254:255], s[84:85]
    v_mfma_f32_16x16x32_bf16 v[168:171], a[120:123], a[8:11], v[168:171]
    v_exp_f32 v161, v161
    v_mfma_f32_16x16x32_bf16 v[168:171], a[124:127], a[12:15], v[168:171]
    v_cvt_pk_bf16_f32 v248, v248, v249
    v_cvt_pk_bf16_f32 v249, v250, v251
    v_mfma_f32_16x16x32_bf16 v[172:175], a[140:143], a[12:15], v[192:195]
    v_exp_f32 v162, v162
    v_mfma_f32_16x16x32_bf16 v[172:175], a[136:139], a[8:11], v[172:175]
    v_cvt_pk_bf16_f32 v250, v252, v253
    v_cvt_pk_bf16_f32 v251, v254, v255
    v_mfma_f32_16x16x32_bf16 v[172:175], a[132:135], a[4:7], v[172:175]
    v_exp_f32 v163, v163
    v_mfma_f32_16x16x32_bf16 v[172:175], a[128:131], a[0:3], v[172:175]
    v_cvt_pk_bf16_f32 v176, v160, v161
    v_cvt_pk_bf16_f32 v177, v162, v163
    v_mfma_f32_16x16x32_bf16 v[128:131], a[144:147], v[184:187], v[128:131]
    v_exp_f32 v164, v164
    v_mfma_f32_16x16x32_bf16 v[128:131], a[176:179], v[188:191], v[128:131]
    ds_read_b64_tr_b16 a[144:145], v216 offset:24576
    ds_read_b64_tr_b16 a[146:147], v216 offset:28672
    v_mfma_f32_16x16x32_bf16 v[132:135], a[180:183], v[188:191], v[132:135]
    v_exp_f32 v165, v165
    v_mfma_f32_16x16x32_bf16 v[132:135], a[148:151], v[184:187], v[132:135]
    ds_read_b64_tr_b16 a[176:177], v216 offset:32768
    ds_read_b64_tr_b16 a[178:179], v216 offset:36864
    v_mfma_f32_16x16x32_bf16 v[136:139], a[152:155], v[184:187], v[136:139]
    v_exp_f32 v166, v166
    v_mfma_f32_16x16x32_bf16 v[136:139], a[184:187], v[188:191], v[136:139]
    ds_read_b64_tr_b16 a[180:181], v217 offset:32768
    ds_read_b64_tr_b16 a[182:183], v217 offset:36864
    v_mfma_f32_16x16x32_bf16 v[140:143], a[188:191], v[188:191], v[140:143]
    v_exp_f32 v167, v167
    v_mfma_f32_16x16x32_bf16 v[140:143], a[156:159], v[184:187], v[140:143]
    v_cvt_pk_bf16_f32 v178, v164, v165
    v_cvt_pk_bf16_f32 v179, v166, v167
    v_mfma_f32_16x16x32_bf16 v[160:163], a[80:83], a[16:19], v[196:199]
    v_exp_f32 v168, v168
    v_mfma_f32_16x16x32_bf16 v[160:163], a[84:87], a[20:23], v[160:163]
    ds_read_b64_tr_b16 a[148:149], v217 offset:24576
    ds_read_b64_tr_b16 a[150:151], v217 offset:28672
    v_mfma_f32_16x16x32_bf16 v[160:163], a[88:91], a[24:27], v[160:163]
    v_exp_f32 v169, v169
    v_mfma_f32_16x16x32_bf16 v[160:163], a[92:95], a[28:31], v[160:163]
    ds_read_b64_tr_b16 a[152:153], v218 offset:24576
    ds_read_b64_tr_b16 a[154:155], v218 offset:28672
    v_mfma_f32_16x16x32_bf16 v[164:167], a[108:111], a[28:31], v[196:199]
    v_exp_f32 v170, v170
    v_mfma_f32_16x16x32_bf16 v[164:167], a[104:107], a[24:27], v[164:167]
    ds_read_b64_tr_b16 a[184:185], v218 offset:32768
    ds_read_b64_tr_b16 a[186:187], v218 offset:36864
    v_mfma_f32_16x16x32_bf16 v[164:167], a[100:103], a[20:23], v[164:167]
    v_exp_f32 v171, v171
    v_mfma_f32_16x16x32_bf16 v[164:167], a[96:99], a[16:19], v[164:167]
    v_cvt_pk_bf16_f32 v180, v168, v169
    v_cvt_pk_bf16_f32 v181, v170, v171
    v_mfma_f32_16x16x32_bf16 v[144:147], a[192:195], v[188:191], v[144:147]
    v_exp_f32 v172, v172
    v_mfma_f32_16x16x32_bf16 v[144:147], a[160:163], v[184:187], v[144:147]
    ds_read_b64_tr_b16 a[188:189], v219 offset:32768
    ds_read_b64_tr_b16 a[190:191], v219 offset:36864
    v_mfma_f32_16x16x32_bf16 v[148:151], a[164:167], v[184:187], v[148:151]
    v_exp_f32 v173, v173
    v_mfma_f32_16x16x32_bf16 v[148:151], a[196:199], v[188:191], v[148:151]
    ds_read_b64_tr_b16 a[156:157], v219 offset:24576
    ds_read_b64_tr_b16 a[158:159], v219 offset:28672
    v_mfma_f32_16x16x32_bf16 v[152:155], a[200:203], v[188:191], v[152:155]
    v_exp_f32 v174, v174
    v_mfma_f32_16x16x32_bf16 v[152:155], a[168:171], v[184:187], v[152:155]
    ds_read_b64_tr_b16 a[192:193], v220 offset:32768
    ds_read_b64_tr_b16 a[194:195], v220 offset:36864
    v_mfma_f32_16x16x32_bf16 v[156:159], a[172:175], v[184:187], v[156:159]
    v_exp_f32 v175, v175
    v_mfma_f32_16x16x32_bf16 v[156:159], a[204:207], v[188:191], v[156:159]
    v_cvt_pk_bf16_f32 v182, v172, v173
    v_cvt_pk_bf16_f32 v183, v174, v175
    v_smfmac_f32_16x16x64_bf16 a[224:227], a[248:251], v[184:191], v231
    ds_read_b64_tr_b16 a[160:161], v220 offset:24576
    ds_write_b128 v229, v[248:251] offset:6144
    v_mfma_f32_16x16x32_bf16 v[168:171], a[112:115], a[16:19], v[196:199]
    v_exp_f32 v160, v160
    v_mfma_f32_16x16x32_bf16 v[168:171], a[116:119], a[20:23], v[168:171]
    ds_read_b64_tr_b16 a[162:163], v220 offset:28672
    ds_read_b64_tr_b16 a[164:165], v221 offset:24576
    v_mfma_f32_16x16x32_bf16 v[168:171], a[120:123], a[24:27], v[168:171]
    v_exp_f32 v161, v161
    v_mfma_f32_16x16x32_bf16 v[168:171], a[124:127], a[28:31], v[168:171]
    ds_read_b64_tr_b16 a[166:167], v221 offset:28672
    ds_read_b64_tr_b16 a[196:197], v221 offset:32768
    v_mfma_f32_16x16x32_bf16 v[172:175], a[140:143], a[28:31], v[196:199]
    v_exp_f32 v162, v162
    v_mfma_f32_16x16x32_bf16 v[172:175], a[136:139], a[24:27], v[172:175]
    ds_read_b64_tr_b16 a[198:199], v221 offset:36864
    ds_read_b64_tr_b16 a[200:201], v222 offset:32768
    v_mfma_f32_16x16x32_bf16 v[172:175], a[132:135], a[20:23], v[172:175]
    v_exp_f32 v163, v163
    v_mfma_f32_16x16x32_bf16 v[172:175], a[128:131], a[16:19], v[172:175]
    s_waitcnt lgkmcnt(14)
    v_cvt_pk_bf16_f32 v184, v160, v161
    v_cvt_pk_bf16_f32 v185, v162, v163
    v_mfma_f32_16x16x32_bf16 v[0:3], a[144:147], v[176:179], v[0:3]
    v_exp_f32 v164, v164
    v_mfma_f32_16x16x32_bf16 v[0:3], a[176:179], v[180:183], v[0:3]
    ds_read_b64_tr_b16 a[202:203], v222 offset:36864
    ds_read_b64_tr_b16 a[168:169], v222 offset:24576
    v_mfma_f32_16x16x32_bf16 v[4:7], a[180:183], v[180:183], v[4:7]
    s_waitcnt lgkmcnt(14)
    s_waitcnt vmcnt(13)
    v_exp_f32 v165, v165
    v_mfma_f32_16x16x32_bf16 v[4:7], a[148:151], v[176:179], v[4:7]
    ds_read_b64_tr_b16 a[170:171], v222 offset:28672
    ds_read_b64_tr_b16 a[172:173], v223 offset:24576
    v_mfma_f32_16x16x32_bf16 v[8:11], a[152:155], v[176:179], v[8:11]
    s_waitcnt lgkmcnt(14)
    v_exp_f32 v166, v166
    v_mfma_f32_16x16x32_bf16 v[8:11], a[184:187], v[180:183], v[8:11]
    ds_read_b64_tr_b16 a[174:175], v223 offset:28672
    ds_read_b64_tr_b16 a[204:205], v223 offset:32768
    v_mfma_f32_16x16x32_bf16 v[12:15], a[188:191], v[180:183], v[12:15]
    s_waitcnt lgkmcnt(14)
    v_exp_f32 v167, v167
    v_mfma_f32_16x16x32_bf16 v[12:15], a[156:159], v[176:179], v[12:15]
    v_cvt_pk_bf16_f32 v186, v164, v165
    v_cvt_pk_bf16_f32 v187, v166, v167
    v_mfma_f32_16x16x32_bf16 v[160:163], a[80:83], a[32:35], v[200:203]
    v_exp_f32 v168, v168
    v_mfma_f32_16x16x32_bf16 v[160:163], a[84:87], a[36:39], v[160:163]
    ds_read_b64_tr_b16 a[206:207], v223 offset:36864
    v_xor_b32 v229, 192, v230
    v_mfma_f32_16x16x32_bf16 v[160:163], a[88:91], a[40:43], v[160:163]
    v_exp_f32 v169, v169
    v_mfma_f32_16x16x32_bf16 v[160:163], a[92:95], a[44:47], v[160:163]
    buffer_load_dwordx4 v[240:243], v228, s[12:15], s27 offen offset:2048 nt
    v_mfma_f32_16x16x32_bf16 v[164:167], a[108:111], a[44:47], v[200:203]
    v_exp_f32 v170, v170
    v_mfma_f32_16x16x32_bf16 v[164:167], a[104:107], a[40:43], v[164:167]
    ds_read_b128 a[244:247], v229 offset:7168
    v_lshlrev_b32 v248, 16, v244
    v_mfma_f32_16x16x32_bf16 v[164:167], a[100:103], a[36:39], v[164:167]
    v_exp_f32 v171, v171
    v_mfma_f32_16x16x32_bf16 v[164:167], a[96:99], a[32:35], v[164:167]
    s_waitcnt lgkmcnt(14)
    v_cvt_pk_bf16_f32 v188, v168, v169
    v_cvt_pk_bf16_f32 v189, v170, v171
    v_mfma_f32_16x16x32_bf16 v[16:19], a[192:195], v[180:183], v[16:19]
    s_waitcnt lgkmcnt(13)
    v_exp_f32 v172, v172
    v_mfma_f32_16x16x32_bf16 v[16:19], a[160:163], v[176:179], v[16:19]
    s_waitcnt lgkmcnt(11)
    v_and_b32 v249, s31, v244
    v_lshlrev_b32 v250, 16, v245
    v_mfma_f32_16x16x32_bf16 v[20:23], a[164:167], v[176:179], v[20:23]
    s_waitcnt lgkmcnt(9)
    v_exp_f32 v173, v173
    v_mfma_f32_16x16x32_bf16 v[20:23], a[196:199], v[180:183], v[20:23]
    s_waitcnt lgkmcnt(7)
    v_and_b32 v251, s31, v245
    v_lshlrev_b32 v252, 16, v246
    v_mfma_f32_16x16x32_bf16 v[24:27], a[200:203], v[180:183], v[24:27]
    s_waitcnt lgkmcnt(5)
    v_exp_f32 v174, v174
    v_mfma_f32_16x16x32_bf16 v[24:27], a[168:171], v[176:179], v[24:27]
    s_waitcnt lgkmcnt(3)
    v_and_b32 v253, s31, v246
    v_lshlrev_b32 v254, 16, v247
    v_mfma_f32_16x16x32_bf16 v[28:31], a[172:175], v[176:179], v[28:31]
    s_waitcnt lgkmcnt(1)
    v_exp_f32 v175, v175
    v_mfma_f32_16x16x32_bf16 v[28:31], a[204:207], v[180:183], v[28:31]
    v_cvt_pk_bf16_f32 v190, v172, v173
    v_cvt_pk_bf16_f32 v191, v174, v175
    v_smfmac_f32_16x16x64_bf16 a[208:211], a[248:251], v[176:183], v231
    s_waitcnt vmcnt(8)
    s_barrier
    v_mfma_f32_16x16x32_bf16 v[168:171], a[112:115], a[32:35], v[200:203]
    s_add_u32 s24, s24, 8192
    v_exp_f32 v160, v160
    v_mfma_f32_16x16x32_bf16 v[168:171], a[116:119], a[36:39], v[168:171]
    s_waitcnt lgkmcnt(0)
    buffer_store_dwordx4 a[244:247], v228, s[16:19], s26 offen offset:3072 nt
    v_mfma_f32_16x16x32_bf16 v[168:171], a[120:123], a[40:43], v[168:171]
    v_exp_f32 v161, v161
    v_mfma_f32_16x16x32_bf16 v[168:171], a[124:127], a[44:47], v[168:171]
    s_add_u32 m0, s32, 24576
    v_and_b32 v255, s31, v247
    v_mfma_f32_16x16x32_bf16 v[172:175], a[140:143], a[44:47], v[200:203]
    v_exp_f32 v162, v162
    v_pk_mul_f32 v[248:249], v[248:249], s[84:85]
    v_pk_mul_f32 v[250:251], v[250:251], s[84:85]
    v_pk_mul_f32 v[252:253], v[252:253], s[84:85]
    v_pk_mul_f32 v[254:255], v[254:255], s[84:85]
    v_mfma_f32_16x16x32_bf16 v[172:175], a[136:139], a[40:43], v[172:175]
    v_cvt_pk_bf16_f32 v248, v248, v249
    v_cvt_pk_bf16_f32 v249, v250, v251
    v_mfma_f32_16x16x32_bf16 v[172:175], a[132:135], a[36:39], v[172:175]
    v_exp_f32 v163, v163
    v_mfma_f32_16x16x32_bf16 v[172:175], a[128:131], a[32:35], v[172:175]
    v_cvt_pk_bf16_f32 v176, v160, v161
    v_cvt_pk_bf16_f32 v177, v162, v163
    v_mfma_f32_16x16x32_bf16 v[32:35], a[144:147], v[184:187], v[32:35]
    v_exp_f32 v164, v164
    v_mfma_f32_16x16x32_bf16 v[32:35], a[176:179], v[188:191], v[32:35]
    buffer_load_dwordx4 v224, s[4:7], s24 offen offset:0 lds
    v_mfma_f32_16x16x32_bf16 v[36:39], a[180:183], v[188:191], v[36:39]
    v_exp_f32 v165, v165
    v_mfma_f32_16x16x32_bf16 v[36:39], a[148:151], v[184:187], v[36:39]
    buffer_load_dwordx4 v225, s[4:7], s24 offen offset:1024 lds
    v_mfma_f32_16x16x32_bf16 v[40:43], a[152:155], v[184:187], v[40:43]
    v_exp_f32 v166, v166
    v_mfma_f32_16x16x32_bf16 v[40:43], a[184:187], v[188:191], v[40:43]
    v_cvt_pk_bf16_f32 v250, v252, v253
    v_cvt_pk_bf16_f32 v251, v254, v255
    v_mfma_f32_16x16x32_bf16 v[44:47], a[188:191], v[188:191], v[44:47]
    s_add_u32 m0, s32, 65536
    v_exp_f32 v167, v167
    v_mfma_f32_16x16x32_bf16 v[44:47], a[156:159], v[184:187], v[44:47]
    v_cvt_pk_bf16_f32 v178, v164, v165
    v_cvt_pk_bf16_f32 v179, v166, v167
    v_mfma_f32_16x16x32_bf16 v[160:163], a[80:83], a[48:51], v[204:207]
    v_exp_f32 v168, v168
    v_mfma_f32_16x16x32_bf16 v[160:163], a[84:87], a[52:55], v[160:163]
    buffer_load_dwordx4 v226, s[8:11], s24 offen offset:0 lds
    v_mfma_f32_16x16x32_bf16 v[160:163], a[88:91], a[56:59], v[160:163]
    v_exp_f32 v169, v169
    v_mfma_f32_16x16x32_bf16 v[160:163], a[92:95], a[60:63], v[160:163]
    v_mfma_f32_16x16x32_bf16 v[164:167], a[108:111], a[60:63], v[204:207]
    v_exp_f32 v170, v170
    v_mfma_f32_16x16x32_bf16 v[164:167], a[104:107], a[56:59], v[164:167]
    buffer_load_dwordx4 v227, s[8:11], s24 offen offset:1024 lds
    v_mfma_f32_16x16x32_bf16 v[164:167], a[100:103], a[52:55], v[164:167]
    v_exp_f32 v171, v171
    v_mfma_f32_16x16x32_bf16 v[164:167], a[96:99], a[48:51], v[164:167]
    v_cvt_pk_bf16_f32 v180, v168, v169
    v_cvt_pk_bf16_f32 v181, v170, v171
    v_mfma_f32_16x16x32_bf16 v[48:51], a[192:195], v[188:191], v[48:51]
    v_exp_f32 v172, v172
    v_mfma_f32_16x16x32_bf16 v[48:51], a[160:163], v[184:187], v[48:51]
    s_add_u32 s24, s24, 8192
    v_mfma_f32_16x16x32_bf16 v[52:55], a[164:167], v[184:187], v[52:55]
    v_exp_f32 v173, v173
    v_mfma_f32_16x16x32_bf16 v[52:55], a[196:199], v[188:191], v[52:55]
    ds_write_b128 v229, v[248:251] offset:7168
    v_mfma_f32_16x16x32_bf16 v[56:59], a[200:203], v[188:191], v[56:59]
    v_exp_f32 v174, v174
    v_mfma_f32_16x16x32_bf16 v[56:59], a[168:171], v[184:187], v[56:59]
    s_add_u32 m0, s32, 32768
    buffer_load_dwordx4 v[244:247], v228, s[12:15], s27 offen offset:3072 nt
    v_mfma_f32_16x16x32_bf16 v[60:63], a[172:175], v[184:187], v[60:63]
    v_exp_f32 v175, v175
    v_mfma_f32_16x16x32_bf16 v[60:63], a[204:207], v[188:191], v[60:63]
    v_cvt_pk_bf16_f32 v182, v172, v173
    v_cvt_pk_bf16_f32 v183, v174, v175
    v_smfmac_f32_16x16x64_bf16 a[212:215], a[248:251], v[184:191], v231
    v_mfma_f32_16x16x32_bf16 v[168:171], a[112:115], a[48:51], v[204:207]
    v_exp_f32 v160, v160
    v_mfma_f32_16x16x32_bf16 v[168:171], a[116:119], a[52:55], v[168:171]
    buffer_load_dwordx4 v224, s[4:7], s24 offen offset:0 lds
    v_mfma_f32_16x16x32_bf16 v[168:171], a[120:123], a[56:59], v[168:171]
    v_exp_f32 v161, v161
    v_mfma_f32_16x16x32_bf16 v[168:171], a[124:127], a[60:63], v[168:171]
    v_mfma_f32_16x16x32_bf16 v[172:175], a[140:143], a[60:63], v[204:207]
    v_exp_f32 v162, v162
    v_mfma_f32_16x16x32_bf16 v[172:175], a[136:139], a[56:59], v[172:175]
    ds_read_b128 a[232:235], v230 offset:8192
    v_lshlrev_b32 v248, 16, v232
    v_mfma_f32_16x16x32_bf16 v[172:175], a[132:135], a[52:55], v[172:175]
    v_exp_f32 v163, v163
    v_mfma_f32_16x16x32_bf16 v[172:175], a[128:131], a[48:51], v[172:175]
    v_cvt_pk_bf16_f32 v184, v160, v161
    v_cvt_pk_bf16_f32 v185, v162, v163
    v_mfma_f32_16x16x32_bf16 v[64:67], a[144:147], v[176:179], v[64:67]
    v_exp_f32 v164, v164
    v_mfma_f32_16x16x32_bf16 v[64:67], a[176:179], v[180:183], v[64:67]
    buffer_load_dwordx4 v225, s[4:7], s24 offen offset:1024 lds
    v_mfma_f32_16x16x32_bf16 v[68:71], a[180:183], v[180:183], v[68:71]
    s_add_u32 m0, s32, 73728
    v_exp_f32 v165, v165
    v_mfma_f32_16x16x32_bf16 v[68:71], a[148:151], v[176:179], v[68:71]
    v_and_b32 v249, s31, v232
    v_lshlrev_b32 v250, 16, v233
    v_mfma_f32_16x16x32_bf16 v[72:75], a[152:155], v[176:179], v[72:75]
    v_exp_f32 v166, v166
    v_mfma_f32_16x16x32_bf16 v[72:75], a[184:187], v[180:183], v[72:75]
    v_and_b32 v251, s31, v233
    v_lshlrev_b32 v252, 16, v234
    v_mfma_f32_16x16x32_bf16 v[76:79], a[188:191], v[180:183], v[76:79]
    v_exp_f32 v167, v167
    v_mfma_f32_16x16x32_bf16 v[76:79], a[156:159], v[176:179], v[76:79]
    v_cvt_pk_bf16_f32 v186, v164, v165
    v_cvt_pk_bf16_f32 v187, v166, v167
    v_mfma_f32_16x16x32_bf16 v[160:163], a[80:83], a[64:67], v[208:211]
    v_exp_f32 v168, v168
    v_mfma_f32_16x16x32_bf16 v[160:163], a[84:87], a[68:71], v[160:163]
    buffer_load_dwordx4 v226, s[8:11], s24 offen offset:0 lds
    v_mfma_f32_16x16x32_bf16 v[160:163], a[88:91], a[72:75], v[160:163]
    v_exp_f32 v169, v169
    v_mfma_f32_16x16x32_bf16 v[160:163], a[92:95], a[76:79], v[160:163]
    s_waitcnt lgkmcnt(0)
    buffer_store_dwordx4 a[232:235], v228, s[16:19], s27 offen offset:0 nt
    v_mfma_f32_16x16x32_bf16 v[164:167], a[108:111], a[76:79], v[208:211]
    v_exp_f32 v170, v170
    v_mfma_f32_16x16x32_bf16 v[164:167], a[104:107], a[72:75], v[164:167]
    buffer_load_dwordx4 v227, s[8:11], s24 offen offset:1024 lds
    v_mfma_f32_16x16x32_bf16 v[164:167], a[100:103], a[68:71], v[164:167]
    v_exp_f32 v171, v171
    v_mfma_f32_16x16x32_bf16 v[164:167], a[96:99], a[64:67], v[164:167]
    v_cvt_pk_bf16_f32 v188, v168, v169
    v_cvt_pk_bf16_f32 v189, v170, v171
    v_mfma_f32_16x16x32_bf16 v[80:83], a[192:195], v[180:183], v[80:83]
    v_exp_f32 v172, v172
    v_mfma_f32_16x16x32_bf16 v[80:83], a[160:163], v[176:179], v[80:83]
    ds_read_b128 a[80:83], v212 offset:0
    v_and_b32 v253, s31, v234
    v_mfma_f32_16x16x32_bf16 v[84:87], a[164:167], v[176:179], v[84:87]
    v_exp_f32 v173, v173
    v_mfma_f32_16x16x32_bf16 v[84:87], a[196:199], v[180:183], v[84:87]
    ds_read_b128 a[84:87], v213 offset:0
    v_lshlrev_b32 v254, 16, v235
    v_mfma_f32_16x16x32_bf16 v[88:91], a[200:203], v[180:183], v[88:91]
    v_exp_f32 v174, v174
    v_mfma_f32_16x16x32_bf16 v[88:91], a[168:171], v[176:179], v[88:91]
    ds_read_b128 a[88:91], v214 offset:0
    v_and_b32 v255, s31, v235
    v_pk_mul_f32 v[248:249], v[248:249], s[84:85]
    v_pk_mul_f32 v[250:251], v[250:251], s[84:85]
    v_pk_mul_f32 v[252:253], v[252:253], s[84:85]
    v_pk_mul_f32 v[254:255], v[254:255], s[84:85]
    v_mfma_f32_16x16x32_bf16 v[92:95], a[172:175], v[176:179], v[92:95]
    v_exp_f32 v175, v175
    v_mfma_f32_16x16x32_bf16 v[92:95], a[204:207], v[180:183], v[92:95]
    v_cvt_pk_bf16_f32 v190, v172, v173
    v_cvt_pk_bf16_f32 v191, v174, v175
    v_smfmac_f32_16x16x64_bf16 a[216:219], a[248:251], v[176:183], v231
    ds_read_b128 a[92:95], v215 offset:0
    v_mfma_f32_16x16x32_bf16 v[168:171], a[112:115], a[64:67], v[208:211]
    v_exp_f32 v160, v160
    v_mfma_f32_16x16x32_bf16 v[168:171], a[116:119], a[68:71], v[168:171]
    ds_read_b128 a[96:99], v212 offset:4096
    v_cvt_pk_bf16_f32 v248, v248, v249
    v_mfma_f32_16x16x32_bf16 v[168:171], a[120:123], a[72:75], v[168:171]
    v_exp_f32 v161, v161
    v_mfma_f32_16x16x32_bf16 v[168:171], a[124:127], a[76:79], v[168:171]
    ds_read_b128 a[100:103], v213 offset:4096
    v_cvt_pk_bf16_f32 v249, v250, v251
    v_mfma_f32_16x16x32_bf16 v[172:175], a[140:143], a[76:79], v[208:211]
    v_exp_f32 v162, v162
    v_mfma_f32_16x16x32_bf16 v[172:175], a[136:139], a[72:75], v[172:175]
    ds_read_b128 a[104:107], v214 offset:4096
    v_cvt_pk_bf16_f32 v250, v252, v253
    v_cvt_pk_bf16_f32 v251, v254, v255
    v_mfma_f32_16x16x32_bf16 v[172:175], a[132:135], a[68:71], v[172:175]
    v_exp_f32 v163, v163
    v_mfma_f32_16x16x32_bf16 v[172:175], a[128:131], a[64:67], v[172:175]
    v_cvt_pk_bf16_f32 v176, v160, v161
    v_cvt_pk_bf16_f32 v177, v162, v163
    v_mfma_f32_16x16x32_bf16 v[96:99], a[144:147], v[184:187], v[96:99]
    v_exp_f32 v164, v164
    v_mfma_f32_16x16x32_bf16 v[96:99], a[176:179], v[188:191], v[96:99]
    ds_read_b128 a[108:111], v215 offset:4096
    ds_read_b128 a[112:115], v212 offset:8192
    v_mfma_f32_16x16x32_bf16 v[100:103], a[180:183], v[188:191], v[100:103]
    v_exp_f32 v165, v165
    v_mfma_f32_16x16x32_bf16 v[100:103], a[148:151], v[184:187], v[100:103]
    ds_read_b128 a[116:119], v213 offset:8192
    ds_write_b128 v230, v[248:251] offset:8192
    v_mfma_f32_16x16x32_bf16 v[104:107], a[152:155], v[184:187], v[104:107]
    v_exp_f32 v166, v166
    v_mfma_f32_16x16x32_bf16 v[104:107], a[184:187], v[188:191], v[104:107]
    ds_read_b128 a[120:123], v214 offset:8192
    v_mfma_f32_16x16x32_bf16 v[108:111], a[188:191], v[188:191], v[108:111]
    v_exp_f32 v167, v167
    v_mfma_f32_16x16x32_bf16 v[108:111], a[156:159], v[184:187], v[108:111]
    s_waitcnt lgkmcnt(4)
    v_cvt_pk_bf16_f32 v178, v164, v165
    v_cvt_pk_bf16_f32 v179, v166, v167
    v_mfma_f32_16x16x32_bf16 v[160:163], a[80:83], a[0:3], v[192:195]
    v_exp_f32 v168, v168
    v_mfma_f32_16x16x32_bf16 v[160:163], a[84:87], a[4:7], v[160:163]
    ds_read_b128 a[124:127], v215 offset:8192
    ds_read_b128 a[128:131], v212 offset:12288
    v_mfma_f32_16x16x32_bf16 v[160:163], a[88:91], a[8:11], v[160:163]
    v_exp_f32 v169, v169
    v_mfma_f32_16x16x32_bf16 v[160:163], a[92:95], a[12:15], v[160:163]
    ds_read_b128 a[132:135], v213 offset:12288
    v_mfma_f32_16x16x32_bf16 v[164:167], a[108:111], a[12:15], v[192:195]
    v_exp_f32 v170, v170
    v_mfma_f32_16x16x32_bf16 v[164:167], a[104:107], a[8:11], v[164:167]
    s_waitcnt vmcnt(13)
    buffer_load_dwordx4 v[232:235], v228, s[12:15], s28 offen offset:0 nt
    v_mfma_f32_16x16x32_bf16 v[164:167], a[100:103], a[4:7], v[164:167]
    v_exp_f32 v171, v171
    v_mfma_f32_16x16x32_bf16 v[164:167], a[96:99], a[0:3], v[164:167]
    v_cvt_pk_bf16_f32 v180, v168, v169
    v_cvt_pk_bf16_f32 v181, v170, v171
    v_mfma_f32_16x16x32_bf16 v[112:115], a[192:195], v[188:191], v[112:115]
    v_exp_f32 v172, v172
    v_mfma_f32_16x16x32_bf16 v[112:115], a[160:163], v[184:187], v[112:115]
    ds_read_b128 a[136:139], v214 offset:12288
    ds_read_b128 a[140:143], v215 offset:12288
    v_mfma_f32_16x16x32_bf16 v[116:119], a[164:167], v[184:187], v[116:119]
    v_exp_f32 v173, v173
    v_mfma_f32_16x16x32_bf16 v[116:119], a[196:199], v[188:191], v[116:119]
    v_xor_b32 v229, 64, v230
    v_lshlrev_b32 v248, 16, v236
    v_mfma_f32_16x16x32_bf16 v[120:123], a[200:203], v[188:191], v[120:123]
    v_exp_f32 v174, v174
    v_mfma_f32_16x16x32_bf16 v[120:123], a[168:171], v[184:187], v[120:123]
    ds_read_b128 a[236:239], v229 offset:9216
    v_and_b32 v249, s31, v236
    v_mfma_f32_16x16x32_bf16 v[124:127], a[172:175], v[184:187], v[124:127]
    v_exp_f32 v175, v175
    v_mfma_f32_16x16x32_bf16 v[124:127], a[204:207], v[188:191], v[124:127]
    v_cvt_pk_bf16_f32 v182, v172, v173
    v_cvt_pk_bf16_f32 v183, v174, v175
    v_smfmac_f32_16x16x64_bf16 a[220:223], a[248:251], v[184:191], v231
    s_waitcnt lgkmcnt(1)
    v_lshlrev_b32 v250, 16, v237
    v_mfma_f32_16x16x32_bf16 v[168:171], a[112:115], a[0:3], v[192:195]
    v_exp_f32 v160, v160
    v_mfma_f32_16x16x32_bf16 v[168:171], a[116:119], a[4:7], v[168:171]
    v_and_b32 v251, s31, v237
    v_lshlrev_b32 v252, 16, v238
    v_mfma_f32_16x16x32_bf16 v[168:171], a[120:123], a[8:11], v[168:171]
    v_exp_f32 v161, v161
    v_mfma_f32_16x16x32_bf16 v[168:171], a[124:127], a[12:15], v[168:171]
    v_and_b32 v253, s31, v238
    v_lshlrev_b32 v254, 16, v239
    v_mfma_f32_16x16x32_bf16 v[172:175], a[140:143], a[12:15], v[192:195]
    v_exp_f32 v162, v162
    v_mfma_f32_16x16x32_bf16 v[172:175], a[136:139], a[8:11], v[172:175]
    v_and_b32 v255, s31, v239
    v_mfma_f32_16x16x32_bf16 v[172:175], a[132:135], a[4:7], v[172:175]
    v_exp_f32 v163, v163
    v_pk_mul_f32 v[248:249], v[248:249], s[84:85]
    v_pk_mul_f32 v[250:251], v[250:251], s[84:85]
    v_pk_mul_f32 v[252:253], v[252:253], s[84:85]
    v_pk_mul_f32 v[254:255], v[254:255], s[84:85]
    v_mfma_f32_16x16x32_bf16 v[172:175], a[128:131], a[0:3], v[172:175]
    v_cvt_pk_bf16_f32 v184, v160, v161
    v_cvt_pk_bf16_f32 v185, v162, v163
    v_mfma_f32_16x16x32_bf16 v[128:131], a[144:147], v[176:179], v[128:131]
    s_waitcnt lgkmcnt(0)
    buffer_store_dwordx4 a[236:239], v228, s[16:19], s27 offen offset:1024 nt
    v_exp_f32 v164, v164
    v_mfma_f32_16x16x32_bf16 v[128:131], a[176:179], v[180:183], v[128:131]
    ds_read_b64_tr_b16 a[144:145], v216 offset:0
    ds_read_b64_tr_b16 a[146:147], v216 offset:4096
    v_mfma_f32_16x16x32_bf16 v[132:135], a[180:183], v[180:183], v[132:135]
    v_exp_f32 v165, v165
    v_mfma_f32_16x16x32_bf16 v[132:135], a[148:151], v[176:179], v[132:135]
    ds_read_b64_tr_b16 a[176:177], v216 offset:8192
    ds_read_b64_tr_b16 a[178:179], v216 offset:12288
    v_mfma_f32_16x16x32_bf16 v[136:139], a[152:155], v[176:179], v[136:139]
    v_exp_f32 v166, v166
    v_mfma_f32_16x16x32_bf16 v[136:139], a[184:187], v[180:183], v[136:139]
    ds_read_b64_tr_b16 a[180:181], v217 offset:8192
    ds_read_b64_tr_b16 a[182:183], v217 offset:12288
    v_mfma_f32_16x16x32_bf16 v[140:143], a[188:191], v[180:183], v[140:143]
    v_exp_f32 v167, v167
    v_mfma_f32_16x16x32_bf16 v[140:143], a[156:159], v[176:179], v[140:143]
    v_cvt_pk_bf16_f32 v186, v164, v165
    v_cvt_pk_bf16_f32 v187, v166, v167
    v_mfma_f32_16x16x32_bf16 v[160:163], a[80:83], a[16:19], v[196:199]
    v_exp_f32 v168, v168
    v_mfma_f32_16x16x32_bf16 v[160:163], a[84:87], a[20:23], v[160:163]
    ds_read_b64_tr_b16 a[148:149], v217 offset:0
    ds_read_b64_tr_b16 a[150:151], v217 offset:4096
    v_mfma_f32_16x16x32_bf16 v[160:163], a[88:91], a[24:27], v[160:163]
    v_exp_f32 v169, v169
    v_mfma_f32_16x16x32_bf16 v[160:163], a[92:95], a[28:31], v[160:163]
    ds_read_b64_tr_b16 a[152:153], v218 offset:0
    ds_read_b64_tr_b16 a[154:155], v218 offset:4096
    v_mfma_f32_16x16x32_bf16 v[164:167], a[108:111], a[28:31], v[196:199]
    v_exp_f32 v170, v170
    v_mfma_f32_16x16x32_bf16 v[164:167], a[104:107], a[24:27], v[164:167]
    ds_read_b64_tr_b16 a[184:185], v218 offset:8192
    ds_read_b64_tr_b16 a[186:187], v218 offset:12288
    v_mfma_f32_16x16x32_bf16 v[164:167], a[100:103], a[20:23], v[164:167]
    v_exp_f32 v171, v171
    v_mfma_f32_16x16x32_bf16 v[164:167], a[96:99], a[16:19], v[164:167]
    v_cvt_pk_bf16_f32 v188, v168, v169
    v_cvt_pk_bf16_f32 v189, v170, v171
    v_mfma_f32_16x16x32_bf16 v[144:147], a[192:195], v[180:183], v[144:147]
    v_exp_f32 v172, v172
    v_mfma_f32_16x16x32_bf16 v[144:147], a[160:163], v[176:179], v[144:147]
    ds_read_b64_tr_b16 a[188:189], v219 offset:8192
    ds_read_b64_tr_b16 a[190:191], v219 offset:12288
    v_mfma_f32_16x16x32_bf16 v[148:151], a[164:167], v[176:179], v[148:151]
    v_exp_f32 v173, v173
    v_mfma_f32_16x16x32_bf16 v[148:151], a[196:199], v[180:183], v[148:151]
    ds_read_b64_tr_b16 a[156:157], v219 offset:0
    ds_read_b64_tr_b16 a[158:159], v219 offset:4096
    v_mfma_f32_16x16x32_bf16 v[152:155], a[200:203], v[180:183], v[152:155]
    v_exp_f32 v174, v174
    v_mfma_f32_16x16x32_bf16 v[152:155], a[168:171], v[176:179], v[152:155]
    ds_read_b64_tr_b16 a[192:193], v220 offset:8192
    ds_read_b64_tr_b16 a[194:195], v220 offset:12288
    v_mfma_f32_16x16x32_bf16 v[156:159], a[172:175], v[176:179], v[156:159]
    v_exp_f32 v175, v175
    v_mfma_f32_16x16x32_bf16 v[156:159], a[204:207], v[180:183], v[156:159]
    v_cvt_pk_bf16_f32 v190, v172, v173
    v_cvt_pk_bf16_f32 v191, v174, v175
    v_smfmac_f32_16x16x64_bf16 a[224:227], a[248:251], v[176:183], v231
    ds_read_b64_tr_b16 a[160:161], v220 offset:0
    v_mfma_f32_16x16x32_bf16 v[168:171], a[112:115], a[16:19], v[196:199]
    v_exp_f32 v160, v160
    v_mfma_f32_16x16x32_bf16 v[168:171], a[116:119], a[20:23], v[168:171]
    ds_read_b64_tr_b16 a[162:163], v220 offset:4096
    ds_read_b64_tr_b16 a[164:165], v221 offset:0
    v_mfma_f32_16x16x32_bf16 v[168:171], a[120:123], a[24:27], v[168:171]
    v_exp_f32 v161, v161
    v_mfma_f32_16x16x32_bf16 v[168:171], a[124:127], a[28:31], v[168:171]
    ds_read_b64_tr_b16 a[166:167], v221 offset:4096
    ds_read_b64_tr_b16 a[196:197], v221 offset:8192
    v_mfma_f32_16x16x32_bf16 v[172:175], a[140:143], a[28:31], v[196:199]
    v_exp_f32 v162, v162
    v_mfma_f32_16x16x32_bf16 v[172:175], a[136:139], a[24:27], v[172:175]
    ds_read_b64_tr_b16 a[198:199], v221 offset:12288
    ds_read_b64_tr_b16 a[200:201], v222 offset:8192
    v_mfma_f32_16x16x32_bf16 v[172:175], a[132:135], a[20:23], v[172:175]
    v_exp_f32 v163, v163
    v_mfma_f32_16x16x32_bf16 v[172:175], a[128:131], a[16:19], v[172:175]
    s_waitcnt lgkmcnt(14)
    v_cvt_pk_bf16_f32 v176, v160, v161
    v_cvt_pk_bf16_f32 v177, v162, v163
    v_mfma_f32_16x16x32_bf16 v[0:3], a[144:147], v[184:187], v[0:3]
    v_exp_f32 v164, v164
    v_mfma_f32_16x16x32_bf16 v[0:3], a[176:179], v[188:191], v[0:3]
    ds_read_b64_tr_b16 a[202:203], v222 offset:12288
    ds_read_b64_tr_b16 a[168:169], v222 offset:0
    v_mfma_f32_16x16x32_bf16 v[4:7], a[180:183], v[188:191], v[4:7]
    s_waitcnt lgkmcnt(14)
    v_exp_f32 v165, v165
    v_mfma_f32_16x16x32_bf16 v[4:7], a[148:151], v[184:187], v[4:7]
    ds_read_b64_tr_b16 a[170:171], v222 offset:4096
    ds_read_b64_tr_b16 a[172:173], v223 offset:0
    v_mfma_f32_16x16x32_bf16 v[8:11], a[152:155], v[184:187], v[8:11]
    s_waitcnt lgkmcnt(14)
    v_exp_f32 v166, v166
    v_mfma_f32_16x16x32_bf16 v[8:11], a[184:187], v[188:191], v[8:11]
    ds_read_b64_tr_b16 a[174:175], v223 offset:4096
    ds_read_b64_tr_b16 a[204:205], v223 offset:8192
    v_mfma_f32_16x16x32_bf16 v[12:15], a[188:191], v[188:191], v[12:15]
    s_waitcnt lgkmcnt(14)
    v_exp_f32 v167, v167
    v_mfma_f32_16x16x32_bf16 v[12:15], a[156:159], v[184:187], v[12:15]
    v_cvt_pk_bf16_f32 v178, v164, v165
    v_cvt_pk_bf16_f32 v179, v166, v167
    v_mfma_f32_16x16x32_bf16 v[160:163], a[80:83], a[32:35], v[200:203]
    v_exp_f32 v168, v168
    v_mfma_f32_16x16x32_bf16 v[160:163], a[84:87], a[36:39], v[160:163]
    ds_read_b64_tr_b16 a[206:207], v223 offset:12288
    v_cvt_pk_bf16_f32 v248, v248, v249
    v_mfma_f32_16x16x32_bf16 v[160:163], a[88:91], a[40:43], v[160:163]
    v_exp_f32 v169, v169
    v_mfma_f32_16x16x32_bf16 v[160:163], a[92:95], a[44:47], v[160:163]
    v_cvt_pk_bf16_f32 v249, v250, v251
    v_cvt_pk_bf16_f32 v250, v252, v253
    v_mfma_f32_16x16x32_bf16 v[164:167], a[108:111], a[44:47], v[200:203]
    v_exp_f32 v170, v170
    v_mfma_f32_16x16x32_bf16 v[164:167], a[104:107], a[40:43], v[164:167]
    v_cvt_pk_bf16_f32 v251, v254, v255
    v_mfma_f32_16x16x32_bf16 v[164:167], a[100:103], a[36:39], v[164:167]
    v_exp_f32 v171, v171
    v_mfma_f32_16x16x32_bf16 v[164:167], a[96:99], a[32:35], v[164:167]
    s_waitcnt lgkmcnt(14)
    v_cvt_pk_bf16_f32 v180, v168, v169
    v_cvt_pk_bf16_f32 v181, v170, v171
    v_mfma_f32_16x16x32_bf16 v[16:19], a[192:195], v[188:191], v[16:19]
    s_waitcnt lgkmcnt(12)
    v_exp_f32 v172, v172
    v_mfma_f32_16x16x32_bf16 v[16:19], a[160:163], v[184:187], v[16:19]
    s_waitcnt lgkmcnt(10)
    v_mfma_f32_16x16x32_bf16 v[20:23], a[164:167], v[184:187], v[20:23]
    s_waitcnt lgkmcnt(8)
    v_exp_f32 v173, v173
    v_mfma_f32_16x16x32_bf16 v[20:23], a[196:199], v[188:191], v[20:23]
    s_waitcnt lgkmcnt(6)
    ds_write_b128 v229, v[248:251] offset:9216
    v_mfma_f32_16x16x32_bf16 v[24:27], a[200:203], v[188:191], v[24:27]
    s_waitcnt lgkmcnt(5)
    v_exp_f32 v174, v174
    v_mfma_f32_16x16x32_bf16 v[24:27], a[168:171], v[184:187], v[24:27]
    s_waitcnt lgkmcnt(3)
    buffer_load_dwordx4 v[236:239], v228, s[12:15], s28 offen offset:1024 nt
    v_mfma_f32_16x16x32_bf16 v[28:31], a[172:175], v[184:187], v[28:31]
    s_waitcnt lgkmcnt(1)
    v_exp_f32 v175, v175
    v_mfma_f32_16x16x32_bf16 v[28:31], a[204:207], v[188:191], v[28:31]
    v_cvt_pk_bf16_f32 v182, v172, v173
    v_cvt_pk_bf16_f32 v183, v174, v175
    v_smfmac_f32_16x16x64_bf16 a[208:211], a[248:251], v[184:191], v231
    s_waitcnt vmcnt(9)
    s_barrier
    v_mfma_f32_16x16x32_bf16 v[168:171], a[112:115], a[32:35], v[200:203]
    s_add_u32 s24, s24, 8192
    v_exp_f32 v160, v160
    v_mfma_f32_16x16x32_bf16 v[168:171], a[116:119], a[36:39], v[168:171]
    v_mfma_f32_16x16x32_bf16 v[168:171], a[120:123], a[40:43], v[168:171]
    v_exp_f32 v161, v161
    v_mfma_f32_16x16x32_bf16 v[168:171], a[124:127], a[44:47], v[168:171]
    s_add_u32 m0, s32, 0
    v_mfma_f32_16x16x32_bf16 v[172:175], a[140:143], a[44:47], v[200:203]
    v_exp_f32 v162, v162
    v_mfma_f32_16x16x32_bf16 v[172:175], a[136:139], a[40:43], v[172:175]
    v_xor_b32 v229, 128, v230
    v_lshlrev_b32 v248, 16, v240
    v_mfma_f32_16x16x32_bf16 v[172:175], a[132:135], a[36:39], v[172:175]
    v_exp_f32 v163, v163
    v_mfma_f32_16x16x32_bf16 v[172:175], a[128:131], a[32:35], v[172:175]
    v_cvt_pk_bf16_f32 v184, v160, v161
    v_cvt_pk_bf16_f32 v185, v162, v163
    v_mfma_f32_16x16x32_bf16 v[32:35], a[144:147], v[176:179], v[32:35]
    v_exp_f32 v164, v164
    v_mfma_f32_16x16x32_bf16 v[32:35], a[176:179], v[180:183], v[32:35]
    buffer_load_dwordx4 v224, s[4:7], s24 offen offset:0 lds
    v_mfma_f32_16x16x32_bf16 v[36:39], a[180:183], v[180:183], v[36:39]
    v_exp_f32 v165, v165
    v_mfma_f32_16x16x32_bf16 v[36:39], a[148:151], v[176:179], v[36:39]
    buffer_load_dwordx4 v225, s[4:7], s24 offen offset:1024 lds
    v_mfma_f32_16x16x32_bf16 v[40:43], a[152:155], v[176:179], v[40:43]
    v_exp_f32 v166, v166
    v_mfma_f32_16x16x32_bf16 v[40:43], a[184:187], v[180:183], v[40:43]
    ds_read_b128 a[240:243], v229 offset:10240
    v_and_b32 v249, s31, v240
    v_mfma_f32_16x16x32_bf16 v[44:47], a[188:191], v[180:183], v[44:47]
    s_add_u32 m0, s32, 40960
    v_exp_f32 v167, v167
    v_mfma_f32_16x16x32_bf16 v[44:47], a[156:159], v[176:179], v[44:47]
    v_cvt_pk_bf16_f32 v186, v164, v165
    v_cvt_pk_bf16_f32 v187, v166, v167
    v_mfma_f32_16x16x32_bf16 v[160:163], a[80:83], a[48:51], v[204:207]
    v_exp_f32 v168, v168
    v_mfma_f32_16x16x32_bf16 v[160:163], a[84:87], a[52:55], v[160:163]
    buffer_load_dwordx4 v226, s[8:11], s24 offen offset:0 lds
    v_mfma_f32_16x16x32_bf16 v[160:163], a[88:91], a[56:59], v[160:163]
    v_exp_f32 v169, v169
    v_mfma_f32_16x16x32_bf16 v[160:163], a[92:95], a[60:63], v[160:163]
    v_lshlrev_b32 v250, 16, v241
    v_and_b32 v251, s31, v241
    v_mfma_f32_16x16x32_bf16 v[164:167], a[108:111], a[60:63], v[204:207]
    v_exp_f32 v170, v170
    v_mfma_f32_16x16x32_bf16 v[164:167], a[104:107], a[56:59], v[164:167]
    buffer_load_dwordx4 v227, s[8:11], s24 offen offset:1024 lds
    v_mfma_f32_16x16x32_bf16 v[164:167], a[100:103], a[52:55], v[164:167]
    v_exp_f32 v171, v171
    v_mfma_f32_16x16x32_bf16 v[164:167], a[96:99], a[48:51], v[164:167]
    v_cvt_pk_bf16_f32 v188, v168, v169
    v_cvt_pk_bf16_f32 v189, v170, v171
    v_mfma_f32_16x16x32_bf16 v[48:51], a[192:195], v[180:183], v[48:51]
    v_exp_f32 v172, v172
    v_mfma_f32_16x16x32_bf16 v[48:51], a[160:163], v[176:179], v[48:51]
    s_add_u32 s24, s24, 8192
    s_waitcnt lgkmcnt(0)
    buffer_store_dwordx4 a[240:243], v228, s[16:19], s27 offen offset:2048 nt
    v_mfma_f32_16x16x32_bf16 v[52:55], a[164:167], v[176:179], v[52:55]
    v_exp_f32 v173, v173
    v_mfma_f32_16x16x32_bf16 v[52:55], a[196:199], v[180:183], v[52:55]
    v_lshlrev_b32 v252, 16, v242
    v_and_b32 v253, s31, v242
    v_mfma_f32_16x16x32_bf16 v[56:59], a[200:203], v[180:183], v[56:59]
    v_exp_f32 v174, v174
    v_mfma_f32_16x16x32_bf16 v[56:59], a[168:171], v[176:179], v[56:59]
    s_add_u32 m0, s32, 8192
    v_lshlrev_b32 v254, 16, v243
    v_and_b32 v255, s31, v243
    v_pk_mul_f32 v[248:249], v[248:249], s[84:85]
    v_pk_mul_f32 v[250:251], v[250:251], s[84:85]
    v_pk_mul_f32 v[252:253], v[252:253], s[84:85]
    v_pk_mul_f32 v[254:255], v[254:255], s[84:85]
    v_mfma_f32_16x16x32_bf16 v[60:63], a[172:175], v[176:179], v[60:63]
    v_exp_f32 v175, v175
    v_mfma_f32_16x16x32_bf16 v[60:63], a[204:207], v[180:183], v[60:63]
    v_cvt_pk_bf16_f32 v190, v172, v173
    v_cvt_pk_bf16_f32 v191, v174, v175
    v_smfmac_f32_16x16x64_bf16 a[212:215], a[248:251], v[176:183], v231
    v_cvt_pk_bf16_f32 v248, v248, v249
    v_mfma_f32_16x16x32_bf16 v[168:171], a[112:115], a[48:51], v[204:207]
    v_exp_f32 v160, v160
    v_mfma_f32_16x16x32_bf16 v[168:171], a[116:119], a[52:55], v[168:171]
    buffer_load_dwordx4 v224, s[4:7], s24 offen offset:0 lds
    v_mfma_f32_16x16x32_bf16 v[168:171], a[120:123], a[56:59], v[168:171]
    v_exp_f32 v161, v161
    v_mfma_f32_16x16x32_bf16 v[168:171], a[124:127], a[60:63], v[168:171]
    v_cvt_pk_bf16_f32 v249, v250, v251
    v_cvt_pk_bf16_f32 v250, v252, v253
    v_mfma_f32_16x16x32_bf16 v[172:175], a[140:143], a[60:63], v[204:207]
    v_exp_f32 v162, v162
    v_mfma_f32_16x16x32_bf16 v[172:175], a[136:139], a[56:59], v[172:175]
    v_cvt_pk_bf16_f32 v251, v254, v255
    v_mfma_f32_16x16x32_bf16 v[172:175], a[132:135], a[52:55], v[172:175]
    v_exp_f32 v163, v163
    v_mfma_f32_16x16x32_bf16 v[172:175], a[128:131], a[48:51], v[172:175]
    v_cvt_pk_bf16_f32 v176, v160, v161
    v_cvt_pk_bf16_f32 v177, v162, v163
    v_mfma_f32_16x16x32_bf16 v[64:67], a[144:147], v[184:187], v[64:67]
    v_exp_f32 v164, v164
    v_mfma_f32_16x16x32_bf16 v[64:67], a[176:179], v[188:191], v[64:67]
    buffer_load_dwordx4 v225, s[4:7], s24 offen offset:1024 lds
    v_mfma_f32_16x16x32_bf16 v[68:71], a[180:183], v[188:191], v[68:71]
    s_add_u32 m0, s32, 49152
    v_exp_f32 v165, v165
    v_mfma_f32_16x16x32_bf16 v[68:71], a[148:151], v[184:187], v[68:71]
    ds_write_b128 v229, v[248:251] offset:10240
    v_mfma_f32_16x16x32_bf16 v[72:75], a[152:155], v[184:187], v[72:75]
    v_exp_f32 v166, v166
    v_mfma_f32_16x16x32_bf16 v[72:75], a[184:187], v[188:191], v[72:75]
    buffer_load_dwordx4 v[240:243], v228, s[12:15], s28 offen offset:2048 nt
    v_mfma_f32_16x16x32_bf16 v[76:79], a[188:191], v[188:191], v[76:79]
    v_exp_f32 v167, v167
    v_mfma_f32_16x16x32_bf16 v[76:79], a[156:159], v[184:187], v[76:79]
    v_cvt_pk_bf16_f32 v178, v164, v165
    v_cvt_pk_bf16_f32 v179, v166, v167
    v_mfma_f32_16x16x32_bf16 v[160:163], a[80:83], a[64:67], v[208:211]
    v_exp_f32 v168, v168
    v_mfma_f32_16x16x32_bf16 v[160:163], a[84:87], a[68:71], v[160:163]
    buffer_load_dwordx4 v226, s[8:11], s24 offen offset:0 lds
    v_mfma_f32_16x16x32_bf16 v[160:163], a[88:91], a[72:75], v[160:163]
    v_exp_f32 v169, v169
    v_mfma_f32_16x16x32_bf16 v[160:163], a[92:95], a[76:79], v[160:163]
    v_mfma_f32_16x16x32_bf16 v[164:167], a[108:111], a[76:79], v[208:211]
    v_exp_f32 v170, v170
    v_mfma_f32_16x16x32_bf16 v[164:167], a[104:107], a[72:75], v[164:167]
    buffer_load_dwordx4 v227, s[8:11], s24 offen offset:1024 lds
    v_mfma_f32_16x16x32_bf16 v[164:167], a[100:103], a[68:71], v[164:167]
    s_waitcnt vmcnt(18)
    v_exp_f32 v171, v171
    v_mfma_f32_16x16x32_bf16 v[164:167], a[96:99], a[64:67], v[164:167]
    v_cvt_pk_bf16_f32 v180, v168, v169
    v_cvt_pk_bf16_f32 v181, v170, v171
    v_mfma_f32_16x16x32_bf16 v[80:83], a[192:195], v[188:191], v[80:83]
    v_exp_f32 v172, v172
    v_mfma_f32_16x16x32_bf16 v[80:83], a[160:163], v[184:187], v[80:83]
    ds_read_b128 a[80:83], v212 offset:16384
    v_xor_b32 v229, 192, v230
    v_mfma_f32_16x16x32_bf16 v[84:87], a[164:167], v[184:187], v[84:87]
    v_exp_f32 v173, v173
    v_mfma_f32_16x16x32_bf16 v[84:87], a[196:199], v[188:191], v[84:87]
    ds_read_b128 a[84:87], v213 offset:16384
    ds_read_b128 a[244:247], v229 offset:11264
    v_mfma_f32_16x16x32_bf16 v[88:91], a[200:203], v[188:191], v[88:91]
    v_exp_f32 v174, v174
    v_mfma_f32_16x16x32_bf16 v[88:91], a[168:171], v[184:187], v[88:91]
    ds_read_b128 a[88:91], v214 offset:16384
    v_lshlrev_b32 v248, 16, v244
    v_mfma_f32_16x16x32_bf16 v[92:95], a[172:175], v[184:187], v[92:95]
    v_exp_f32 v175, v175
    v_mfma_f32_16x16x32_bf16 v[92:95], a[204:207], v[188:191], v[92:95]
    v_cvt_pk_bf16_f32 v182, v172, v173
    v_cvt_pk_bf16_f32 v183, v174, v175
    v_smfmac_f32_16x16x64_bf16 a[216:219], a[248:251], v[184:191], v231
    ds_read_b128 a[92:95], v215 offset:16384
    v_mfma_f32_16x16x32_bf16 v[168:171], a[112:115], a[64:67], v[208:211]
    v_exp_f32 v160, v160
    v_mfma_f32_16x16x32_bf16 v[168:171], a[116:119], a[68:71], v[168:171]
    ds_read_b128 a[96:99], v212 offset:20480
    v_and_b32 v249, s31, v244
    v_mfma_f32_16x16x32_bf16 v[168:171], a[120:123], a[72:75], v[168:171]
    v_exp_f32 v161, v161
    v_mfma_f32_16x16x32_bf16 v[168:171], a[124:127], a[76:79], v[168:171]
    ds_read_b128 a[100:103], v213 offset:20480
    v_lshlrev_b32 v250, 16, v245
    v_mfma_f32_16x16x32_bf16 v[172:175], a[140:143], a[76:79], v[208:211]
    v_exp_f32 v162, v162
    v_mfma_f32_16x16x32_bf16 v[172:175], a[136:139], a[72:75], v[172:175]
    ds_read_b128 a[104:107], v214 offset:20480
    v_and_b32 v251, s31, v245
    v_mfma_f32_16x16x32_bf16 v[172:175], a[132:135], a[68:71], v[172:175]
    v_exp_f32 v163, v163
    v_mfma_f32_16x16x32_bf16 v[172:175], a[128:131], a[64:67], v[172:175]
    v_cvt_pk_bf16_f32 v184, v160, v161
    v_cvt_pk_bf16_f32 v185, v162, v163
    v_mfma_f32_16x16x32_bf16 v[96:99], a[144:147], v[176:179], v[96:99]
    v_exp_f32 v164, v164
    v_mfma_f32_16x16x32_bf16 v[96:99], a[176:179], v[180:183], v[96:99]
    ds_read_b128 a[108:111], v215 offset:20480
    ds_read_b128 a[112:115], v212 offset:24576
    v_mfma_f32_16x16x32_bf16 v[100:103], a[180:183], v[180:183], v[100:103]
    v_exp_f32 v165, v165
    v_mfma_f32_16x16x32_bf16 v[100:103], a[148:151], v[176:179], v[100:103]
    ds_read_b128 a[116:119], v213 offset:24576
    v_lshlrev_b32 v252, 16, v246
    v_mfma_f32_16x16x32_bf16 v[104:107], a[152:155], v[176:179], v[104:107]
    v_exp_f32 v166, v166
    v_mfma_f32_16x16x32_bf16 v[104:107], a[184:187], v[180:183], v[104:107]
    ds_read_b128 a[120:123], v214 offset:24576
    v_and_b32 v253, s31, v246
    v_mfma_f32_16x16x32_bf16 v[108:111], a[188:191], v[180:183], v[108:111]
    v_exp_f32 v167, v167
    v_mfma_f32_16x16x32_bf16 v[108:111], a[156:159], v[176:179], v[108:111]
    s_waitcnt lgkmcnt(3)
    v_cvt_pk_bf16_f32 v186, v164, v165
    v_cvt_pk_bf16_f32 v187, v166, v167
    v_mfma_f32_16x16x32_bf16 v[160:163], a[80:83], a[0:3], v[192:195]
    v_exp_f32 v168, v168
    v_mfma_f32_16x16x32_bf16 v[160:163], a[84:87], a[4:7], v[160:163]
    ds_read_b128 a[124:127], v215 offset:24576
    ds_read_b128 a[128:131], v212 offset:28672
    v_mfma_f32_16x16x32_bf16 v[160:163], a[88:91], a[8:11], v[160:163]
    v_exp_f32 v169, v169
    v_mfma_f32_16x16x32_bf16 v[160:163], a[92:95], a[12:15], v[160:163]
    ds_read_b128 a[132:135], v213 offset:28672
    v_lshlrev_b32 v254, 16, v247
    v_mfma_f32_16x16x32_bf16 v[164:167], a[108:111], a[12:15], v[192:195]
    v_exp_f32 v170, v170
    v_mfma_f32_16x16x32_bf16 v[164:167], a[104:107], a[8:11], v[164:167]
    buffer_store_dwordx4 a[244:247], v228, s[16:19], s27 offen offset:3072 nt
    v_mfma_f32_16x16x32_bf16 v[164:167], a[100:103], a[4:7], v[164:167]
    v_exp_f32 v171, v171
    v_mfma_f32_16x16x32_bf16 v[164:167], a[96:99], a[0:3], v[164:167]
    v_cvt_pk_bf16_f32 v188, v168, v169
    v_cvt_pk_bf16_f32 v189, v170, v171
    v_mfma_f32_16x16x32_bf16 v[112:115], a[192:195], v[180:183], v[112:115]
    v_exp_f32 v172, v172
    v_mfma_f32_16x16x32_bf16 v[112:115], a[160:163], v[176:179], v[112:115]
    ds_read_b128 a[136:139], v214 offset:28672
    ds_read_b128 a[140:143], v215 offset:28672
    v_mfma_f32_16x16x32_bf16 v[116:119], a[164:167], v[176:179], v[116:119]
    v_exp_f32 v173, v173
    v_mfma_f32_16x16x32_bf16 v[116:119], a[196:199], v[180:183], v[116:119]
    v_and_b32 v255, s31, v247
    v_mfma_f32_16x16x32_bf16 v[120:123], a[200:203], v[180:183], v[120:123]
    v_exp_f32 v174, v174
    v_pk_mul_f32 v[248:249], v[248:249], s[84:85]
    v_pk_mul_f32 v[250:251], v[250:251], s[84:85]
    v_pk_mul_f32 v[252:253], v[252:253], s[84:85]
    v_pk_mul_f32 v[254:255], v[254:255], s[84:85]
    v_cvt_pk_bf16_f32 v248, v248, v249
    v_cvt_pk_bf16_f32 v249, v250, v251
    v_cvt_pk_bf16_f32 v250, v252, v253
    v_cvt_pk_bf16_f32 v251, v254, v255
    v_mfma_f32_16x16x32_bf16 v[120:123], a[168:171], v[176:179], v[120:123]
    ds_write_b128 v229, v[248:251] offset:11264
    v_mfma_f32_16x16x32_bf16 v[124:127], a[172:175], v[176:179], v[124:127]
    v_exp_f32 v175, v175
    v_mfma_f32_16x16x32_bf16 v[124:127], a[204:207], v[180:183], v[124:127]
    v_cvt_pk_bf16_f32 v190, v172, v173
    v_cvt_pk_bf16_f32 v191, v174, v175
    v_smfmac_f32_16x16x64_bf16 a[220:223], a[248:251], v[176:183], v231
    s_waitcnt lgkmcnt(1)
    v_mfma_f32_16x16x32_bf16 v[168:171], a[112:115], a[0:3], v[192:195]
    v_exp_f32 v160, v160
    v_mfma_f32_16x16x32_bf16 v[168:171], a[116:119], a[4:7], v[168:171]
    buffer_load_dwordx4 v[244:247], v228, s[12:15], s28 offen offset:3072 nt
    v_mfma_f32_16x16x32_bf16 v[168:171], a[120:123], a[8:11], v[168:171]
    v_exp_f32 v161, v161
    v_mfma_f32_16x16x32_bf16 v[168:171], a[124:127], a[12:15], v[168:171]
    v_mfma_f32_16x16x32_bf16 v[172:175], a[140:143], a[12:15], v[192:195]
    v_exp_f32 v162, v162
    v_mfma_f32_16x16x32_bf16 v[172:175], a[136:139], a[8:11], v[172:175]
    v_mfma_f32_16x16x32_bf16 v[172:175], a[132:135], a[4:7], v[172:175]
    s_waitcnt vmcnt(14)
    ds_read_b128 a[232:235], v230 offset:12288
    v_exp_f32 v163, v163
    v_mfma_f32_16x16x32_bf16 v[172:175], a[128:131], a[0:3], v[172:175]
    v_cvt_pk_bf16_f32 v176, v160, v161
    v_cvt_pk_bf16_f32 v177, v162, v163
    v_mfma_f32_16x16x32_bf16 v[128:131], a[144:147], v[184:187], v[128:131]
    v_exp_f32 v164, v164
    v_mfma_f32_16x16x32_bf16 v[128:131], a[176:179], v[188:191], v[128:131]
    ds_read_b64_tr_b16 a[144:145], v216 offset:16384
    ds_read_b64_tr_b16 a[146:147], v216 offset:20480
    v_mfma_f32_16x16x32_bf16 v[132:135], a[180:183], v[188:191], v[132:135]
    v_exp_f32 v165, v165
    v_mfma_f32_16x16x32_bf16 v[132:135], a[148:151], v[184:187], v[132:135]
    ds_read_b64_tr_b16 a[176:177], v216 offset:24576
    ds_read_b64_tr_b16 a[178:179], v216 offset:28672
    v_mfma_f32_16x16x32_bf16 v[136:139], a[152:155], v[184:187], v[136:139]
    v_exp_f32 v166, v166
    v_mfma_f32_16x16x32_bf16 v[136:139], a[184:187], v[188:191], v[136:139]
    ds_read_b64_tr_b16 a[180:181], v217 offset:24576
    ds_read_b64_tr_b16 a[182:183], v217 offset:28672
    v_mfma_f32_16x16x32_bf16 v[140:143], a[188:191], v[188:191], v[140:143]
    v_exp_f32 v167, v167
    v_mfma_f32_16x16x32_bf16 v[140:143], a[156:159], v[184:187], v[140:143]
    v_cvt_pk_bf16_f32 v178, v164, v165
    v_cvt_pk_bf16_f32 v179, v166, v167
    v_mfma_f32_16x16x32_bf16 v[160:163], a[80:83], a[16:19], v[196:199]
    v_exp_f32 v168, v168
    v_mfma_f32_16x16x32_bf16 v[160:163], a[84:87], a[20:23], v[160:163]
    ds_read_b64_tr_b16 a[148:149], v217 offset:16384
    ds_read_b64_tr_b16 a[150:151], v217 offset:20480
    v_mfma_f32_16x16x32_bf16 v[160:163], a[88:91], a[24:27], v[160:163]
    s_waitcnt lgkmcnt(8)
    buffer_store_dwordx4 a[232:235], v228, s[16:19], s28 offen offset:0 nt
    v_exp_f32 v169, v169
    v_mfma_f32_16x16x32_bf16 v[160:163], a[92:95], a[28:31], v[160:163]
    ds_read_b64_tr_b16 a[152:153], v218 offset:16384
    ds_read_b64_tr_b16 a[154:155], v218 offset:20480
    v_mfma_f32_16x16x32_bf16 v[164:167], a[108:111], a[28:31], v[196:199]
    v_exp_f32 v170, v170
    v_mfma_f32_16x16x32_bf16 v[164:167], a[104:107], a[24:27], v[164:167]
    ds_read_b64_tr_b16 a[184:185], v218 offset:24576
    ds_read_b64_tr_b16 a[186:187], v218 offset:28672
    v_mfma_f32_16x16x32_bf16 v[164:167], a[100:103], a[20:23], v[164:167]
    v_exp_f32 v171, v171
    v_mfma_f32_16x16x32_bf16 v[164:167], a[96:99], a[16:19], v[164:167]
    v_cvt_pk_bf16_f32 v180, v168, v169
    v_cvt_pk_bf16_f32 v181, v170, v171
    v_mfma_f32_16x16x32_bf16 v[144:147], a[192:195], v[188:191], v[144:147]
    v_exp_f32 v172, v172
    v_mfma_f32_16x16x32_bf16 v[144:147], a[160:163], v[184:187], v[144:147]
    ds_read_b64_tr_b16 a[188:189], v219 offset:24576
    ds_read_b64_tr_b16 a[190:191], v219 offset:28672
    v_mfma_f32_16x16x32_bf16 v[148:151], a[164:167], v[184:187], v[148:151]
    v_exp_f32 v173, v173
    v_mfma_f32_16x16x32_bf16 v[148:151], a[196:199], v[188:191], v[148:151]
    ds_read_b64_tr_b16 a[156:157], v219 offset:16384
    ds_read_b64_tr_b16 a[158:159], v219 offset:20480
    v_mfma_f32_16x16x32_bf16 v[152:155], a[200:203], v[188:191], v[152:155]
    v_exp_f32 v174, v174
    v_mfma_f32_16x16x32_bf16 v[152:155], a[168:171], v[184:187], v[152:155]
    ds_read_b64_tr_b16 a[192:193], v220 offset:24576
    ds_read_b64_tr_b16 a[194:195], v220 offset:28672
    v_mfma_f32_16x16x32_bf16 v[156:159], a[172:175], v[184:187], v[156:159]
    v_exp_f32 v175, v175
    v_mfma_f32_16x16x32_bf16 v[156:159], a[204:207], v[188:191], v[156:159]
    v_cvt_pk_bf16_f32 v182, v172, v173
    v_cvt_pk_bf16_f32 v183, v174, v175
    v_smfmac_f32_16x16x64_bf16 a[224:227], a[248:251], v[184:191], v231
    ds_read_b64_tr_b16 a[160:161], v220 offset:16384
    v_mfma_f32_16x16x32_bf16 v[168:171], a[112:115], a[16:19], v[196:199]
    v_exp_f32 v160, v160
    v_mfma_f32_16x16x32_bf16 v[168:171], a[116:119], a[20:23], v[168:171]
    ds_read_b64_tr_b16 a[162:163], v220 offset:20480
    ds_read_b64_tr_b16 a[164:165], v221 offset:16384
    v_mfma_f32_16x16x32_bf16 v[168:171], a[120:123], a[24:27], v[168:171]
    v_exp_f32 v161, v161
    v_mfma_f32_16x16x32_bf16 v[168:171], a[124:127], a[28:31], v[168:171]
    ds_read_b64_tr_b16 a[166:167], v221 offset:20480
    ds_read_b64_tr_b16 a[196:197], v221 offset:24576
    v_mfma_f32_16x16x32_bf16 v[172:175], a[140:143], a[28:31], v[196:199]
    v_exp_f32 v162, v162
    v_mfma_f32_16x16x32_bf16 v[172:175], a[136:139], a[24:27], v[172:175]
    ds_read_b64_tr_b16 a[198:199], v221 offset:28672
    ds_read_b64_tr_b16 a[200:201], v222 offset:24576
    v_mfma_f32_16x16x32_bf16 v[172:175], a[132:135], a[20:23], v[172:175]
    v_exp_f32 v163, v163
    v_mfma_f32_16x16x32_bf16 v[172:175], a[128:131], a[16:19], v[172:175]
    s_waitcnt lgkmcnt(14)
    v_cvt_pk_bf16_f32 v184, v160, v161
    v_cvt_pk_bf16_f32 v185, v162, v163
    v_mfma_f32_16x16x32_bf16 v[0:3], a[144:147], v[176:179], v[0:3]
    v_exp_f32 v164, v164
    v_mfma_f32_16x16x32_bf16 v[0:3], a[176:179], v[180:183], v[0:3]
    ds_read_b64_tr_b16 a[202:203], v222 offset:28672
    ds_read_b64_tr_b16 a[168:169], v222 offset:16384
    v_mfma_f32_16x16x32_bf16 v[4:7], a[180:183], v[180:183], v[4:7]
    s_waitcnt lgkmcnt(14)
    v_exp_f32 v165, v165
    v_mfma_f32_16x16x32_bf16 v[4:7], a[148:151], v[176:179], v[4:7]
    ds_read_b64_tr_b16 a[170:171], v222 offset:20480
    ds_read_b64_tr_b16 a[172:173], v223 offset:16384
    v_mfma_f32_16x16x32_bf16 v[8:11], a[152:155], v[176:179], v[8:11]
    s_waitcnt lgkmcnt(14)
    v_exp_f32 v166, v166
    v_mfma_f32_16x16x32_bf16 v[8:11], a[184:187], v[180:183], v[8:11]
    ds_read_b64_tr_b16 a[174:175], v223 offset:20480
    ds_read_b64_tr_b16 a[204:205], v223 offset:24576
    v_mfma_f32_16x16x32_bf16 v[12:15], a[188:191], v[180:183], v[12:15]
    s_waitcnt lgkmcnt(14)
    v_exp_f32 v167, v167
    v_mfma_f32_16x16x32_bf16 v[12:15], a[156:159], v[176:179], v[12:15]
    v_cvt_pk_bf16_f32 v186, v164, v165
    v_cvt_pk_bf16_f32 v187, v166, v167
    v_mfma_f32_16x16x32_bf16 v[160:163], a[80:83], a[32:35], v[200:203]
    v_exp_f32 v168, v168
    v_mfma_f32_16x16x32_bf16 v[160:163], a[84:87], a[36:39], v[160:163]
    ds_read_b64_tr_b16 a[206:207], v223 offset:28672
    v_lshlrev_b32 v248, 16, v232
    v_mfma_f32_16x16x32_bf16 v[160:163], a[88:91], a[40:43], v[160:163]
    v_exp_f32 v169, v169
    v_mfma_f32_16x16x32_bf16 v[160:163], a[92:95], a[44:47], v[160:163]
    v_and_b32 v249, s31, v232
    v_lshlrev_b32 v250, 16, v233
    v_mfma_f32_16x16x32_bf16 v[164:167], a[108:111], a[44:47], v[200:203]
    v_exp_f32 v170, v170
    v_mfma_f32_16x16x32_bf16 v[164:167], a[104:107], a[40:43], v[164:167]
    v_and_b32 v251, s31, v233
    v_lshlrev_b32 v252, 16, v234
    v_mfma_f32_16x16x32_bf16 v[164:167], a[100:103], a[36:39], v[164:167]
    v_exp_f32 v171, v171
    v_mfma_f32_16x16x32_bf16 v[164:167], a[96:99], a[32:35], v[164:167]
    s_waitcnt lgkmcnt(14)
    v_cvt_pk_bf16_f32 v188, v168, v169
    v_cvt_pk_bf16_f32 v189, v170, v171
    v_mfma_f32_16x16x32_bf16 v[16:19], a[192:195], v[180:183], v[16:19]
    s_waitcnt lgkmcnt(12)
    v_exp_f32 v172, v172
    v_mfma_f32_16x16x32_bf16 v[16:19], a[160:163], v[176:179], v[16:19]
    s_waitcnt lgkmcnt(10)
    v_and_b32 v253, s31, v234
    v_lshlrev_b32 v254, 16, v235
    v_mfma_f32_16x16x32_bf16 v[20:23], a[164:167], v[176:179], v[20:23]
    s_waitcnt lgkmcnt(8)
    v_exp_f32 v173, v173
    v_mfma_f32_16x16x32_bf16 v[20:23], a[196:199], v[180:183], v[20:23]
    s_waitcnt lgkmcnt(6)
    v_and_b32 v255, s31, v235
    v_mfma_f32_16x16x32_bf16 v[24:27], a[200:203], v[180:183], v[24:27]
    s_waitcnt lgkmcnt(4)
    v_exp_f32 v174, v174
    v_pk_mul_f32 v[248:249], v[248:249], s[84:85]
    v_pk_mul_f32 v[250:251], v[250:251], s[84:85]
    v_pk_mul_f32 v[252:253], v[252:253], s[84:85]
    v_pk_mul_f32 v[254:255], v[254:255], s[84:85]
    v_mfma_f32_16x16x32_bf16 v[24:27], a[168:171], v[176:179], v[24:27]
    s_waitcnt lgkmcnt(2)
    v_cvt_pk_bf16_f32 v248, v248, v249
    v_cvt_pk_bf16_f32 v249, v250, v251
    v_mfma_f32_16x16x32_bf16 v[28:31], a[172:175], v[176:179], v[28:31]
    s_waitcnt lgkmcnt(0)
    v_exp_f32 v175, v175
    v_mfma_f32_16x16x32_bf16 v[28:31], a[204:207], v[180:183], v[28:31]
    v_cvt_pk_bf16_f32 v190, v172, v173
    v_cvt_pk_bf16_f32 v191, v174, v175
    v_smfmac_f32_16x16x64_bf16 a[208:211], a[248:251], v[176:183], v231
    s_waitcnt vmcnt(9)
    s_barrier
    v_mfma_f32_16x16x32_bf16 v[168:171], a[112:115], a[32:35], v[200:203]
    s_add_u32 s24, s24, 8192
    v_exp_f32 v160, v160
    v_mfma_f32_16x16x32_bf16 v[168:171], a[116:119], a[36:39], v[168:171]
    v_cvt_pk_bf16_f32 v250, v252, v253
    v_cvt_pk_bf16_f32 v251, v254, v255
    v_mfma_f32_16x16x32_bf16 v[168:171], a[120:123], a[40:43], v[168:171]
    v_exp_f32 v161, v161
    v_mfma_f32_16x16x32_bf16 v[168:171], a[124:127], a[44:47], v[168:171]
    s_add_u32 m0, s32, 16384
    v_mfma_f32_16x16x32_bf16 v[172:175], a[140:143], a[44:47], v[200:203]
    v_exp_f32 v162, v162
    v_mfma_f32_16x16x32_bf16 v[172:175], a[136:139], a[40:43], v[172:175]
    v_mfma_f32_16x16x32_bf16 v[172:175], a[132:135], a[36:39], v[172:175]
    v_exp_f32 v163, v163
    v_mfma_f32_16x16x32_bf16 v[172:175], a[128:131], a[32:35], v[172:175]
    v_cvt_pk_bf16_f32 v176, v160, v161
    v_cvt_pk_bf16_f32 v177, v162, v163
    v_mfma_f32_16x16x32_bf16 v[32:35], a[144:147], v[184:187], v[32:35]
    v_exp_f32 v164, v164
    v_mfma_f32_16x16x32_bf16 v[32:35], a[176:179], v[188:191], v[32:35]
    buffer_load_dwordx4 v224, s[4:7], s24 offen offset:0 lds
    v_mfma_f32_16x16x32_bf16 v[36:39], a[180:183], v[188:191], v[36:39]
    v_exp_f32 v165, v165
    v_mfma_f32_16x16x32_bf16 v[36:39], a[148:151], v[184:187], v[36:39]
    buffer_load_dwordx4 v225, s[4:7], s24 offen offset:1024 lds
    v_mfma_f32_16x16x32_bf16 v[40:43], a[152:155], v[184:187], v[40:43]
    v_exp_f32 v166, v166
    v_mfma_f32_16x16x32_bf16 v[40:43], a[184:187], v[188:191], v[40:43]
    ds_write_b128 v230, v[248:251] offset:12288
    v_mfma_f32_16x16x32_bf16 v[44:47], a[188:191], v[188:191], v[44:47]
    s_add_u32 m0, s32, 57344
    v_exp_f32 v167, v167
    v_mfma_f32_16x16x32_bf16 v[44:47], a[156:159], v[184:187], v[44:47]
    v_cvt_pk_bf16_f32 v178, v164, v165
    v_cvt_pk_bf16_f32 v179, v166, v167
    v_mfma_f32_16x16x32_bf16 v[160:163], a[80:83], a[48:51], v[204:207]
    v_exp_f32 v168, v168
    v_mfma_f32_16x16x32_bf16 v[160:163], a[84:87], a[52:55], v[160:163]
    buffer_load_dwordx4 v226, s[8:11], s24 offen offset:0 lds
    v_mfma_f32_16x16x32_bf16 v[160:163], a[88:91], a[56:59], v[160:163]
    v_exp_f32 v169, v169
    v_mfma_f32_16x16x32_bf16 v[160:163], a[92:95], a[60:63], v[160:163]
    buffer_load_dwordx4 v[232:235], v228, s[12:15], s29 offen offset:0 nt
    v_mfma_f32_16x16x32_bf16 v[164:167], a[108:111], a[60:63], v[204:207]
    v_exp_f32 v170, v170
    v_mfma_f32_16x16x32_bf16 v[164:167], a[104:107], a[56:59], v[164:167]
    buffer_load_dwordx4 v227, s[8:11], s24 offen offset:1024 lds
    v_mfma_f32_16x16x32_bf16 v[164:167], a[100:103], a[52:55], v[164:167]
    v_exp_f32 v171, v171
    v_mfma_f32_16x16x32_bf16 v[164:167], a[96:99], a[48:51], v[164:167]
    v_cvt_pk_bf16_f32 v180, v168, v169
    v_cvt_pk_bf16_f32 v181, v170, v171
    v_mfma_f32_16x16x32_bf16 v[48:51], a[192:195], v[188:191], v[48:51]
    v_exp_f32 v172, v172
    v_mfma_f32_16x16x32_bf16 v[48:51], a[160:163], v[184:187], v[48:51]
    s_add_u32 s24, s24, 8192
    v_xor_b32 v229, 64, v230
    v_lshlrev_b32 v248, 16, v236
    v_mfma_f32_16x16x32_bf16 v[52:55], a[164:167], v[184:187], v[52:55]
    v_exp_f32 v173, v173
    v_mfma_f32_16x16x32_bf16 v[52:55], a[196:199], v[188:191], v[52:55]
    ds_read_b128 a[236:239], v229 offset:13312
    v_and_b32 v249, s31, v236
    v_mfma_f32_16x16x32_bf16 v[56:59], a[200:203], v[188:191], v[56:59]
    v_exp_f32 v174, v174
    v_mfma_f32_16x16x32_bf16 v[56:59], a[168:171], v[184:187], v[56:59]
    s_add_u32 m0, s32, 24576
    v_lshlrev_b32 v250, 16, v237
    v_and_b32 v251, s31, v237
    v_mfma_f32_16x16x32_bf16 v[60:63], a[172:175], v[184:187], v[60:63]
    v_exp_f32 v175, v175
    v_mfma_f32_16x16x32_bf16 v[60:63], a[204:207], v[188:191], v[60:63]
    v_cvt_pk_bf16_f32 v182, v172, v173
    v_cvt_pk_bf16_f32 v183, v174, v175
    v_smfmac_f32_16x16x64_bf16 a[212:215], a[248:251], v[184:191], v231
    v_lshlrev_b32 v252, 16, v238
    v_mfma_f32_16x16x32_bf16 v[168:171], a[112:115], a[48:51], v[204:207]
    v_exp_f32 v160, v160
    v_mfma_f32_16x16x32_bf16 v[168:171], a[116:119], a[52:55], v[168:171]
    buffer_load_dwordx4 v224, s[4:7], s24 offen offset:0 lds
    v_mfma_f32_16x16x32_bf16 v[168:171], a[120:123], a[56:59], v[168:171]
    v_exp_f32 v161, v161
    v_mfma_f32_16x16x32_bf16 v[168:171], a[124:127], a[60:63], v[168:171]
    v_and_b32 v253, s31, v238
    v_lshlrev_b32 v254, 16, v239
    v_mfma_f32_16x16x32_bf16 v[172:175], a[140:143], a[60:63], v[204:207]
    v_exp_f32 v162, v162
    v_mfma_f32_16x16x32_bf16 v[172:175], a[136:139], a[56:59], v[172:175]
    v_and_b32 v255, s31, v239
    v_mfma_f32_16x16x32_bf16 v[172:175], a[132:135], a[52:55], v[172:175]
    v_exp_f32 v163, v163
    v_pk_mul_f32 v[248:249], v[248:249], s[84:85]
    v_pk_mul_f32 v[250:251], v[250:251], s[84:85]
    v_pk_mul_f32 v[252:253], v[252:253], s[84:85]
    v_pk_mul_f32 v[254:255], v[254:255], s[84:85]
    v_mfma_f32_16x16x32_bf16 v[172:175], a[128:131], a[48:51], v[172:175]
    v_cvt_pk_bf16_f32 v184, v160, v161
    v_cvt_pk_bf16_f32 v185, v162, v163
    v_mfma_f32_16x16x32_bf16 v[64:67], a[144:147], v[176:179], v[64:67]
    v_exp_f32 v164, v164
    v_mfma_f32_16x16x32_bf16 v[64:67], a[176:179], v[180:183], v[64:67]
    buffer_load_dwordx4 v225, s[4:7], s24 offen offset:1024 lds
    v_mfma_f32_16x16x32_bf16 v[68:71], a[180:183], v[180:183], v[68:71]
    s_add_u32 m0, s32, 65536
    v_exp_f32 v165, v165
    v_mfma_f32_16x16x32_bf16 v[68:71], a[148:151], v[176:179], v[68:71]
    s_waitcnt lgkmcnt(0)
    buffer_store_dwordx4 a[236:239], v228, s[16:19], s28 offen offset:1024 nt
    v_mfma_f32_16x16x32_bf16 v[72:75], a[152:155], v[176:179], v[72:75]
    v_exp_f32 v166, v166
    v_mfma_f32_16x16x32_bf16 v[72:75], a[184:187], v[180:183], v[72:75]
    v_cvt_pk_bf16_f32 v248, v248, v249
    v_cvt_pk_bf16_f32 v249, v250, v251
    v_mfma_f32_16x16x32_bf16 v[76:79], a[188:191], v[180:183], v[76:79]
    v_exp_f32 v167, v167
    v_mfma_f32_16x16x32_bf16 v[76:79], a[156:159], v[176:179], v[76:79]
    v_cvt_pk_bf16_f32 v186, v164, v165
    v_cvt_pk_bf16_f32 v187, v166, v167
    v_mfma_f32_16x16x32_bf16 v[160:163], a[80:83], a[64:67], v[208:211]
    v_exp_f32 v168, v168
    v_mfma_f32_16x16x32_bf16 v[160:163], a[84:87], a[68:71], v[160:163]
    buffer_load_dwordx4 v226, s[8:11], s24 offen offset:0 lds
    v_mfma_f32_16x16x32_bf16 v[160:163], a[88:91], a[72:75], v[160:163]
    v_exp_f32 v169, v169
    v_mfma_f32_16x16x32_bf16 v[160:163], a[92:95], a[76:79], v[160:163]
    v_cvt_pk_bf16_f32 v250, v252, v253
    v_cvt_pk_bf16_f32 v251, v254, v255
    v_mfma_f32_16x16x32_bf16 v[164:167], a[108:111], a[76:79], v[208:211]
    v_exp_f32 v170, v170
    v_mfma_f32_16x16x32_bf16 v[164:167], a[104:107], a[72:75], v[164:167]
    buffer_load_dwordx4 v227, s[8:11], s24 offen offset:1024 lds
    v_mfma_f32_16x16x32_bf16 v[164:167], a[100:103], a[68:71], v[164:167]
    v_exp_f32 v171, v171
    v_mfma_f32_16x16x32_bf16 v[164:167], a[96:99], a[64:67], v[164:167]
    v_cvt_pk_bf16_f32 v188, v168, v169
    v_cvt_pk_bf16_f32 v189, v170, v171
    v_mfma_f32_16x16x32_bf16 v[80:83], a[192:195], v[180:183], v[80:83]
    v_exp_f32 v172, v172
    v_mfma_f32_16x16x32_bf16 v[80:83], a[160:163], v[176:179], v[80:83]
    ds_read_b128 a[80:83], v212 offset:32768
    v_mfma_f32_16x16x32_bf16 v[84:87], a[164:167], v[176:179], v[84:87]
    v_exp_f32 v173, v173
    v_mfma_f32_16x16x32_bf16 v[84:87], a[196:199], v[180:183], v[84:87]
    ds_read_b128 a[84:87], v213 offset:32768
    v_mfma_f32_16x16x32_bf16 v[88:91], a[200:203], v[180:183], v[88:91]
    v_exp_f32 v174, v174
    v_mfma_f32_16x16x32_bf16 v[88:91], a[168:171], v[176:179], v[88:91]
    ds_read_b128 a[88:91], v214 offset:32768
    ds_write_b128 v229, v[248:251] offset:13312
    v_mfma_f32_16x16x32_bf16 v[92:95], a[172:175], v[176:179], v[92:95]
    v_exp_f32 v175, v175
    v_mfma_f32_16x16x32_bf16 v[92:95], a[204:207], v[180:183], v[92:95]
    v_cvt_pk_bf16_f32 v190, v172, v173
    v_cvt_pk_bf16_f32 v191, v174, v175
    v_smfmac_f32_16x16x64_bf16 a[216:219], a[248:251], v[176:183], v231
    ds_read_b128 a[92:95], v215 offset:32768
    v_mfma_f32_16x16x32_bf16 v[168:171], a[112:115], a[64:67], v[208:211]
    v_exp_f32 v160, v160
    v_mfma_f32_16x16x32_bf16 v[168:171], a[116:119], a[68:71], v[168:171]
    ds_read_b128 a[96:99], v212 offset:36864
    v_mfma_f32_16x16x32_bf16 v[168:171], a[120:123], a[72:75], v[168:171]
    v_exp_f32 v161, v161
    v_mfma_f32_16x16x32_bf16 v[168:171], a[124:127], a[76:79], v[168:171]
    ds_read_b128 a[100:103], v213 offset:36864
    v_mfma_f32_16x16x32_bf16 v[172:175], a[140:143], a[76:79], v[208:211]
    v_exp_f32 v162, v162
    v_mfma_f32_16x16x32_bf16 v[172:175], a[136:139], a[72:75], v[172:175]
    ds_read_b128 a[104:107], v214 offset:36864
    v_mfma_f32_16x16x32_bf16 v[172:175], a[132:135], a[68:71], v[172:175]
    v_exp_f32 v163, v163
    v_mfma_f32_16x16x32_bf16 v[172:175], a[128:131], a[64:67], v[172:175]
    s_waitcnt vmcnt(15)
    v_cvt_pk_bf16_f32 v176, v160, v161
    v_cvt_pk_bf16_f32 v177, v162, v163
    v_mfma_f32_16x16x32_bf16 v[96:99], a[144:147], v[184:187], v[96:99]
    v_exp_f32 v164, v164
    v_mfma_f32_16x16x32_bf16 v[96:99], a[176:179], v[188:191], v[96:99]
    ds_read_b128 a[108:111], v215 offset:36864
    ds_read_b128 a[112:115], v212 offset:0
    v_mfma_f32_16x16x32_bf16 v[100:103], a[180:183], v[188:191], v[100:103]
    v_exp_f32 v165, v165
    v_mfma_f32_16x16x32_bf16 v[100:103], a[148:151], v[184:187], v[100:103]
    ds_read_b128 a[116:119], v213 offset:0
    v_xor_b32 v229, 128, v230
    v_mfma_f32_16x16x32_bf16 v[104:107], a[152:155], v[184:187], v[104:107]
    v_exp_f32 v166, v166
    v_mfma_f32_16x16x32_bf16 v[104:107], a[184:187], v[188:191], v[104:107]
    ds_read_b128 a[120:123], v214 offset:0
    ds_read_b128 a[240:243], v229 offset:14336
    v_mfma_f32_16x16x32_bf16 v[108:111], a[188:191], v[188:191], v[108:111]
    v_exp_f32 v167, v167
    v_mfma_f32_16x16x32_bf16 v[108:111], a[156:159], v[184:187], v[108:111]
    s_waitcnt lgkmcnt(4)
    v_cvt_pk_bf16_f32 v178, v164, v165
    v_cvt_pk_bf16_f32 v179, v166, v167
    v_mfma_f32_16x16x32_bf16 v[160:163], a[80:83], a[0:3], v[192:195]
    v_exp_f32 v168, v168
    v_mfma_f32_16x16x32_bf16 v[160:163], a[84:87], a[4:7], v[160:163]
    ds_read_b128 a[124:127], v215 offset:0
    ds_read_b128 a[128:131], v212 offset:4096
    v_mfma_f32_16x16x32_bf16 v[160:163], a[88:91], a[8:11], v[160:163]
    v_exp_f32 v169, v169
    v_mfma_f32_16x16x32_bf16 v[160:163], a[92:95], a[12:15], v[160:163]
    ds_read_b128 a[132:135], v213 offset:4096
    v_lshlrev_b32 v248, 16, v240
    v_mfma_f32_16x16x32_bf16 v[164:167], a[108:111], a[12:15], v[192:195]
    v_exp_f32 v170, v170
    v_mfma_f32_16x16x32_bf16 v[164:167], a[104:107], a[8:11], v[164:167]
    buffer_load_dwordx4 v[236:239], v228, s[12:15], s29 offen offset:1024 nt
    v_mfma_f32_16x16x32_bf16 v[164:167], a[100:103], a[4:7], v[164:167]
    v_exp_f32 v171, v171
    v_mfma_f32_16x16x32_bf16 v[164:167], a[96:99], a[0:3], v[164:167]
    v_cvt_pk_bf16_f32 v180, v168, v169
    v_cvt_pk_bf16_f32 v181, v170, v171
    v_mfma_f32_16x16x32_bf16 v[112:115], a[192:195], v[188:191], v[112:115]
    v_exp_f32 v172, v172
    v_mfma_f32_16x16x32_bf16 v[112:115], a[160:163], v[184:187], v[112:115]
    ds_read_b128 a[136:139], v214 offset:4096
    ds_read_b128 a[140:143], v215 offset:4096
    v_mfma_f32_16x16x32_bf16 v[116:119], a[164:167], v[184:187], v[116:119]
    v_exp_f32 v173, v173
    v_mfma_f32_16x16x32_bf16 v[116:119], a[196:199], v[188:191], v[116:119]
    s_waitcnt lgkmcnt(5)
    buffer_store_dwordx4 a[240:243], v228, s[16:19], s28 offen offset:2048 nt
    v_mfma_f32_16x16x32_bf16 v[120:123], a[200:203], v[188:191], v[120:123]
    v_exp_f32 v174, v174
    v_mfma_f32_16x16x32_bf16 v[120:123], a[168:171], v[184:187], v[120:123]
    v_and_b32 v249, s31, v240
    v_lshlrev_b32 v250, 16, v241
    v_mfma_f32_16x16x32_bf16 v[124:127], a[172:175], v[184:187], v[124:127]
    v_exp_f32 v175, v175
    v_mfma_f32_16x16x32_bf16 v[124:127], a[204:207], v[188:191], v[124:127]
    v_cvt_pk_bf16_f32 v182, v172, v173
    v_cvt_pk_bf16_f32 v183, v174, v175
    v_smfmac_f32_16x16x64_bf16 a[220:223], a[248:251], v[184:191], v231
    s_waitcnt lgkmcnt(0)
    v_and_b32 v251, s31, v241
    v_mfma_f32_16x16x32_bf16 v[168:171], a[112:115], a[0:3], v[192:195]
    v_exp_f32 v160, v160
    v_mfma_f32_16x16x32_bf16 v[168:171], a[116:119], a[4:7], v[168:171]
    v_lshlrev_b32 v252, 16, v242
    v_and_b32 v253, s31, v242
    v_mfma_f32_16x16x32_bf16 v[168:171], a[120:123], a[8:11], v[168:171]
    v_exp_f32 v161, v161
    v_mfma_f32_16x16x32_bf16 v[168:171], a[124:127], a[12:15], v[168:171]
    v_lshlrev_b32 v254, 16, v243
    v_and_b32 v255, s31, v243
    v_pk_mul_f32 v[248:249], v[248:249], s[84:85]
    v_pk_mul_f32 v[250:251], v[250:251], s[84:85]
    v_pk_mul_f32 v[252:253], v[252:253], s[84:85]
    v_pk_mul_f32 v[254:255], v[254:255], s[84:85]
    v_mfma_f32_16x16x32_bf16 v[172:175], a[140:143], a[12:15], v[192:195]
    v_exp_f32 v162, v162
    v_mfma_f32_16x16x32_bf16 v[172:175], a[136:139], a[8:11], v[172:175]
    v_cvt_pk_bf16_f32 v248, v248, v249
    v_cvt_pk_bf16_f32 v249, v250, v251
    v_mfma_f32_16x16x32_bf16 v[172:175], a[132:135], a[4:7], v[172:175]
    v_exp_f32 v163, v163
    v_mfma_f32_16x16x32_bf16 v[172:175], a[128:131], a[0:3], v[172:175]
    v_cvt_pk_bf16_f32 v184, v160, v161
    v_cvt_pk_bf16_f32 v185, v162, v163
    v_mfma_f32_16x16x32_bf16 v[128:131], a[144:147], v[176:179], v[128:131]
    v_exp_f32 v164, v164
    v_mfma_f32_16x16x32_bf16 v[128:131], a[176:179], v[180:183], v[128:131]
    ds_read_b64_tr_b16 a[144:145], v216 offset:32768
    ds_read_b64_tr_b16 a[146:147], v216 offset:36864
    v_mfma_f32_16x16x32_bf16 v[132:135], a[180:183], v[180:183], v[132:135]
    v_exp_f32 v165, v165
    v_mfma_f32_16x16x32_bf16 v[132:135], a[148:151], v[176:179], v[132:135]
    ds_read_b64_tr_b16 a[176:177], v216 offset:0
    ds_read_b64_tr_b16 a[178:179], v216 offset:4096
    v_mfma_f32_16x16x32_bf16 v[136:139], a[152:155], v[176:179], v[136:139]
    v_exp_f32 v166, v166
    v_mfma_f32_16x16x32_bf16 v[136:139], a[184:187], v[180:183], v[136:139]
    ds_read_b64_tr_b16 a[180:181], v217 offset:0
    ds_read_b64_tr_b16 a[182:183], v217 offset:4096
    v_mfma_f32_16x16x32_bf16 v[140:143], a[188:191], v[180:183], v[140:143]
    v_exp_f32 v167, v167
    v_mfma_f32_16x16x32_bf16 v[140:143], a[156:159], v[176:179], v[140:143]
    v_cvt_pk_bf16_f32 v186, v164, v165
    v_cvt_pk_bf16_f32 v187, v166, v167
    v_mfma_f32_16x16x32_bf16 v[160:163], a[80:83], a[16:19], v[196:199]
    v_exp_f32 v168, v168
    v_mfma_f32_16x16x32_bf16 v[160:163], a[84:87], a[20:23], v[160:163]
    ds_read_b64_tr_b16 a[148:149], v217 offset:32768
    ds_read_b64_tr_b16 a[150:151], v217 offset:36864
    v_mfma_f32_16x16x32_bf16 v[160:163], a[88:91], a[24:27], v[160:163]
    v_exp_f32 v169, v169
    v_mfma_f32_16x16x32_bf16 v[160:163], a[92:95], a[28:31], v[160:163]
    ds_read_b64_tr_b16 a[152:153], v218 offset:32768
    ds_read_b64_tr_b16 a[154:155], v218 offset:36864
    v_mfma_f32_16x16x32_bf16 v[164:167], a[108:111], a[28:31], v[196:199]
    v_exp_f32 v170, v170
    v_mfma_f32_16x16x32_bf16 v[164:167], a[104:107], a[24:27], v[164:167]
    ds_read_b64_tr_b16 a[184:185], v218 offset:0
    ds_read_b64_tr_b16 a[186:187], v218 offset:4096
    v_mfma_f32_16x16x32_bf16 v[164:167], a[100:103], a[20:23], v[164:167]
    v_exp_f32 v171, v171
    v_mfma_f32_16x16x32_bf16 v[164:167], a[96:99], a[16:19], v[164:167]
    v_cvt_pk_bf16_f32 v188, v168, v169
    v_cvt_pk_bf16_f32 v189, v170, v171
    v_mfma_f32_16x16x32_bf16 v[144:147], a[192:195], v[180:183], v[144:147]
    v_exp_f32 v172, v172
    v_mfma_f32_16x16x32_bf16 v[144:147], a[160:163], v[176:179], v[144:147]
    ds_read_b64_tr_b16 a[188:189], v219 offset:0
    ds_read_b64_tr_b16 a[190:191], v219 offset:4096
    v_mfma_f32_16x16x32_bf16 v[148:151], a[164:167], v[176:179], v[148:151]
    v_exp_f32 v173, v173
    v_mfma_f32_16x16x32_bf16 v[148:151], a[196:199], v[180:183], v[148:151]
    ds_read_b64_tr_b16 a[156:157], v219 offset:32768
    ds_read_b64_tr_b16 a[158:159], v219 offset:36864
    v_mfma_f32_16x16x32_bf16 v[152:155], a[200:203], v[180:183], v[152:155]
    v_exp_f32 v174, v174
    v_mfma_f32_16x16x32_bf16 v[152:155], a[168:171], v[176:179], v[152:155]
    ds_read_b64_tr_b16 a[192:193], v220 offset:0
    ds_read_b64_tr_b16 a[194:195], v220 offset:4096
    v_mfma_f32_16x16x32_bf16 v[156:159], a[172:175], v[176:179], v[156:159]
    v_exp_f32 v175, v175
    v_mfma_f32_16x16x32_bf16 v[156:159], a[204:207], v[180:183], v[156:159]
    v_cvt_pk_bf16_f32 v190, v172, v173
    v_cvt_pk_bf16_f32 v191, v174, v175
    v_smfmac_f32_16x16x64_bf16 a[224:227], a[248:251], v[176:183], v231
    ds_read_b64_tr_b16 a[160:161], v220 offset:32768
    v_mfma_f32_16x16x32_bf16 v[168:171], a[112:115], a[16:19], v[196:199]
    v_exp_f32 v160, v160
    v_mfma_f32_16x16x32_bf16 v[168:171], a[116:119], a[20:23], v[168:171]
    ds_read_b64_tr_b16 a[162:163], v220 offset:36864
    ds_read_b64_tr_b16 a[164:165], v221 offset:32768
    v_mfma_f32_16x16x32_bf16 v[168:171], a[120:123], a[24:27], v[168:171]
    v_exp_f32 v161, v161
    v_mfma_f32_16x16x32_bf16 v[168:171], a[124:127], a[28:31], v[168:171]
    ds_read_b64_tr_b16 a[166:167], v221 offset:36864
    ds_read_b64_tr_b16 a[196:197], v221 offset:0
    v_mfma_f32_16x16x32_bf16 v[172:175], a[140:143], a[28:31], v[196:199]
    v_exp_f32 v162, v162
    v_mfma_f32_16x16x32_bf16 v[172:175], a[136:139], a[24:27], v[172:175]
    ds_read_b64_tr_b16 a[198:199], v221 offset:4096
    ds_read_b64_tr_b16 a[200:201], v222 offset:0
    v_mfma_f32_16x16x32_bf16 v[172:175], a[132:135], a[20:23], v[172:175]
    v_exp_f32 v163, v163
    v_mfma_f32_16x16x32_bf16 v[172:175], a[128:131], a[16:19], v[172:175]
    s_waitcnt lgkmcnt(14)
    v_cvt_pk_bf16_f32 v176, v160, v161
    v_cvt_pk_bf16_f32 v177, v162, v163
    v_mfma_f32_16x16x32_bf16 v[0:3], a[144:147], v[184:187], v[0:3]
    v_exp_f32 v164, v164
    v_mfma_f32_16x16x32_bf16 v[0:3], a[176:179], v[188:191], v[0:3]
    ds_read_b64_tr_b16 a[202:203], v222 offset:4096
    ds_read_b64_tr_b16 a[168:169], v222 offset:32768
    v_mfma_f32_16x16x32_bf16 v[4:7], a[180:183], v[188:191], v[4:7]
    s_waitcnt lgkmcnt(14)
    v_exp_f32 v165, v165
    v_mfma_f32_16x16x32_bf16 v[4:7], a[148:151], v[184:187], v[4:7]
    ds_read_b64_tr_b16 a[170:171], v222 offset:36864
    ds_read_b64_tr_b16 a[172:173], v223 offset:32768
    v_mfma_f32_16x16x32_bf16 v[8:11], a[152:155], v[184:187], v[8:11]
    s_waitcnt lgkmcnt(14)
    v_exp_f32 v166, v166
    v_mfma_f32_16x16x32_bf16 v[8:11], a[184:187], v[188:191], v[8:11]
    ds_read_b64_tr_b16 a[174:175], v223 offset:36864
    ds_read_b64_tr_b16 a[204:205], v223 offset:0
    v_mfma_f32_16x16x32_bf16 v[12:15], a[188:191], v[188:191], v[12:15]
    s_waitcnt lgkmcnt(14)
    v_exp_f32 v167, v167
    v_mfma_f32_16x16x32_bf16 v[12:15], a[156:159], v[184:187], v[12:15]
    v_cvt_pk_bf16_f32 v178, v164, v165
    v_cvt_pk_bf16_f32 v179, v166, v167
    v_mfma_f32_16x16x32_bf16 v[160:163], a[80:83], a[32:35], v[200:203]
    v_exp_f32 v168, v168
    v_mfma_f32_16x16x32_bf16 v[160:163], a[84:87], a[36:39], v[160:163]
    ds_read_b64_tr_b16 a[206:207], v223 offset:4096
    v_cvt_pk_bf16_f32 v250, v252, v253
    v_cvt_pk_bf16_f32 v251, v254, v255
    v_mfma_f32_16x16x32_bf16 v[160:163], a[88:91], a[40:43], v[160:163]
    v_exp_f32 v169, v169
    v_mfma_f32_16x16x32_bf16 v[160:163], a[92:95], a[44:47], v[160:163]
    ds_write_b128 v229, v[248:251] offset:14336
    v_mfma_f32_16x16x32_bf16 v[164:167], a[108:111], a[44:47], v[200:203]
    s_waitcnt vmcnt(13)
    v_exp_f32 v170, v170
    v_mfma_f32_16x16x32_bf16 v[164:167], a[104:107], a[40:43], v[164:167]
    buffer_load_dwordx4 v[240:243], v228, s[12:15], s29 offen offset:2048 nt
    v_mfma_f32_16x16x32_bf16 v[164:167], a[100:103], a[36:39], v[164:167]
    v_exp_f32 v171, v171
    v_mfma_f32_16x16x32_bf16 v[164:167], a[96:99], a[32:35], v[164:167]
    s_waitcnt lgkmcnt(14)
    v_cvt_pk_bf16_f32 v180, v168, v169
    v_cvt_pk_bf16_f32 v181, v170, v171
    v_mfma_f32_16x16x32_bf16 v[16:19], a[192:195], v[188:191], v[16:19]
    s_waitcnt lgkmcnt(13)
    v_exp_f32 v172, v172
    v_mfma_f32_16x16x32_bf16 v[16:19], a[160:163], v[184:187], v[16:19]
    s_waitcnt lgkmcnt(11)
    v_xor_b32 v229, 192, v230
    v_lshlrev_b32 v248, 16, v244
    v_mfma_f32_16x16x32_bf16 v[20:23], a[164:167], v[184:187], v[20:23]
    s_waitcnt lgkmcnt(9)
    v_exp_f32 v173, v173
    v_mfma_f32_16x16x32_bf16 v[20:23], a[196:199], v[188:191], v[20:23]
    s_waitcnt lgkmcnt(7)
    ds_read_b128 a[244:247], v229 offset:15360
    v_and_b32 v249, s31, v244
    v_mfma_f32_16x16x32_bf16 v[24:27], a[200:203], v[188:191], v[24:27]
    s_waitcnt lgkmcnt(6)
    v_exp_f32 v174, v174
    v_mfma_f32_16x16x32_bf16 v[24:27], a[168:171], v[184:187], v[24:27]
    s_waitcnt lgkmcnt(4)
    v_lshlrev_b32 v250, 16, v245
    v_and_b32 v251, s31, v245
    v_mfma_f32_16x16x32_bf16 v[28:31], a[172:175], v[184:187], v[28:31]
    s_waitcnt lgkmcnt(2)
    v_exp_f32 v175, v175
    v_mfma_f32_16x16x32_bf16 v[28:31], a[204:207], v[188:191], v[28:31]
    v_cvt_pk_bf16_f32 v182, v172, v173
    v_cvt_pk_bf16_f32 v183, v174, v175
    v_smfmac_f32_16x16x64_bf16 a[208:211], a[248:251], v[184:191], v231
    s_waitcnt vmcnt(8)
    s_barrier
    v_mfma_f32_16x16x32_bf16 v[168:171], a[112:115], a[32:35], v[200:203]
    s_add_u32 s24, s24, 8192
    v_exp_f32 v160, v160
    v_mfma_f32_16x16x32_bf16 v[168:171], a[116:119], a[36:39], v[168:171]
    v_lshlrev_b32 v252, 16, v246
    v_and_b32 v253, s31, v246
    v_mfma_f32_16x16x32_bf16 v[168:171], a[120:123], a[40:43], v[168:171]
    v_exp_f32 v161, v161
    v_mfma_f32_16x16x32_bf16 v[168:171], a[124:127], a[44:47], v[168:171]
    s_add_u32 m0, s32, 32768
    v_lshlrev_b32 v254, 16, v247
    v_and_b32 v255, s31, v247
    v_pk_mul_f32 v[248:249], v[248:249], s[84:85]
    v_pk_mul_f32 v[250:251], v[250:251], s[84:85]
    v_pk_mul_f32 v[252:253], v[252:253], s[84:85]
    v_pk_mul_f32 v[254:255], v[254:255], s[84:85]
    v_mfma_f32_16x16x32_bf16 v[172:175], a[140:143], a[44:47], v[200:203]
    v_exp_f32 v162, v162
    v_mfma_f32_16x16x32_bf16 v[172:175], a[136:139], a[40:43], v[172:175]
    v_cvt_pk_bf16_f32 v248, v248, v249
    v_cvt_pk_bf16_f32 v249, v250, v251
    v_mfma_f32_16x16x32_bf16 v[172:175], a[132:135], a[36:39], v[172:175]
    v_exp_f32 v163, v163
    v_mfma_f32_16x16x32_bf16 v[172:175], a[128:131], a[32:35], v[172:175]
    v_cvt_pk_bf16_f32 v184, v160, v161
    v_cvt_pk_bf16_f32 v185, v162, v163
    v_mfma_f32_16x16x32_bf16 v[32:35], a[144:147], v[176:179], v[32:35]
    v_exp_f32 v164, v164
    v_mfma_f32_16x16x32_bf16 v[32:35], a[176:179], v[180:183], v[32:35]
    buffer_load_dwordx4 v224, s[4:7], s24 offen offset:0 lds
    v_mfma_f32_16x16x32_bf16 v[36:39], a[180:183], v[180:183], v[36:39]
    v_exp_f32 v165, v165
    v_mfma_f32_16x16x32_bf16 v[36:39], a[148:151], v[176:179], v[36:39]
    buffer_load_dwordx4 v225, s[4:7], s24 offen offset:1024 lds
    v_mfma_f32_16x16x32_bf16 v[40:43], a[152:155], v[176:179], v[40:43]
    v_exp_f32 v166, v166
    v_mfma_f32_16x16x32_bf16 v[40:43], a[184:187], v[180:183], v[40:43]
    s_waitcnt lgkmcnt(0)
    buffer_store_dwordx4 a[244:247], v228, s[16:19], s28 offen offset:3072 nt
    v_mfma_f32_16x16x32_bf16 v[44:47], a[188:191], v[180:183], v[44:47]
    s_add_u32 m0, s32, 73728
    v_exp_f32 v167, v167
    v_mfma_f32_16x16x32_bf16 v[44:47], a[156:159], v[176:179], v[44:47]
    v_cvt_pk_bf16_f32 v186, v164, v165
    v_cvt_pk_bf16_f32 v187, v166, v167
    v_mfma_f32_16x16x32_bf16 v[160:163], a[80:83], a[48:51], v[204:207]
    v_exp_f32 v168, v168
    v_mfma_f32_16x16x32_bf16 v[160:163], a[84:87], a[52:55], v[160:163]
    buffer_load_dwordx4 v226, s[8:11], s24 offen offset:0 lds
    v_mfma_f32_16x16x32_bf16 v[160:163], a[88:91], a[56:59], v[160:163]
    v_exp_f32 v169, v169
    v_mfma_f32_16x16x32_bf16 v[160:163], a[92:95], a[60:63], v[160:163]
    v_cvt_pk_bf16_f32 v250, v252, v253
    v_cvt_pk_bf16_f32 v251, v254, v255
    v_mfma_f32_16x16x32_bf16 v[164:167], a[108:111], a[60:63], v[204:207]
    v_exp_f32 v170, v170
    v_mfma_f32_16x16x32_bf16 v[164:167], a[104:107], a[56:59], v[164:167]
    buffer_load_dwordx4 v227, s[8:11], s24 offen offset:1024 lds
    v_mfma_f32_16x16x32_bf16 v[164:167], a[100:103], a[52:55], v[164:167]
    v_exp_f32 v171, v171
    v_mfma_f32_16x16x32_bf16 v[164:167], a[96:99], a[48:51], v[164:167]
    v_cvt_pk_bf16_f32 v188, v168, v169
    v_cvt_pk_bf16_f32 v189, v170, v171
    v_mfma_f32_16x16x32_bf16 v[48:51], a[192:195], v[180:183], v[48:51]
    v_exp_f32 v172, v172
    v_mfma_f32_16x16x32_bf16 v[48:51], a[160:163], v[176:179], v[48:51]
    s_mov_b32 s24, s34
    s_mov_b32 s6, s38
    s_mov_b32 s10, s38
    v_mfma_f32_16x16x32_bf16 v[52:55], a[164:167], v[176:179], v[52:55]
    v_exp_f32 v173, v173
    v_mfma_f32_16x16x32_bf16 v[52:55], a[196:199], v[180:183], v[52:55]
    v_mfma_f32_16x16x32_bf16 v[56:59], a[200:203], v[180:183], v[56:59]
    v_exp_f32 v174, v174
    v_mfma_f32_16x16x32_bf16 v[56:59], a[168:171], v[176:179], v[56:59]
    s_add_u32 m0, s32, 0
    ds_write_b128 v229, v[248:251] offset:15360
    v_mfma_f32_16x16x32_bf16 v[60:63], a[172:175], v[176:179], v[60:63]
    v_exp_f32 v175, v175
    v_mfma_f32_16x16x32_bf16 v[60:63], a[204:207], v[180:183], v[60:63]
    v_cvt_pk_bf16_f32 v190, v172, v173
    v_cvt_pk_bf16_f32 v191, v174, v175
    v_smfmac_f32_16x16x64_bf16 a[212:215], a[248:251], v[176:183], v231
    v_mfma_f32_16x16x32_bf16 v[168:171], a[112:115], a[48:51], v[204:207]
    v_exp_f32 v160, v160
    v_mfma_f32_16x16x32_bf16 v[168:171], a[116:119], a[52:55], v[168:171]
    buffer_load_dwordx4 v224, s[4:7], s24 offen offset:0 lds
    v_mfma_f32_16x16x32_bf16 v[168:171], a[120:123], a[56:59], v[168:171]
    v_exp_f32 v161, v161
    v_mfma_f32_16x16x32_bf16 v[168:171], a[124:127], a[60:63], v[168:171]
    buffer_load_dwordx4 v[244:247], v228, s[12:15], s29 offen offset:3072 nt
    v_mfma_f32_16x16x32_bf16 v[172:175], a[140:143], a[60:63], v[204:207]
    v_exp_f32 v162, v162
    v_mfma_f32_16x16x32_bf16 v[172:175], a[136:139], a[56:59], v[172:175]
    v_mfma_f32_16x16x32_bf16 v[172:175], a[132:135], a[52:55], v[172:175]
    v_exp_f32 v163, v163
    v_mfma_f32_16x16x32_bf16 v[172:175], a[128:131], a[48:51], v[172:175]
    v_cvt_pk_bf16_f32 v176, v160, v161
    v_cvt_pk_bf16_f32 v177, v162, v163
    v_mfma_f32_16x16x32_bf16 v[64:67], a[144:147], v[184:187], v[64:67]
    v_exp_f32 v164, v164
    v_mfma_f32_16x16x32_bf16 v[64:67], a[176:179], v[188:191], v[64:67]
    buffer_load_dwordx4 v225, s[4:7], s24 offen offset:1024 lds
    v_mfma_f32_16x16x32_bf16 v[68:71], a[180:183], v[188:191], v[68:71]
    s_add_u32 m0, s32, 40960
    v_exp_f32 v165, v165
    v_mfma_f32_16x16x32_bf16 v[68:71], a[148:151], v[184:187], v[68:71]
    ds_read_b128 a[232:235], v230 offset:16384
    v_lshlrev_b32 v248, 16, v232
    v_mfma_f32_16x16x32_bf16 v[72:75], a[152:155], v[184:187], v[72:75]
    v_exp_f32 v166, v166
    v_mfma_f32_16x16x32_bf16 v[72:75], a[184:187], v[188:191], v[72:75]
    v_and_b32 v249, s31, v232
    v_lshlrev_b32 v250, 16, v233
    v_mfma_f32_16x16x32_bf16 v[76:79], a[188:191], v[188:191], v[76:79]
    v_exp_f32 v167, v167
    v_mfma_f32_16x16x32_bf16 v[76:79], a[156:159], v[184:187], v[76:79]
    v_cvt_pk_bf16_f32 v178, v164, v165
    v_cvt_pk_bf16_f32 v179, v166, v167
    v_mfma_f32_16x16x32_bf16 v[160:163], a[80:83], a[64:67], v[208:211]
    v_exp_f32 v168, v168
    v_mfma_f32_16x16x32_bf16 v[160:163], a[84:87], a[68:71], v[160:163]
    buffer_load_dwordx4 v226, s[8:11], s24 offen offset:0 lds
    v_mfma_f32_16x16x32_bf16 v[160:163], a[88:91], a[72:75], v[160:163]
    v_exp_f32 v169, v169
    v_mfma_f32_16x16x32_bf16 v[160:163], a[92:95], a[76:79], v[160:163]
    v_and_b32 v251, s31, v233
    v_lshlrev_b32 v252, 16, v234
    v_mfma_f32_16x16x32_bf16 v[164:167], a[108:111], a[76:79], v[208:211]
    v_exp_f32 v170, v170
    v_mfma_f32_16x16x32_bf16 v[164:167], a[104:107], a[72:75], v[164:167]
    buffer_load_dwordx4 v227, s[8:11], s24 offen offset:1024 lds
    v_mfma_f32_16x16x32_bf16 v[164:167], a[100:103], a[68:71], v[164:167]
    v_exp_f32 v171, v171
    v_mfma_f32_16x16x32_bf16 v[164:167], a[96:99], a[64:67], v[164:167]
    v_cvt_pk_bf16_f32 v180, v168, v169
    v_cvt_pk_bf16_f32 v181, v170, v171
    v_mfma_f32_16x16x32_bf16 v[80:83], a[192:195], v[188:191], v[80:83]
    v_exp_f32 v172, v172
    v_mfma_f32_16x16x32_bf16 v[80:83], a[160:163], v[184:187], v[80:83]
    s_waitcnt lgkmcnt(0)
    ds_read_b128 a[80:83], v212 offset:8192
    buffer_store_dwordx4 a[232:235], v228, s[16:19], s29 offen offset:0 nt
    v_mfma_f32_16x16x32_bf16 v[84:87], a[164:167], v[184:187], v[84:87]
    v_exp_f32 v173, v173
    v_mfma_f32_16x16x32_bf16 v[84:87], a[196:199], v[188:191], v[84:87]
    ds_read_b128 a[84:87], v213 offset:8192
    v_and_b32 v253, s31, v234
    v_mfma_f32_16x16x32_bf16 v[88:91], a[200:203], v[188:191], v[88:91]
    v_exp_f32 v174, v174
    v_mfma_f32_16x16x32_bf16 v[88:91], a[168:171], v[184:187], v[88:91]
    ds_read_b128 a[88:91], v214 offset:8192
    v_lshlrev_b32 v254, 16, v235
    v_mfma_f32_16x16x32_bf16 v[92:95], a[172:175], v[184:187], v[92:95]
    v_exp_f32 v175, v175
    v_mfma_f32_16x16x32_bf16 v[92:95], a[204:207], v[188:191], v[92:95]
    v_cvt_pk_bf16_f32 v182, v172, v173
    v_cvt_pk_bf16_f32 v183, v174, v175
    v_smfmac_f32_16x16x64_bf16 a[216:219], a[248:251], v[184:191], v231
    ds_read_b128 a[92:95], v215 offset:8192
    v_mfma_f32_16x16x32_bf16 v[168:171], a[112:115], a[64:67], v[208:211]
    v_exp_f32 v160, v160
    v_mfma_f32_16x16x32_bf16 v[168:171], a[116:119], a[68:71], v[168:171]
    ds_read_b128 a[96:99], v212 offset:12288
    v_and_b32 v255, s31, v235
    v_pk_mul_f32 v[248:249], v[248:249], s[84:85]
    v_pk_mul_f32 v[250:251], v[250:251], s[84:85]
    v_pk_mul_f32 v[252:253], v[252:253], s[84:85]
    v_pk_mul_f32 v[254:255], v[254:255], s[84:85]
    v_mfma_f32_16x16x32_bf16 v[168:171], a[120:123], a[72:75], v[168:171]
    v_exp_f32 v161, v161
    v_mfma_f32_16x16x32_bf16 v[168:171], a[124:127], a[76:79], v[168:171]
    ds_read_b128 a[100:103], v213 offset:12288
    v_cvt_pk_bf16_f32 v248, v248, v249
    v_mfma_f32_16x16x32_bf16 v[172:175], a[140:143], a[76:79], v[208:211]
    v_exp_f32 v162, v162
    v_mfma_f32_16x16x32_bf16 v[172:175], a[136:139], a[72:75], v[172:175]
    ds_read_b128 a[104:107], v214 offset:12288
    v_cvt_pk_bf16_f32 v249, v250, v251
    v_mfma_f32_16x16x32_bf16 v[172:175], a[132:135], a[68:71], v[172:175]
    v_exp_f32 v163, v163
    v_mfma_f32_16x16x32_bf16 v[172:175], a[128:131], a[64:67], v[172:175]
    v_cvt_pk_bf16_f32 v184, v160, v161
    v_cvt_pk_bf16_f32 v185, v162, v163
    v_mfma_f32_16x16x32_bf16 v[96:99], a[144:147], v[176:179], v[96:99]
    v_exp_f32 v164, v164
    v_mfma_f32_16x16x32_bf16 v[96:99], a[176:179], v[180:183], v[96:99]
    ds_read_b128 a[108:111], v215 offset:12288
    ds_read_b128 a[112:115], v212 offset:16384
    v_mfma_f32_16x16x32_bf16 v[100:103], a[180:183], v[180:183], v[100:103]
    v_exp_f32 v165, v165
    v_mfma_f32_16x16x32_bf16 v[100:103], a[148:151], v[176:179], v[100:103]
    ds_read_b128 a[116:119], v213 offset:16384
    v_cvt_pk_bf16_f32 v250, v252, v253
    v_mfma_f32_16x16x32_bf16 v[104:107], a[152:155], v[176:179], v[104:107]
    v_exp_f32 v166, v166
    v_mfma_f32_16x16x32_bf16 v[104:107], a[184:187], v[180:183], v[104:107]
    ds_read_b128 a[120:123], v214 offset:16384
    v_cvt_pk_bf16_f32 v251, v254, v255
    v_mfma_f32_16x16x32_bf16 v[108:111], a[188:191], v[180:183], v[108:111]
    v_exp_f32 v167, v167
    v_mfma_f32_16x16x32_bf16 v[108:111], a[156:159], v[176:179], v[108:111]
    s_waitcnt lgkmcnt(3)
    v_cvt_pk_bf16_f32 v186, v164, v165
    v_cvt_pk_bf16_f32 v187, v166, v167
    v_mfma_f32_16x16x32_bf16 v[160:163], a[80:83], a[0:3], v[192:195]
    v_exp_f32 v168, v168
    v_mfma_f32_16x16x32_bf16 v[160:163], a[84:87], a[4:7], v[160:163]
    ds_read_b128 a[124:127], v215 offset:16384
    ds_read_b128 a[128:131], v212 offset:20480
    v_mfma_f32_16x16x32_bf16 v[160:163], a[88:91], a[8:11], v[160:163]
    v_exp_f32 v169, v169
    v_mfma_f32_16x16x32_bf16 v[160:163], a[92:95], a[12:15], v[160:163]
    ds_read_b128 a[132:135], v213 offset:20480
    v_mfma_f32_16x16x32_bf16 v[164:167], a[108:111], a[12:15], v[192:195]
    v_exp_f32 v170, v170
    v_mfma_f32_16x16x32_bf16 v[164:167], a[104:107], a[8:11], v[164:167]
    ds_write_b128 v230, v[248:251] offset:16384
    v_mfma_f32_16x16x32_bf16 v[164:167], a[100:103], a[4:7], v[164:167]
    v_exp_f32 v171, v171
    v_mfma_f32_16x16x32_bf16 v[164:167], a[96:99], a[0:3], v[164:167]
    v_cvt_pk_bf16_f32 v188, v168, v169
    v_cvt_pk_bf16_f32 v189, v170, v171
    v_mfma_f32_16x16x32_bf16 v[112:115], a[192:195], v[180:183], v[112:115]
    v_exp_f32 v172, v172
    v_mfma_f32_16x16x32_bf16 v[112:115], a[160:163], v[176:179], v[112:115]
    s_waitcnt vmcnt(13)
    ds_read_b128 a[136:139], v214 offset:20480
    ds_read_b128 a[140:143], v215 offset:20480
    v_mfma_f32_16x16x32_bf16 v[116:119], a[164:167], v[176:179], v[116:119]
    v_exp_f32 v173, v173
    v_mfma_f32_16x16x32_bf16 v[116:119], a[196:199], v[180:183], v[116:119]
    v_xor_b32 v229, 64, v230
    v_lshlrev_b32 v248, 16, v236
    v_mfma_f32_16x16x32_bf16 v[120:123], a[200:203], v[180:183], v[120:123]
    v_exp_f32 v174, v174
    v_mfma_f32_16x16x32_bf16 v[120:123], a[168:171], v[176:179], v[120:123]
    ds_read_b128 a[236:239], v229 offset:17408
    v_and_b32 v249, s31, v236
    v_mfma_f32_16x16x32_bf16 v[124:127], a[172:175], v[176:179], v[124:127]
    v_exp_f32 v175, v175
    v_mfma_f32_16x16x32_bf16 v[124:127], a[204:207], v[180:183], v[124:127]
    v_cvt_pk_bf16_f32 v190, v172, v173
    v_cvt_pk_bf16_f32 v191, v174, v175
    v_smfmac_f32_16x16x64_bf16 a[220:223], a[248:251], v[176:183], v231
    s_waitcnt lgkmcnt(1)
    v_lshlrev_b32 v250, 16, v237
    v_mfma_f32_16x16x32_bf16 v[168:171], a[112:115], a[0:3], v[192:195]
    v_exp_f32 v160, v160
    v_mfma_f32_16x16x32_bf16 v[168:171], a[116:119], a[4:7], v[168:171]
    v_and_b32 v251, s31, v237
    v_lshlrev_b32 v252, 16, v238
    v_mfma_f32_16x16x32_bf16 v[168:171], a[120:123], a[8:11], v[168:171]
    v_exp_f32 v161, v161
    v_mfma_f32_16x16x32_bf16 v[168:171], a[124:127], a[12:15], v[168:171]
    v_and_b32 v253, s31, v238
    v_lshlrev_b32 v254, 16, v239
    v_mfma_f32_16x16x32_bf16 v[172:175], a[140:143], a[12:15], v[192:195]
    v_exp_f32 v162, v162
    v_mfma_f32_16x16x32_bf16 v[172:175], a[136:139], a[8:11], v[172:175]
    v_and_b32 v255, s31, v239
    v_mfma_f32_16x16x32_bf16 v[172:175], a[132:135], a[4:7], v[172:175]
    v_exp_f32 v163, v163
    v_pk_mul_f32 v[248:249], v[248:249], s[84:85]
    v_pk_mul_f32 v[250:251], v[250:251], s[84:85]
    v_pk_mul_f32 v[252:253], v[252:253], s[84:85]
    v_pk_mul_f32 v[254:255], v[254:255], s[84:85]
    v_mfma_f32_16x16x32_bf16 v[172:175], a[128:131], a[0:3], v[172:175]
    v_cvt_pk_bf16_f32 v176, v160, v161
    v_cvt_pk_bf16_f32 v177, v162, v163
    v_mfma_f32_16x16x32_bf16 v[128:131], a[144:147], v[184:187], v[128:131]
    s_waitcnt lgkmcnt(0)
    buffer_store_dwordx4 a[236:239], v228, s[16:19], s29 offen offset:1024 nt
    v_exp_f32 v164, v164
    v_mfma_f32_16x16x32_bf16 v[128:131], a[176:179], v[188:191], v[128:131]
    ds_read_b64_tr_b16 a[144:145], v216 offset:8192
    ds_read_b64_tr_b16 a[146:147], v216 offset:12288
    v_mfma_f32_16x16x32_bf16 v[132:135], a[180:183], v[188:191], v[132:135]
    v_exp_f32 v165, v165
    v_mfma_f32_16x16x32_bf16 v[132:135], a[148:151], v[184:187], v[132:135]
    ds_read_b64_tr_b16 a[176:177], v216 offset:16384
    ds_read_b64_tr_b16 a[178:179], v216 offset:20480
    v_mfma_f32_16x16x32_bf16 v[136:139], a[152:155], v[184:187], v[136:139]
    v_exp_f32 v166, v166
    v_mfma_f32_16x16x32_bf16 v[136:139], a[184:187], v[188:191], v[136:139]
    ds_read_b64_tr_b16 a[180:181], v217 offset:16384
    ds_read_b64_tr_b16 a[182:183], v217 offset:20480
    v_mfma_f32_16x16x32_bf16 v[140:143], a[188:191], v[188:191], v[140:143]
    v_exp_f32 v167, v167
    v_mfma_f32_16x16x32_bf16 v[140:143], a[156:159], v[184:187], v[140:143]
    v_cvt_pk_bf16_f32 v178, v164, v165
    v_cvt_pk_bf16_f32 v179, v166, v167
    v_mfma_f32_16x16x32_bf16 v[160:163], a[80:83], a[16:19], v[196:199]
    v_exp_f32 v168, v168
    v_mfma_f32_16x16x32_bf16 v[160:163], a[84:87], a[20:23], v[160:163]
    ds_read_b64_tr_b16 a[148:149], v217 offset:8192
    ds_read_b64_tr_b16 a[150:151], v217 offset:12288
    v_mfma_f32_16x16x32_bf16 v[160:163], a[88:91], a[24:27], v[160:163]
    v_exp_f32 v169, v169
    v_mfma_f32_16x16x32_bf16 v[160:163], a[92:95], a[28:31], v[160:163]
    ds_read_b64_tr_b16 a[152:153], v218 offset:8192
    ds_read_b64_tr_b16 a[154:155], v218 offset:12288
    v_mfma_f32_16x16x32_bf16 v[164:167], a[108:111], a[28:31], v[196:199]
    v_exp_f32 v170, v170
    v_mfma_f32_16x16x32_bf16 v[164:167], a[104:107], a[24:27], v[164:167]
    ds_read_b64_tr_b16 a[184:185], v218 offset:16384
    ds_read_b64_tr_b16 a[186:187], v218 offset:20480
    v_mfma_f32_16x16x32_bf16 v[164:167], a[100:103], a[20:23], v[164:167]
    v_exp_f32 v171, v171
    v_mfma_f32_16x16x32_bf16 v[164:167], a[96:99], a[16:19], v[164:167]
    v_cvt_pk_bf16_f32 v180, v168, v169
    v_cvt_pk_bf16_f32 v181, v170, v171
    v_mfma_f32_16x16x32_bf16 v[144:147], a[192:195], v[188:191], v[144:147]
    v_exp_f32 v172, v172
    v_mfma_f32_16x16x32_bf16 v[144:147], a[160:163], v[184:187], v[144:147]
    ds_read_b64_tr_b16 a[188:189], v219 offset:16384
    ds_read_b64_tr_b16 a[190:191], v219 offset:20480
    v_mfma_f32_16x16x32_bf16 v[148:151], a[164:167], v[184:187], v[148:151]
    v_exp_f32 v173, v173
    v_mfma_f32_16x16x32_bf16 v[148:151], a[196:199], v[188:191], v[148:151]
    ds_read_b64_tr_b16 a[156:157], v219 offset:8192
    ds_read_b64_tr_b16 a[158:159], v219 offset:12288
    v_mfma_f32_16x16x32_bf16 v[152:155], a[200:203], v[188:191], v[152:155]
    v_exp_f32 v174, v174
    v_mfma_f32_16x16x32_bf16 v[152:155], a[168:171], v[184:187], v[152:155]
    ds_read_b64_tr_b16 a[192:193], v220 offset:16384
    ds_read_b64_tr_b16 a[194:195], v220 offset:20480
    v_mfma_f32_16x16x32_bf16 v[156:159], a[172:175], v[184:187], v[156:159]
    v_exp_f32 v175, v175
    v_mfma_f32_16x16x32_bf16 v[156:159], a[204:207], v[188:191], v[156:159]
    v_cvt_pk_bf16_f32 v182, v172, v173
    v_cvt_pk_bf16_f32 v183, v174, v175
    v_smfmac_f32_16x16x64_bf16 a[224:227], a[248:251], v[184:191], v231
    ds_read_b64_tr_b16 a[160:161], v220 offset:8192
    v_mfma_f32_16x16x32_bf16 v[168:171], a[112:115], a[16:19], v[196:199]
    v_exp_f32 v160, v160
    v_mfma_f32_16x16x32_bf16 v[168:171], a[116:119], a[20:23], v[168:171]
    ds_read_b64_tr_b16 a[162:163], v220 offset:12288
    ds_read_b64_tr_b16 a[164:165], v221 offset:8192
    v_mfma_f32_16x16x32_bf16 v[168:171], a[120:123], a[24:27], v[168:171]
    v_exp_f32 v161, v161
    v_mfma_f32_16x16x32_bf16 v[168:171], a[124:127], a[28:31], v[168:171]
    ds_read_b64_tr_b16 a[166:167], v221 offset:12288
    ds_read_b64_tr_b16 a[196:197], v221 offset:16384
    v_mfma_f32_16x16x32_bf16 v[172:175], a[140:143], a[28:31], v[196:199]
    v_exp_f32 v162, v162
    v_mfma_f32_16x16x32_bf16 v[172:175], a[136:139], a[24:27], v[172:175]
    ds_read_b64_tr_b16 a[198:199], v221 offset:20480
    ds_read_b64_tr_b16 a[200:201], v222 offset:16384
    v_mfma_f32_16x16x32_bf16 v[172:175], a[132:135], a[20:23], v[172:175]
    v_exp_f32 v163, v163
    v_mfma_f32_16x16x32_bf16 v[172:175], a[128:131], a[16:19], v[172:175]
    s_waitcnt lgkmcnt(14)
    v_cvt_pk_bf16_f32 v184, v160, v161
    v_cvt_pk_bf16_f32 v185, v162, v163
    v_mfma_f32_16x16x32_bf16 v[0:3], a[144:147], v[176:179], v[0:3]
    v_exp_f32 v164, v164
    v_mfma_f32_16x16x32_bf16 v[0:3], a[176:179], v[180:183], v[0:3]
    ds_read_b64_tr_b16 a[202:203], v222 offset:20480
    ds_read_b64_tr_b16 a[168:169], v222 offset:8192
    v_mfma_f32_16x16x32_bf16 v[4:7], a[180:183], v[180:183], v[4:7]
    s_waitcnt lgkmcnt(14)
    v_exp_f32 v165, v165
    v_mfma_f32_16x16x32_bf16 v[4:7], a[148:151], v[176:179], v[4:7]
    ds_read_b64_tr_b16 a[170:171], v222 offset:12288
    ds_read_b64_tr_b16 a[172:173], v223 offset:8192
    v_mfma_f32_16x16x32_bf16 v[8:11], a[152:155], v[176:179], v[8:11]
    s_waitcnt lgkmcnt(14)
    v_exp_f32 v166, v166
    v_mfma_f32_16x16x32_bf16 v[8:11], a[184:187], v[180:183], v[8:11]
    ds_read_b64_tr_b16 a[174:175], v223 offset:12288
    ds_read_b64_tr_b16 a[204:205], v223 offset:16384
    v_mfma_f32_16x16x32_bf16 v[12:15], a[188:191], v[180:183], v[12:15]
    s_waitcnt lgkmcnt(14)
    v_exp_f32 v167, v167
    v_mfma_f32_16x16x32_bf16 v[12:15], a[156:159], v[176:179], v[12:15]
    v_cvt_pk_bf16_f32 v186, v164, v165
    v_cvt_pk_bf16_f32 v187, v166, v167
    v_mfma_f32_16x16x32_bf16 v[160:163], a[80:83], a[32:35], v[200:203]
    v_exp_f32 v168, v168
    v_mfma_f32_16x16x32_bf16 v[160:163], a[84:87], a[36:39], v[160:163]
    ds_read_b64_tr_b16 a[206:207], v223 offset:20480
    v_cvt_pk_bf16_f32 v248, v248, v249
    v_mfma_f32_16x16x32_bf16 v[160:163], a[88:91], a[40:43], v[160:163]
    v_exp_f32 v169, v169
    v_mfma_f32_16x16x32_bf16 v[160:163], a[92:95], a[44:47], v[160:163]
    v_cvt_pk_bf16_f32 v249, v250, v251
    v_cvt_pk_bf16_f32 v250, v252, v253
    v_mfma_f32_16x16x32_bf16 v[164:167], a[108:111], a[44:47], v[200:203]
    v_exp_f32 v170, v170
    v_mfma_f32_16x16x32_bf16 v[164:167], a[104:107], a[40:43], v[164:167]
    v_cvt_pk_bf16_f32 v251, v254, v255
    v_mfma_f32_16x16x32_bf16 v[164:167], a[100:103], a[36:39], v[164:167]
    v_exp_f32 v171, v171
    v_mfma_f32_16x16x32_bf16 v[164:167], a[96:99], a[32:35], v[164:167]
    s_waitcnt lgkmcnt(14)
    v_cvt_pk_bf16_f32 v188, v168, v169
    v_cvt_pk_bf16_f32 v189, v170, v171
    v_mfma_f32_16x16x32_bf16 v[16:19], a[192:195], v[180:183], v[16:19]
    s_waitcnt lgkmcnt(12)
    v_exp_f32 v172, v172
    v_mfma_f32_16x16x32_bf16 v[16:19], a[160:163], v[176:179], v[16:19]
    s_waitcnt lgkmcnt(10)
    v_mfma_f32_16x16x32_bf16 v[20:23], a[164:167], v[176:179], v[20:23]
    s_waitcnt lgkmcnt(8)
    v_exp_f32 v173, v173
    v_mfma_f32_16x16x32_bf16 v[20:23], a[196:199], v[180:183], v[20:23]
    s_waitcnt lgkmcnt(6)
    v_mfma_f32_16x16x32_bf16 v[24:27], a[200:203], v[180:183], v[24:27]
    s_waitcnt lgkmcnt(4)
    v_exp_f32 v174, v174
    v_mfma_f32_16x16x32_bf16 v[24:27], a[168:171], v[176:179], v[24:27]
    s_waitcnt lgkmcnt(2)
    v_mfma_f32_16x16x32_bf16 v[28:31], a[172:175], v[176:179], v[28:31]
    s_waitcnt lgkmcnt(0)
    v_exp_f32 v175, v175
    v_mfma_f32_16x16x32_bf16 v[28:31], a[204:207], v[180:183], v[28:31]
    v_cvt_pk_bf16_f32 v190, v172, v173
    v_cvt_pk_bf16_f32 v191, v174, v175
    v_smfmac_f32_16x16x64_bf16 a[208:211], a[248:251], v[176:183], v231
    s_waitcnt vmcnt(7)
    s_barrier
    v_mfma_f32_16x16x32_bf16 v[168:171], a[112:115], a[32:35], v[200:203]
    s_add_u32 s24, s24, 4096
    v_exp_f32 v160, v160
    v_mfma_f32_16x16x32_bf16 v[168:171], a[116:119], a[36:39], v[168:171]
    ds_write_b128 v229, v[248:251] offset:17408
    v_mfma_f32_16x16x32_bf16 v[168:171], a[120:123], a[40:43], v[168:171]
    v_exp_f32 v161, v161
    v_mfma_f32_16x16x32_bf16 v[168:171], a[124:127], a[44:47], v[168:171]
    s_add_u32 m0, s32, 8192
    v_mfma_f32_16x16x32_bf16 v[172:175], a[140:143], a[44:47], v[200:203]
    v_exp_f32 v162, v162
    v_mfma_f32_16x16x32_bf16 v[172:175], a[136:139], a[40:43], v[172:175]
    v_mfma_f32_16x16x32_bf16 v[172:175], a[132:135], a[36:39], v[172:175]
    v_exp_f32 v163, v163
    v_mfma_f32_16x16x32_bf16 v[172:175], a[128:131], a[32:35], v[172:175]
    v_cvt_pk_bf16_f32 v176, v160, v161
    v_cvt_pk_bf16_f32 v177, v162, v163
    v_mfma_f32_16x16x32_bf16 v[32:35], a[144:147], v[184:187], v[32:35]
    v_exp_f32 v164, v164
    v_mfma_f32_16x16x32_bf16 v[32:35], a[176:179], v[188:191], v[32:35]
    buffer_load_dwordx4 v224, s[4:7], s24 offen offset:0 lds
    v_mfma_f32_16x16x32_bf16 v[36:39], a[180:183], v[188:191], v[36:39]
    v_exp_f32 v165, v165
    v_mfma_f32_16x16x32_bf16 v[36:39], a[148:151], v[184:187], v[36:39]
    buffer_load_dwordx4 v225, s[4:7], s24 offen offset:1024 lds
    v_mfma_f32_16x16x32_bf16 v[40:43], a[152:155], v[184:187], v[40:43]
    v_exp_f32 v166, v166
    v_mfma_f32_16x16x32_bf16 v[40:43], a[184:187], v[188:191], v[40:43]
    v_xor_b32 v229, 128, v230
    v_lshlrev_b32 v248, 16, v240
    v_mfma_f32_16x16x32_bf16 v[44:47], a[188:191], v[188:191], v[44:47]
    s_add_u32 m0, s32, 49152
    v_exp_f32 v167, v167
    v_mfma_f32_16x16x32_bf16 v[44:47], a[156:159], v[184:187], v[44:47]
    v_cvt_pk_bf16_f32 v178, v164, v165
    v_cvt_pk_bf16_f32 v179, v166, v167
    v_mfma_f32_16x16x32_bf16 v[160:163], a[80:83], a[48:51], v[204:207]
    v_exp_f32 v168, v168
    v_mfma_f32_16x16x32_bf16 v[160:163], a[84:87], a[52:55], v[160:163]
    buffer_load_dwordx4 v226, s[8:11], s24 offen offset:0 lds
    v_mfma_f32_16x16x32_bf16 v[160:163], a[88:91], a[56:59], v[160:163]
    v_exp_f32 v169, v169
    v_mfma_f32_16x16x32_bf16 v[160:163], a[92:95], a[60:63], v[160:163]
    ds_read_b128 a[240:243], v229 offset:18432
    v_and_b32 v249, s31, v240
    v_mfma_f32_16x16x32_bf16 v[164:167], a[108:111], a[60:63], v[204:207]
    v_exp_f32 v170, v170
    v_mfma_f32_16x16x32_bf16 v[164:167], a[104:107], a[56:59], v[164:167]
    buffer_load_dwordx4 v227, s[8:11], s24 offen offset:1024 lds
    v_mfma_f32_16x16x32_bf16 v[164:167], a[100:103], a[52:55], v[164:167]
    v_exp_f32 v171, v171
    v_mfma_f32_16x16x32_bf16 v[164:167], a[96:99], a[48:51], v[164:167]
    v_cvt_pk_bf16_f32 v180, v168, v169
    v_cvt_pk_bf16_f32 v181, v170, v171
    v_mfma_f32_16x16x32_bf16 v[48:51], a[192:195], v[188:191], v[48:51]
    v_exp_f32 v172, v172
    v_mfma_f32_16x16x32_bf16 v[48:51], a[160:163], v[184:187], v[48:51]
    s_add_u32 s24, s24, 8192
    v_lshlrev_b32 v250, 16, v241
    v_and_b32 v251, s31, v241
    v_mfma_f32_16x16x32_bf16 v[52:55], a[164:167], v[184:187], v[52:55]
    v_exp_f32 v173, v173
    v_mfma_f32_16x16x32_bf16 v[52:55], a[196:199], v[188:191], v[52:55]
    v_lshlrev_b32 v252, 16, v242
    v_and_b32 v253, s31, v242
    v_mfma_f32_16x16x32_bf16 v[56:59], a[200:203], v[188:191], v[56:59]
    v_exp_f32 v174, v174
    v_mfma_f32_16x16x32_bf16 v[56:59], a[168:171], v[184:187], v[56:59]
    s_add_u32 m0, s32, 16384
    v_lshlrev_b32 v254, 16, v243
    v_and_b32 v255, s31, v243
    v_pk_mul_f32 v[248:249], v[248:249], s[84:85]
    v_pk_mul_f32 v[250:251], v[250:251], s[84:85]
    v_pk_mul_f32 v[252:253], v[252:253], s[84:85]
    v_pk_mul_f32 v[254:255], v[254:255], s[84:85]
    v_mfma_f32_16x16x32_bf16 v[60:63], a[172:175], v[184:187], v[60:63]
    v_exp_f32 v175, v175
    v_mfma_f32_16x16x32_bf16 v[60:63], a[204:207], v[188:191], v[60:63]
    v_cvt_pk_bf16_f32 v182, v172, v173
    v_cvt_pk_bf16_f32 v183, v174, v175
    v_smfmac_f32_16x16x64_bf16 a[212:215], a[248:251], v[184:191], v231
    v_cvt_pk_bf16_f32 v248, v248, v249
    v_mfma_f32_16x16x32_bf16 v[168:171], a[112:115], a[48:51], v[204:207]
    v_exp_f32 v160, v160
    v_mfma_f32_16x16x32_bf16 v[168:171], a[116:119], a[52:55], v[168:171]
    buffer_load_dwordx4 v224, s[4:7], s24 offen offset:0 lds
    v_mfma_f32_16x16x32_bf16 v[168:171], a[120:123], a[56:59], v[168:171]
    v_exp_f32 v161, v161
    v_mfma_f32_16x16x32_bf16 v[168:171], a[124:127], a[60:63], v[168:171]
    s_waitcnt lgkmcnt(0)
    buffer_store_dwordx4 a[240:243], v228, s[16:19], s29 offen offset:2048 nt
    v_mfma_f32_16x16x32_bf16 v[172:175], a[140:143], a[60:63], v[204:207]
    v_exp_f32 v162, v162
    v_mfma_f32_16x16x32_bf16 v[172:175], a[136:139], a[56:59], v[172:175]
    v_cvt_pk_bf16_f32 v249, v250, v251
    v_cvt_pk_bf16_f32 v250, v252, v253
    v_mfma_f32_16x16x32_bf16 v[172:175], a[132:135], a[52:55], v[172:175]
    v_exp_f32 v163, v163
    v_mfma_f32_16x16x32_bf16 v[172:175], a[128:131], a[48:51], v[172:175]
    v_cvt_pk_bf16_f32 v184, v160, v161
    v_cvt_pk_bf16_f32 v185, v162, v163
    v_mfma_f32_16x16x32_bf16 v[64:67], a[144:147], v[176:179], v[64:67]
    v_exp_f32 v164, v164
    v_mfma_f32_16x16x32_bf16 v[64:67], a[176:179], v[180:183], v[64:67]
    buffer_load_dwordx4 v225, s[4:7], s24 offen offset:1024 lds
    v_mfma_f32_16x16x32_bf16 v[68:71], a[180:183], v[180:183], v[68:71]
    s_add_u32 m0, s32, 57344
    v_exp_f32 v165, v165
    v_mfma_f32_16x16x32_bf16 v[68:71], a[148:151], v[176:179], v[68:71]
    v_cvt_pk_bf16_f32 v251, v254, v255
    v_mfma_f32_16x16x32_bf16 v[72:75], a[152:155], v[176:179], v[72:75]
    v_exp_f32 v166, v166
    v_mfma_f32_16x16x32_bf16 v[72:75], a[184:187], v[180:183], v[72:75]
    v_mfma_f32_16x16x32_bf16 v[76:79], a[188:191], v[180:183], v[76:79]
    v_exp_f32 v167, v167
    v_mfma_f32_16x16x32_bf16 v[76:79], a[156:159], v[176:179], v[76:79]
    v_cvt_pk_bf16_f32 v186, v164, v165
    v_cvt_pk_bf16_f32 v187, v166, v167
    v_mfma_f32_16x16x32_bf16 v[160:163], a[80:83], a[64:67], v[208:211]
    v_exp_f32 v168, v168
    v_mfma_f32_16x16x32_bf16 v[160:163], a[84:87], a[68:71], v[160:163]
    buffer_load_dwordx4 v226, s[8:11], s24 offen offset:0 lds
    v_mfma_f32_16x16x32_bf16 v[160:163], a[88:91], a[72:75], v[160:163]
    v_exp_f32 v169, v169
    v_mfma_f32_16x16x32_bf16 v[160:163], a[92:95], a[76:79], v[160:163]
    ds_write_b128 v229, v[248:251] offset:18432
    v_mfma_f32_16x16x32_bf16 v[164:167], a[108:111], a[76:79], v[208:211]
    v_exp_f32 v170, v170
    v_mfma_f32_16x16x32_bf16 v[164:167], a[104:107], a[72:75], v[164:167]
    buffer_load_dwordx4 v227, s[8:11], s24 offen offset:1024 lds
    v_mfma_f32_16x16x32_bf16 v[164:167], a[100:103], a[68:71], v[164:167]
    v_exp_f32 v171, v171
    v_mfma_f32_16x16x32_bf16 v[164:167], a[96:99], a[64:67], v[164:167]
    v_cvt_pk_bf16_f32 v188, v168, v169
    v_cvt_pk_bf16_f32 v189, v170, v171
    v_mfma_f32_16x16x32_bf16 v[80:83], a[192:195], v[180:183], v[80:83]
    v_exp_f32 v172, v172
    v_mfma_f32_16x16x32_bf16 v[80:83], a[160:163], v[176:179], v[80:83]
    s_waitcnt vmcnt(14)
    ds_read_b128 a[80:83], v212 offset:24576
    v_xor_b32 v229, 192, v230
    v_mfma_f32_16x16x32_bf16 v[84:87], a[164:167], v[176:179], v[84:87]
    v_exp_f32 v173, v173
    v_mfma_f32_16x16x32_bf16 v[84:87], a[196:199], v[180:183], v[84:87]
    ds_read_b128 a[84:87], v213 offset:24576
    ds_read_b128 a[244:247], v229 offset:19456
    v_mfma_f32_16x16x32_bf16 v[88:91], a[200:203], v[180:183], v[88:91]
    v_exp_f32 v174, v174
    v_mfma_f32_16x16x32_bf16 v[88:91], a[168:171], v[176:179], v[88:91]
    ds_read_b128 a[88:91], v214 offset:24576
    v_lshlrev_b32 v248, 16, v244
    v_mfma_f32_16x16x32_bf16 v[92:95], a[172:175], v[176:179], v[92:95]
    v_exp_f32 v175, v175
    v_mfma_f32_16x16x32_bf16 v[92:95], a[204:207], v[180:183], v[92:95]
    v_cvt_pk_bf16_f32 v190, v172, v173
    v_cvt_pk_bf16_f32 v191, v174, v175
    v_smfmac_f32_16x16x64_bf16 a[216:219], a[248:251], v[176:183], v231
    ds_read_b128 a[92:95], v215 offset:24576
    v_mfma_f32_16x16x32_bf16 v[168:171], a[112:115], a[64:67], v[208:211]
    v_exp_f32 v160, v160
    v_mfma_f32_16x16x32_bf16 v[168:171], a[116:119], a[68:71], v[168:171]
    ds_read_b128 a[96:99], v212 offset:28672
    v_and_b32 v249, s31, v244
    v_mfma_f32_16x16x32_bf16 v[168:171], a[120:123], a[72:75], v[168:171]
    v_exp_f32 v161, v161
    v_mfma_f32_16x16x32_bf16 v[168:171], a[124:127], a[76:79], v[168:171]
    ds_read_b128 a[100:103], v213 offset:28672
    v_lshlrev_b32 v250, 16, v245
    v_mfma_f32_16x16x32_bf16 v[172:175], a[140:143], a[76:79], v[208:211]
    v_exp_f32 v162, v162
    v_mfma_f32_16x16x32_bf16 v[172:175], a[136:139], a[72:75], v[172:175]
    ds_read_b128 a[104:107], v214 offset:28672
    v_and_b32 v251, s31, v245
    v_mfma_f32_16x16x32_bf16 v[172:175], a[132:135], a[68:71], v[172:175]
    v_exp_f32 v163, v163
    v_mfma_f32_16x16x32_bf16 v[172:175], a[128:131], a[64:67], v[172:175]
    v_cvt_pk_bf16_f32 v176, v160, v161
    v_cvt_pk_bf16_f32 v177, v162, v163
    v_mfma_f32_16x16x32_bf16 v[96:99], a[144:147], v[184:187], v[96:99]
    v_exp_f32 v164, v164
    v_mfma_f32_16x16x32_bf16 v[96:99], a[176:179], v[188:191], v[96:99]
    ds_read_b128 a[108:111], v215 offset:28672
    ds_read_b128 a[112:115], v212 offset:32768
    v_mfma_f32_16x16x32_bf16 v[100:103], a[180:183], v[188:191], v[100:103]
    v_exp_f32 v165, v165
    v_mfma_f32_16x16x32_bf16 v[100:103], a[148:151], v[184:187], v[100:103]
    ds_read_b128 a[116:119], v213 offset:32768
    v_lshlrev_b32 v252, 16, v246
    v_mfma_f32_16x16x32_bf16 v[104:107], a[152:155], v[184:187], v[104:107]
    v_exp_f32 v166, v166
    v_mfma_f32_16x16x32_bf16 v[104:107], a[184:187], v[188:191], v[104:107]
    ds_read_b128 a[120:123], v214 offset:32768
    v_and_b32 v253, s31, v246
    v_mfma_f32_16x16x32_bf16 v[108:111], a[188:191], v[188:191], v[108:111]
    v_exp_f32 v167, v167
    v_mfma_f32_16x16x32_bf16 v[108:111], a[156:159], v[184:187], v[108:111]
    s_waitcnt lgkmcnt(3)
    v_cvt_pk_bf16_f32 v178, v164, v165
    v_cvt_pk_bf16_f32 v179, v166, v167
    v_mfma_f32_16x16x32_bf16 v[160:163], a[80:83], a[0:3], v[192:195]
    v_exp_f32 v168, v168
    v_mfma_f32_16x16x32_bf16 v[160:163], a[84:87], a[4:7], v[160:163]
    ds_read_b128 a[124:127], v215 offset:32768
    ds_read_b128 a[128:131], v212 offset:36864
    v_mfma_f32_16x16x32_bf16 v[160:163], a[88:91], a[8:11], v[160:163]
    v_exp_f32 v169, v169
    v_mfma_f32_16x16x32_bf16 v[160:163], a[92:95], a[12:15], v[160:163]
    ds_read_b128 a[132:135], v213 offset:36864
    v_lshlrev_b32 v254, 16, v247
    v_mfma_f32_16x16x32_bf16 v[164:167], a[108:111], a[12:15], v[192:195]
    v_exp_f32 v170, v170
    v_mfma_f32_16x16x32_bf16 v[164:167], a[104:107], a[8:11], v[164:167]
    buffer_store_dwordx4 a[244:247], v228, s[16:19], s29 offen offset:3072 nt
    v_mfma_f32_16x16x32_bf16 v[164:167], a[100:103], a[4:7], v[164:167]
    v_exp_f32 v171, v171
    v_mfma_f32_16x16x32_bf16 v[164:167], a[96:99], a[0:3], v[164:167]
    v_cvt_pk_bf16_f32 v180, v168, v169
    v_cvt_pk_bf16_f32 v181, v170, v171
    v_mfma_f32_16x16x32_bf16 v[112:115], a[192:195], v[188:191], v[112:115]
    v_exp_f32 v172, v172
    v_mfma_f32_16x16x32_bf16 v[112:115], a[160:163], v[184:187], v[112:115]
    ds_read_b128 a[136:139], v214 offset:36864
    ds_read_b128 a[140:143], v215 offset:36864
    v_mfma_f32_16x16x32_bf16 v[116:119], a[164:167], v[184:187], v[116:119]
    v_exp_f32 v173, v173
    v_mfma_f32_16x16x32_bf16 v[116:119], a[196:199], v[188:191], v[116:119]
    v_and_b32 v255, s31, v247
    v_mfma_f32_16x16x32_bf16 v[120:123], a[200:203], v[188:191], v[120:123]
    v_exp_f32 v174, v174
    v_pk_mul_f32 v[248:249], v[248:249], s[84:85]
    v_pk_mul_f32 v[250:251], v[250:251], s[84:85]
    v_pk_mul_f32 v[252:253], v[252:253], s[84:85]
    v_pk_mul_f32 v[254:255], v[254:255], s[84:85]
    v_mfma_f32_16x16x32_bf16 v[120:123], a[168:171], v[184:187], v[120:123]
    v_cvt_pk_bf16_f32 v248, v248, v249
    v_cvt_pk_bf16_f32 v249, v250, v251
    v_mfma_f32_16x16x32_bf16 v[124:127], a[172:175], v[184:187], v[124:127]
    v_exp_f32 v175, v175
    v_mfma_f32_16x16x32_bf16 v[124:127], a[204:207], v[188:191], v[124:127]
    v_cvt_pk_bf16_f32 v182, v172, v173
    v_cvt_pk_bf16_f32 v183, v174, v175
    v_smfmac_f32_16x16x64_bf16 a[220:223], a[248:251], v[184:191], v231
    s_waitcnt lgkmcnt(0)
    v_cvt_pk_bf16_f32 v250, v252, v253
    v_cvt_pk_bf16_f32 v251, v254, v255
    v_mfma_f32_16x16x32_bf16 v[168:171], a[112:115], a[0:3], v[192:195]
    v_exp_f32 v160, v160
    v_mfma_f32_16x16x32_bf16 v[168:171], a[116:119], a[4:7], v[168:171]
    ds_write_b128 v229, v[248:251] offset:19456
    v_mfma_f32_16x16x32_bf16 v[168:171], a[120:123], a[8:11], v[168:171]
    v_exp_f32 v161, v161
    v_mfma_f32_16x16x32_bf16 v[168:171], a[124:127], a[12:15], v[168:171]
    v_mfma_f32_16x16x32_bf16 v[172:175], a[140:143], a[12:15], v[192:195]
    v_exp_f32 v162, v162
    v_mfma_f32_16x16x32_bf16 v[172:175], a[136:139], a[8:11], v[172:175]
    v_mfma_f32_16x16x32_bf16 v[172:175], a[132:135], a[4:7], v[172:175]
    v_exp_f32 v163, v163
    v_mfma_f32_16x16x32_bf16 v[172:175], a[128:131], a[0:3], v[172:175]
    v_cvt_pk_bf16_f32 v184, v160, v161
    v_cvt_pk_bf16_f32 v185, v162, v163
    v_mfma_f32_16x16x32_bf16 v[128:131], a[144:147], v[176:179], v[128:131]
    v_exp_f32 v164, v164
    v_mfma_f32_16x16x32_bf16 v[128:131], a[176:179], v[180:183], v[128:131]
    ds_read_b64_tr_b16 a[144:145], v216 offset:24576
    ds_read_b64_tr_b16 a[146:147], v216 offset:28672
    v_mfma_f32_16x16x32_bf16 v[132:135], a[180:183], v[180:183], v[132:135]
    v_exp_f32 v165, v165
    v_mfma_f32_16x16x32_bf16 v[132:135], a[148:151], v[176:179], v[132:135]
    ds_read_b64_tr_b16 a[176:177], v216 offset:32768
    ds_read_b64_tr_b16 a[178:179], v216 offset:36864
    v_mfma_f32_16x16x32_bf16 v[136:139], a[152:155], v[176:179], v[136:139]
    v_exp_f32 v166, v166
    v_mfma_f32_16x16x32_bf16 v[136:139], a[184:187], v[180:183], v[136:139]
    ds_read_b64_tr_b16 a[180:181], v217 offset:32768
    ds_read_b64_tr_b16 a[182:183], v217 offset:36864
    v_mfma_f32_16x16x32_bf16 v[140:143], a[188:191], v[180:183], v[140:143]
    v_exp_f32 v167, v167
    v_mfma_f32_16x16x32_bf16 v[140:143], a[156:159], v[176:179], v[140:143]
    v_cvt_pk_bf16_f32 v186, v164, v165
    v_cvt_pk_bf16_f32 v187, v166, v167
    s_cmp_eq_u32 s33, 0
    s_cbranch_scc1 L_tail
    v_mfma_f32_16x16x32_bf16 v[160:163], a[80:83], a[16:19], v[196:199]
    v_exp_f32 v168, v168
    v_add_u32 v232, s52, v212
    v_mfma_f32_16x16x32_bf16 v[160:163], a[84:87], a[20:23], v[160:163]
    ds_read_b64_tr_b16 a[148:149], v217 offset:24576
    ds_read_b64_tr_b16 a[150:151], v217 offset:28672
    v_mfma_f32_16x16x32_bf16 v[160:163], a[88:91], a[24:27], v[160:163]
    v_exp_f32 v169, v169
    v_add_u32 v233, s52, v213
    v_mfma_f32_16x16x32_bf16 v[160:163], a[92:95], a[28:31], v[160:163]
    ds_read_b64_tr_b16 a[152:153], v218 offset:24576
    ds_read_b64_tr_b16 a[154:155], v218 offset:28672
    v_mfma_f32_16x16x32_bf16 v[164:167], a[108:111], a[28:31], v[196:199]
    v_exp_f32 v170, v170
    v_add_u32 v234, s52, v214
    v_mfma_f32_16x16x32_bf16 v[164:167], a[104:107], a[24:27], v[164:167]
    ds_read_b64_tr_b16 a[184:185], v218 offset:32768
    ds_read_b64_tr_b16 a[186:187], v218 offset:36864
    v_mfma_f32_16x16x32_bf16 v[164:167], a[100:103], a[20:23], v[164:167]
    v_exp_f32 v171, v171
    v_add_u32 v235, s52, v215
    v_mfma_f32_16x16x32_bf16 v[164:167], a[96:99], a[16:19], v[164:167]
    v_cvt_pk_bf16_f32 v188, v168, v169
    v_cvt_pk_bf16_f32 v189, v170, v171
    v_mfma_f32_16x16x32_bf16 v[144:147], a[192:195], v[180:183], v[144:147]
    v_exp_f32 v172, v172
    v_mfma_f32_16x16x32_bf16 v[144:147], a[160:163], v[176:179], v[144:147]
    ds_read_b64_tr_b16 a[188:189], v219 offset:32768
    ds_read_b64_tr_b16 a[190:191], v219 offset:36864
    v_xor_b32 v249, 0x28, v232
    v_mfma_f32_16x16x32_bf16 v[148:151], a[164:167], v[176:179], v[148:151]
    v_exp_f32 v173, v173
    v_mfma_f32_16x16x32_bf16 v[148:151], a[196:199], v[180:183], v[148:151]
    ds_read_b64_tr_b16 a[156:157], v219 offset:24576
    ds_read_b64_tr_b16 a[158:159], v219 offset:28672
    v_mfma_f32_16x16x32_bf16 v[152:155], a[200:203], v[180:183], v[152:155]
    v_exp_f32 v174, v174
    v_mfma_f32_16x16x32_bf16 v[152:155], a[168:171], v[176:179], v[152:155]
    ds_read_b64_tr_b16 a[192:193], v220 offset:32768
    ds_read_b64_tr_b16 a[194:195], v220 offset:36864
    v_cndmask_b32 v248, v232, v249, s[58:59]
    v_mfma_f32_16x16x32_bf16 v[156:159], a[172:175], v[176:179], v[156:159]
    v_exp_f32 v175, v175
    v_mfma_f32_16x16x32_bf16 v[156:159], a[204:207], v[180:183], v[156:159]
    v_cvt_pk_bf16_f32 v190, v172, v173
    v_cvt_pk_bf16_f32 v191, v174, v175
    v_smfmac_f32_16x16x64_bf16 a[224:227], a[248:251], v[176:183], v231
    ds_read_b64_tr_b16 a[160:161], v220 offset:24576
    v_mfma_f32_16x16x32_bf16 v[168:171], a[112:115], a[16:19], v[196:199]
    ds_read_b128 a[0:3], v232 offset:0
    v_exp_f32 v160, v160
    v_mfma_f32_16x16x32_bf16 v[168:171], a[116:119], a[20:23], v[168:171]
    ds_read_b64_tr_b16 a[162:163], v220 offset:28672
    ds_read_b64_tr_b16 a[164:165], v221 offset:24576
    v_xor_b32 v249, 32, v248
    v_mfma_f32_16x16x32_bf16 v[168:171], a[120:123], a[24:27], v[168:171]
    v_exp_f32 v161, v161
    v_mfma_f32_16x16x32_bf16 v[168:171], a[124:127], a[28:31], v[168:171]
    ds_read_b64_tr_b16 a[166:167], v221 offset:28672
    ds_read_b64_tr_b16 a[196:197], v221 offset:32768
    v_mfma_f32_16x16x32_bf16 v[172:175], a[140:143], a[28:31], v[196:199]
    ds_read_b128 a[4:7], v233 offset:0
    v_exp_f32 v162, v162
    v_mfma_f32_16x16x32_bf16 v[172:175], a[136:139], a[24:27], v[172:175]
    ds_read_b64_tr_b16 a[198:199], v221 offset:36864
    ds_read_b64_tr_b16 a[200:201], v222 offset:32768
    v_xor_b32 v250, 64, v248
    v_mfma_f32_16x16x32_bf16 v[172:175], a[132:135], a[20:23], v[172:175]
    v_exp_f32 v163, v163
    v_mfma_f32_16x16x32_bf16 v[172:175], a[128:131], a[16:19], v[172:175]
    s_waitcnt lgkmcnt(14)
    v_cvt_pk_bf16_f32 v176, v160, v161
    v_cvt_pk_bf16_f32 v177, v162, v163
    v_mfma_f32_16x16x32_bf16 v[0:3], a[144:147], v[184:187], v[0:3]
    ds_read_b128 a[8:11], v234 offset:0
    v_exp_f32 v164, v164
    v_mfma_f32_16x16x32_bf16 v[0:3], a[176:179], v[188:191], v[0:3]
    s_waitcnt lgkmcnt(14)
    ds_read_b64_tr_b16 a[202:203], v222 offset:36864
    ds_read_b64_tr_b16 a[168:169], v222 offset:24576
    v_mfma_f32_16x16x32_bf16 v[4:7], a[180:183], v[188:191], v[4:7]
    s_waitcnt lgkmcnt(14)
    v_exp_f32 v165, v165
    v_xor_b32 v251, 96, v248
    v_mfma_f32_16x16x32_bf16 v[4:7], a[148:151], v[184:187], v[4:7]
    ds_read_b64_tr_b16 a[170:171], v222 offset:28672
    ds_read_b64_tr_b16 a[172:173], v223 offset:24576
    v_mfma_f32_16x16x32_bf16 v[8:11], a[152:155], v[184:187], v[8:11]
    s_waitcnt lgkmcnt(14)
    ds_read_b128 a[12:15], v235 offset:0
    v_exp_f32 v166, v166
    v_mfma_f32_16x16x32_bf16 v[8:11], a[184:187], v[188:191], v[8:11]
    s_waitcnt lgkmcnt(14)
    ds_read_b64_tr_b16 a[174:175], v223 offset:28672
    ds_read_b64_tr_b16 a[204:205], v223 offset:32768
    v_mfma_f32_16x16x32_bf16 v[12:15], a[188:191], v[188:191], v[12:15]
    s_waitcnt lgkmcnt(14)
    v_exp_f32 v167, v167
    v_mfma_f32_16x16x32_bf16 v[12:15], a[156:159], v[184:187], v[12:15]
    v_cvt_pk_bf16_f32 v178, v164, v165
    v_cvt_pk_bf16_f32 v179, v166, v167
    v_mfma_f32_16x16x32_bf16 v[160:163], a[80:83], a[32:35], v[200:203]
    s_add_u32 s16, s22, s35
    s_addc_u32 s17, s23, 0
    s_mov_b32 s18, 159744
    v_exp_f32 v168, v168
    v_mfma_f32_16x16x32_bf16 v[160:163], a[84:87], a[36:39], v[160:163]
    ds_read_b64_tr_b16 a[206:207], v223 offset:36864
    v_xor_b32 v252, 128, v248
    v_mfma_f32_16x16x32_bf16 v[160:163], a[88:91], a[40:43], v[160:163]
    v_exp_f32 v169, v169
    v_mfma_f32_16x16x32_bf16 v[160:163], a[92:95], a[44:47], v[160:163]
    v_xor_b32 v253, 160, v248
    v_mfma_f32_16x16x32_bf16 v[164:167], a[108:111], a[44:47], v[200:203]
    v_exp_f32 v170, v170
    v_mfma_f32_16x16x32_bf16 v[164:167], a[104:107], a[40:43], v[164:167]
    v_mfma_f32_16x16x32_bf16 v[164:167], a[100:103], a[36:39], v[164:167]
    v_exp_f32 v171, v171
    v_mfma_f32_16x16x32_bf16 v[164:167], a[96:99], a[32:35], v[164:167]
    s_waitcnt lgkmcnt(14)
    v_cvt_pk_bf16_f32 v180, v168, v169
    v_cvt_pk_bf16_f32 v181, v170, v171
    v_mfma_f32_16x16x32_bf16 v[16:19], a[192:195], v[188:191], v[16:19]
    v_exp_f32 v172, v172
    v_mfma_f32_16x16x32_bf16 v[16:19], a[160:163], v[184:187], v[16:19]
    s_waitcnt lgkmcnt(13)
    v_xor_b32 v254, 192, v248
    v_mfma_f32_16x16x32_bf16 v[20:23], a[164:167], v[184:187], v[20:23]
    s_waitcnt lgkmcnt(10)
    v_exp_f32 v173, v173
    v_mfma_f32_16x16x32_bf16 v[20:23], a[196:199], v[188:191], v[20:23]
    s_waitcnt lgkmcnt(7)
    v_mfma_f32_16x16x32_bf16 v[24:27], a[200:203], v[188:191], v[24:27]
    s_waitcnt lgkmcnt(5)
    v_exp_f32 v174, v174
    v_mfma_f32_16x16x32_bf16 v[24:27], a[168:171], v[184:187], v[24:27]
    s_waitcnt lgkmcnt(2)
    v_xor_b32 v255, 224, v248
    v_mfma_f32_16x16x32_bf16 v[28:31], a[172:175], v[184:187], v[28:31]
    s_waitcnt lgkmcnt(0)
    v_exp_f32 v175, v175
    v_mfma_f32_16x16x32_bf16 v[28:31], a[204:207], v[188:191], v[28:31]
    v_cvt_pk_bf16_f32 v182, v172, v173
    v_cvt_pk_bf16_f32 v183, v174, v175
    v_smfmac_f32_16x16x64_bf16 a[208:211], a[248:251], v[184:191], v231
    s_waitcnt vmcnt(6)
    s_barrier
    v_mfma_f32_16x16x32_bf16 v[168:171], a[112:115], a[32:35], v[200:203]
    s_add_u32 s24, s24, 8192
    v_exp_f32 v160, v160
    v_mfma_f32_16x16x32_bf16 v[168:171], a[116:119], a[36:39], v[168:171]
    ds_read_b128 a[16:19], v232 offset:4096
    v_mfma_f32_16x16x32_bf16 v[168:171], a[120:123], a[40:43], v[168:171]
    v_exp_f32 v161, v161
    v_mfma_f32_16x16x32_bf16 v[168:171], a[124:127], a[44:47], v[168:171]
    s_add_u32 m0, s32, 24576
    v_mfma_f32_16x16x32_bf16 v[172:175], a[140:143], a[44:47], v[200:203]
    v_exp_f32 v162, v162
    v_mfma_f32_16x16x32_bf16 v[172:175], a[136:139], a[40:43], v[172:175]
    ds_read_b128 a[20:23], v233 offset:4096
    v_accvgpr_read_b32 v239, a208
    v_accvgpr_read_b32 v238, a209
    v_add_f32 v239, v239, v238
    v_cmp_nge_f32 s[62:63], s37, v239
    v_mfma_f32_16x16x32_bf16 v[172:175], a[132:135], a[36:39], v[172:175]
    v_exp_f32 v163, v163
    v_rcp_f32 v239, v239
    s_or_b64 s[40:41], s[40:41], s[62:63]
    v_mfma_f32_16x16x32_bf16 v[172:175], a[128:131], a[32:35], v[172:175]
    v_cvt_pk_bf16_f32 v184, v160, v161
    v_cvt_pk_bf16_f32 v185, v162, v163
    v_mfma_f32_16x16x32_bf16 v[32:35], a[144:147], v[176:179], v[32:35]
    ds_read_b128 a[24:27], v234 offset:4096
    v_exp_f32 v164, v164
    v_mfma_f32_16x16x32_bf16 v[32:35], a[176:179], v[180:183], v[32:35]
    buffer_load_dwordx4 v224, s[4:7], s24 offen offset:0 lds
    v_pk_mul_f32 v[0:1], v[0:1], v[238:239] op_sel:[0,1] op_sel_hi:[1,1]
    v_pk_mul_f32 v[2:3], v[2:3], v[238:239] op_sel:[0,1] op_sel_hi:[1,1]
    v_pk_mul_f32 v[4:5], v[4:5], v[238:239] op_sel:[0,1] op_sel_hi:[1,1]
    v_pk_mul_f32 v[6:7], v[6:7], v[238:239] op_sel:[0,1] op_sel_hi:[1,1]
    v_pk_mul_f32 v[8:9], v[8:9], v[238:239] op_sel:[0,1] op_sel_hi:[1,1]
    v_pk_mul_f32 v[10:11], v[10:11], v[238:239] op_sel:[0,1] op_sel_hi:[1,1]
    v_pk_mul_f32 v[12:13], v[12:13], v[238:239] op_sel:[0,1] op_sel_hi:[1,1]
    v_pk_mul_f32 v[14:15], v[14:15], v[238:239] op_sel:[0,1] op_sel_hi:[1,1]
    v_pk_mul_f32 v[16:17], v[16:17], v[238:239] op_sel:[0,1] op_sel_hi:[1,1]
    v_pk_mul_f32 v[18:19], v[18:19], v[238:239] op_sel:[0,1] op_sel_hi:[1,1]
    v_pk_mul_f32 v[20:21], v[20:21], v[238:239] op_sel:[0,1] op_sel_hi:[1,1]
    v_pk_mul_f32 v[22:23], v[22:23], v[238:239] op_sel:[0,1] op_sel_hi:[1,1]
    v_pk_mul_f32 v[24:25], v[24:25], v[238:239] op_sel:[0,1] op_sel_hi:[1,1]
    v_pk_mul_f32 v[26:27], v[26:27], v[238:239] op_sel:[0,1] op_sel_hi:[1,1]
    v_pk_mul_f32 v[28:29], v[28:29], v[238:239] op_sel:[0,1] op_sel_hi:[1,1]
    v_pk_mul_f32 v[30:31], v[30:31], v[238:239] op_sel:[0,1] op_sel_hi:[1,1]
    v_mfma_f32_16x16x32_bf16 v[36:39], a[180:183], v[180:183], v[36:39]
    v_exp_f32 v165, v165
    v_mfma_f32_16x16x32_bf16 v[36:39], a[148:151], v[176:179], v[36:39]
    buffer_load_dwordx4 v225, s[4:7], s24 offen offset:1024 lds
    v_mfma_f32_16x16x32_bf16 v[40:43], a[152:155], v[176:179], v[40:43]
    v_exp_f32 v166, v166
    v_mfma_f32_16x16x32_bf16 v[40:43], a[184:187], v[180:183], v[40:43]
    ds_read_b128 a[28:31], v235 offset:4096
    v_cvt_pk_bf16_f32 v0, v0, v1
    v_cvt_pk_bf16_f32 v1, v2, v3
    v_mfma_f32_16x16x32_bf16 v[44:47], a[188:191], v[180:183], v[44:47]
    s_add_u32 m0, s32, 65536
    v_exp_f32 v167, v167
    v_cvt_pk_bf16_f32 v4, v4, v5
    v_cvt_pk_bf16_f32 v5, v6, v7
    v_mfma_f32_16x16x32_bf16 v[44:47], a[156:159], v[176:179], v[44:47]
    v_cvt_pk_bf16_f32 v186, v164, v165
    v_cvt_pk_bf16_f32 v187, v166, v167
    v_mfma_f32_16x16x32_bf16 v[160:163], a[80:83], a[48:51], v[204:207]
    v_exp_f32 v168, v168
    v_mfma_f32_16x16x32_bf16 v[160:163], a[84:87], a[52:55], v[160:163]
    buffer_load_dwordx4 v226, s[8:11], s24 offen offset:0 lds
    v_mfma_f32_16x16x32_bf16 v[160:163], a[88:91], a[56:59], v[160:163]
    v_exp_f32 v169, v169
    v_mfma_f32_16x16x32_bf16 v[160:163], a[92:95], a[60:63], v[160:163]
    ds_write_b64 v248, v[0:1] offset:0
    v_cvt_pk_bf16_f32 v8, v8, v9
    v_cvt_pk_bf16_f32 v9, v10, v11
    v_mfma_f32_16x16x32_bf16 v[164:167], a[108:111], a[60:63], v[204:207]
    v_exp_f32 v170, v170
    v_mfma_f32_16x16x32_bf16 v[164:167], a[104:107], a[56:59], v[164:167]
    buffer_load_dwordx4 v227, s[8:11], s24 offen offset:1024 lds
    v_mfma_f32_16x16x32_bf16 v[164:167], a[100:103], a[52:55], v[164:167]
    v_exp_f32 v171, v171
    v_mfma_f32_16x16x32_bf16 v[164:167], a[96:99], a[48:51], v[164:167]
    v_cvt_pk_bf16_f32 v188, v168, v169
    v_cvt_pk_bf16_f32 v189, v170, v171
    v_mfma_f32_16x16x32_bf16 v[48:51], a[192:195], v[180:183], v[48:51]
    v_exp_f32 v172, v172
    v_mfma_f32_16x16x32_bf16 v[48:51], a[160:163], v[176:179], v[48:51]
    s_add_u32 s24, s24, 8192
    ds_write_b64 v249, v[4:5] offset:0
    v_mfma_f32_16x16x32_bf16 v[52:55], a[164:167], v[176:179], v[52:55]
    v_exp_f32 v173, v173
    v_mfma_f32_16x16x32_bf16 v[52:55], a[196:199], v[180:183], v[52:55]
    v_cvt_pk_bf16_f32 v12, v12, v13
    v_cvt_pk_bf16_f32 v13, v14, v15
    v_mfma_f32_16x16x32_bf16 v[56:59], a[200:203], v[180:183], v[56:59]
    v_exp_f32 v174, v174
    v_mfma_f32_16x16x32_bf16 v[56:59], a[168:171], v[176:179], v[56:59]
    s_add_u32 m0, s32, 32768
    ds_write_b64 v250, v[8:9] offset:0
    v_mfma_f32_16x16x32_bf16 v[60:63], a[172:175], v[176:179], v[60:63]
    v_exp_f32 v175, v175
    v_mfma_f32_16x16x32_bf16 v[60:63], a[204:207], v[180:183], v[60:63]
    v_cvt_pk_bf16_f32 v190, v172, v173
    v_cvt_pk_bf16_f32 v191, v174, v175
    v_smfmac_f32_16x16x64_bf16 a[212:215], a[248:251], v[176:183], v231
    v_cvt_pk_bf16_f32 v16, v16, v17
    v_cvt_pk_bf16_f32 v17, v18, v19
    v_mfma_f32_16x16x32_bf16 v[168:171], a[112:115], a[48:51], v[204:207]
    v_exp_f32 v160, v160
    v_mfma_f32_16x16x32_bf16 v[168:171], a[116:119], a[52:55], v[168:171]
    buffer_load_dwordx4 v224, s[4:7], s24 offen offset:0 lds
    v_mfma_f32_16x16x32_bf16 v[168:171], a[120:123], a[56:59], v[168:171]
    v_exp_f32 v161, v161
    v_mfma_f32_16x16x32_bf16 v[168:171], a[124:127], a[60:63], v[168:171]
    ds_read_b128 a[32:35], v232 offset:8192
    ds_write_b64 v251, v[12:13] offset:0
    v_mfma_f32_16x16x32_bf16 v[172:175], a[140:143], a[60:63], v[204:207]
    v_exp_f32 v162, v162
    v_mfma_f32_16x16x32_bf16 v[172:175], a[136:139], a[56:59], v[172:175]
    ds_read_b128 a[36:39], v233 offset:8192
    v_cvt_pk_bf16_f32 v20, v20, v21
    v_cvt_pk_bf16_f32 v21, v22, v23
    v_mfma_f32_16x16x32_bf16 v[172:175], a[132:135], a[52:55], v[172:175]
    ds_write_b64 v252, v[16:17] offset:0
    v_exp_f32 v163, v163
    v_mfma_f32_16x16x32_bf16 v[172:175], a[128:131], a[48:51], v[172:175]
    v_cvt_pk_bf16_f32 v176, v160, v161
    v_cvt_pk_bf16_f32 v177, v162, v163
    v_cvt_pk_bf16_f32 v24, v24, v25
    v_cvt_pk_bf16_f32 v25, v26, v27
    v_mfma_f32_16x16x32_bf16 v[64:67], a[144:147], v[184:187], v[64:67]
    v_exp_f32 v164, v164
    v_mfma_f32_16x16x32_bf16 v[64:67], a[176:179], v[188:191], v[64:67]
    buffer_load_dwordx4 v225, s[4:7], s24 offen offset:1024 lds
    v_mfma_f32_16x16x32_bf16 v[68:71], a[180:183], v[188:191], v[68:71]
    s_add_u32 m0, s32, 73728
    v_exp_f32 v165, v165
    v_mfma_f32_16x16x32_bf16 v[68:71], a[148:151], v[184:187], v[68:71]
    ds_read_b128 a[40:43], v234 offset:8192
    ds_write_b64 v253, v[20:21] offset:0
    v_mfma_f32_16x16x32_bf16 v[72:75], a[152:155], v[184:187], v[72:75]
    v_exp_f32 v166, v166
    v_mfma_f32_16x16x32_bf16 v[72:75], a[184:187], v[188:191], v[72:75]
    ds_read_b128 a[44:47], v235 offset:8192
    v_cvt_pk_bf16_f32 v28, v28, v29
    v_cvt_pk_bf16_f32 v29, v30, v31
    v_mfma_f32_16x16x32_bf16 v[76:79], a[188:191], v[188:191], v[76:79]
    ds_write_b64 v254, v[24:25] offset:0
    v_exp_f32 v167, v167
    v_mfma_f32_16x16x32_bf16 v[76:79], a[156:159], v[184:187], v[76:79]
    v_cvt_pk_bf16_f32 v178, v164, v165
    v_cvt_pk_bf16_f32 v179, v166, v167
    v_mfma_f32_16x16x32_bf16 v[160:163], a[80:83], a[64:67], v[208:211]
    v_exp_f32 v168, v168
    v_mfma_f32_16x16x32_bf16 v[160:163], a[84:87], a[68:71], v[160:163]
    buffer_load_dwordx4 v226, s[8:11], s24 offen offset:0 lds
    v_mfma_f32_16x16x32_bf16 v[160:163], a[88:91], a[72:75], v[160:163]
    v_exp_f32 v169, v169
    v_mfma_f32_16x16x32_bf16 v[160:163], a[92:95], a[76:79], v[160:163]
    ds_write_b64 v255, v[28:29] offset:0
    v_mfma_f32_16x16x32_bf16 v[164:167], a[108:111], a[76:79], v[208:211]
    v_exp_f32 v170, v170
    v_accvgpr_read_b32 v239, a212
    v_accvgpr_read_b32 v238, a213
    v_add_f32 v239, v239, v238
    v_cmp_nge_f32 s[62:63], s37, v239
    v_mfma_f32_16x16x32_bf16 v[164:167], a[104:107], a[72:75], v[164:167]
    buffer_load_dwordx4 v227, s[8:11], s24 offen offset:1024 lds
    v_mfma_f32_16x16x32_bf16 v[164:167], a[100:103], a[68:71], v[164:167]
    v_exp_f32 v171, v171
    v_mfma_f32_16x16x32_bf16 v[164:167], a[96:99], a[64:67], v[164:167]
    v_cvt_pk_bf16_f32 v180, v168, v169
    v_cvt_pk_bf16_f32 v181, v170, v171
    v_mfma_f32_16x16x32_bf16 v[80:83], a[192:195], v[188:191], v[80:83]
    v_exp_f32 v172, v172
    v_mfma_f32_16x16x32_bf16 v[80:83], a[160:163], v[184:187], v[80:83]
    ds_read_b128 a[80:83], v212 offset:0
    v_rcp_f32 v239, v239
    s_or_b64 s[40:41], s[40:41], s[62:63]
    v_pk_mul_f32 v[32:33], v[32:33], v[238:239] op_sel:[0,1] op_sel_hi:[1,1]
    v_pk_mul_f32 v[34:35], v[34:35], v[238:239] op_sel:[0,1] op_sel_hi:[1,1]
    v_pk_mul_f32 v[36:37], v[36:37], v[238:239] op_sel:[0,1] op_sel_hi:[1,1]
    v_pk_mul_f32 v[38:39], v[38:39], v[238:239] op_sel:[0,1] op_sel_hi:[1,1]
    v_pk_mul_f32 v[40:41], v[40:41], v[238:239] op_sel:[0,1] op_sel_hi:[1,1]
    v_pk_mul_f32 v[42:43], v[42:43], v[238:239] op_sel:[0,1] op_sel_hi:[1,1]
    v_pk_mul_f32 v[44:45], v[44:45], v[238:239] op_sel:[0,1] op_sel_hi:[1,1]
    v_pk_mul_f32 v[46:47], v[46:47], v[238:239] op_sel:[0,1] op_sel_hi:[1,1]
    v_pk_mul_f32 v[48:49], v[48:49], v[238:239] op_sel:[0,1] op_sel_hi:[1,1]
    v_pk_mul_f32 v[50:51], v[50:51], v[238:239] op_sel:[0,1] op_sel_hi:[1,1]
    v_pk_mul_f32 v[52:53], v[52:53], v[238:239] op_sel:[0,1] op_sel_hi:[1,1]
    v_pk_mul_f32 v[54:55], v[54:55], v[238:239] op_sel:[0,1] op_sel_hi:[1,1]
    v_pk_mul_f32 v[56:57], v[56:57], v[238:239] op_sel:[0,1] op_sel_hi:[1,1]
    v_pk_mul_f32 v[58:59], v[58:59], v[238:239] op_sel:[0,1] op_sel_hi:[1,1]
    v_pk_mul_f32 v[60:61], v[60:61], v[238:239] op_sel:[0,1] op_sel_hi:[1,1]
    v_pk_mul_f32 v[62:63], v[62:63], v[238:239] op_sel:[0,1] op_sel_hi:[1,1]
    v_mfma_f32_16x16x32_bf16 v[84:87], a[164:167], v[184:187], v[84:87]
    v_exp_f32 v173, v173
    v_mfma_f32_16x16x32_bf16 v[84:87], a[196:199], v[188:191], v[84:87]
    v_cvt_pk_bf16_f32 v32, v32, v33
    v_cvt_pk_bf16_f32 v33, v34, v35
    v_mfma_f32_16x16x32_bf16 v[88:91], a[200:203], v[188:191], v[88:91]
    v_exp_f32 v174, v174
    v_mfma_f32_16x16x32_bf16 v[88:91], a[168:171], v[184:187], v[88:91]
    ds_read_b128 a[84:87], v213 offset:0
    v_mfma_f32_16x16x32_bf16 v[92:95], a[172:175], v[184:187], v[92:95]
    v_exp_f32 v175, v175
    v_mfma_f32_16x16x32_bf16 v[92:95], a[204:207], v[188:191], v[92:95]
    v_cvt_pk_bf16_f32 v182, v172, v173
    v_cvt_pk_bf16_f32 v183, v174, v175
    v_smfmac_f32_16x16x64_bf16 a[216:219], a[248:251], v[184:191], v231
    v_cvt_pk_bf16_f32 v36, v36, v37
    v_cvt_pk_bf16_f32 v37, v38, v39
    v_mfma_f32_16x16x32_bf16 v[168:171], a[112:115], a[64:67], v[208:211]
    v_exp_f32 v160, v160
    v_mfma_f32_16x16x32_bf16 v[168:171], a[116:119], a[68:71], v[168:171]
    ds_read_b128 a[88:91], v214 offset:0
    ds_read_b128 a[48:51], v232 offset:12288
    v_mfma_f32_16x16x32_bf16 v[168:171], a[120:123], a[72:75], v[168:171]
    v_exp_f32 v161, v161
    v_mfma_f32_16x16x32_bf16 v[168:171], a[124:127], a[76:79], v[168:171]
    ds_write_b64 v248, v[32:33] offset:4096
    v_cvt_pk_bf16_f32 v40, v40, v41
    v_cvt_pk_bf16_f32 v41, v42, v43
    v_mfma_f32_16x16x32_bf16 v[172:175], a[140:143], a[76:79], v[208:211]
    v_exp_f32 v162, v162
    v_mfma_f32_16x16x32_bf16 v[172:175], a[136:139], a[72:75], v[172:175]
    ds_read_b128 a[92:95], v215 offset:0
    ds_read_b128 a[52:55], v233 offset:12288
    ds_write_b64 v249, v[36:37] offset:4096
    v_mfma_f32_16x16x32_bf16 v[172:175], a[132:135], a[68:71], v[172:175]
    v_exp_f32 v163, v163
    v_mfma_f32_16x16x32_bf16 v[172:175], a[128:131], a[64:67], v[172:175]
    v_cvt_pk_bf16_f32 v184, v160, v161
    v_cvt_pk_bf16_f32 v185, v162, v163
    v_mfma_f32_16x16x32_bf16 v[96:99], a[144:147], v[176:179], v[96:99]
    v_exp_f32 v164, v164
    v_cvt_pk_bf16_f32 v44, v44, v45
    v_cvt_pk_bf16_f32 v45, v46, v47
    v_mfma_f32_16x16x32_bf16 v[96:99], a[176:179], v[180:183], v[96:99]
    ds_read_b128 a[112:115], v212 offset:8192
    ds_read_b128 a[116:119], v213 offset:8192
    v_mfma_f32_16x16x32_bf16 v[100:103], a[180:183], v[180:183], v[100:103]
    ds_write_b64 v250, v[40:41] offset:4096
    v_exp_f32 v165, v165
    v_mfma_f32_16x16x32_bf16 v[100:103], a[148:151], v[176:179], v[100:103]
    ds_read_b128 a[120:123], v214 offset:8192
    ds_read_b128 a[56:59], v234 offset:12288
    v_mfma_f32_16x16x32_bf16 v[104:107], a[152:155], v[176:179], v[104:107]
    v_exp_f32 v166, v166
    v_mfma_f32_16x16x32_bf16 v[104:107], a[184:187], v[180:183], v[104:107]
    ds_read_b128 a[124:127], v215 offset:8192
    ds_read_b128 a[60:63], v235 offset:12288
    v_cvt_pk_bf16_f32 v48, v48, v49
    v_cvt_pk_bf16_f32 v49, v50, v51
    v_mfma_f32_16x16x32_bf16 v[108:111], a[188:191], v[180:183], v[108:111]
    v_exp_f32 v167, v167
    v_mfma_f32_16x16x32_bf16 v[108:111], a[156:159], v[176:179], v[108:111]
    s_waitcnt lgkmcnt(9)
    ds_write_b64 v251, v[44:45] offset:4096
    v_cvt_pk_bf16_f32 v186, v164, v165
    v_cvt_pk_bf16_f32 v187, v166, v167
    v_mfma_f32_16x16x32_bf16 v[160:163], a[80:83], a[0:3], 0
    v_exp_f32 v168, v168
    v_mfma_f32_16x16x32_bf16 v[160:163], a[84:87], a[4:7], v[160:163]
    v_exp_f32 v169, v169
    v_mfma_f32_16x16x32_bf16 v[160:163], a[88:91], a[8:11], v[160:163]
    ds_read_b128 a[128:131], v212 offset:12288
    ds_read_b128 a[132:135], v213 offset:12288
    v_cvt_pk_bf16_f32 v52, v52, v53
    v_cvt_pk_bf16_f32 v53, v54, v55
    v_mfma_f32_16x16x32_bf16 v[160:163], a[92:95], a[12:15], v[160:163]
    ds_read_b128 a[136:139], v214 offset:12288
    v_exp_f32 v170, v170
    v_mfma_f32_16x16x32_bf16 v[112:115], a[192:195], v[180:183], v[112:115]
    v_exp_f32 v171, v171
    v_mfma_f32_16x16x32_bf16 v[112:115], a[160:163], v[176:179], v[112:115]
    ds_read_b128 a[140:143], v215 offset:12288
    v_cvt_pk_bf16_f32 v188, v168, v169
    v_cvt_pk_bf16_f32 v189, v170, v171
    v_mfma_f32_16x16x32_bf16 v[116:119], a[164:167], v[176:179], v[116:119]
    v_exp_f32 v172, v172
    v_max3_f32 v236, v160, v161, v162
    v_max_f32 v236, v236, v163
    v_mfma_f32_16x16x32_bf16 v[116:119], a[196:199], v[180:183], v[116:119]
    v_exp_f32 v173, v173
    v_mov_b32 v237, v236
    s_nop 1
    v_permlane32_swap_b32 v236, v237
    v_mfma_f32_16x16x32_bf16 v[120:123], a[200:203], v[180:183], v[120:123]
    ds_write_b64 v252, v[48:49] offset:4096
    v_max_f32 v236, v236, v237
    v_mov_b32 v237, v236
    v_cvt_pk_bf16_f32 v56, v56, v57
    v_cvt_pk_bf16_f32 v57, v58, v59
    v_mfma_f32_16x16x32_bf16 v[120:123], a[168:171], v[176:179], v[120:123]
    v_exp_f32 v174, v174
    v_permlane16_swap_b32 v236, v237
    v_max_f32 v236, v236, v237
    v_mfma_f32_16x16x32_bf16 v[124:127], a[172:175], v[176:179], v[124:127]
    v_exp_f32 v175, v175
    v_sub_f32 v192, 0, v236
    v_sub_f32 v193, 0, v236
    v_mfma_f32_16x16x32_bf16 v[124:127], a[204:207], v[180:183], v[124:127]
    v_cvt_pk_bf16_f32 v190, v172, v173
    v_cvt_pk_bf16_f32 v191, v174, v175
    v_sub_f32 v194, 0, v236
    v_sub_f32 v195, 0, v236
    v_smfmac_f32_16x16x64_bf16 a[220:223], a[248:251], v[176:183], v231
    s_waitcnt lgkmcnt(1)
    ds_write_b64 v253, v[52:53] offset:4096
    v_mfma_f32_16x16x32_bf16 v[168:171], a[112:115], a[0:3], v[192:195]
    ds_read_b128 a[64:67], v232 offset:16384
    v_add_f32 v160, v160, v192
    v_mfma_f32_16x16x32_bf16 v[168:171], a[116:119], a[4:7], v[168:171]
    v_add_f32 v161, v161, v192
    v_mfma_f32_16x16x32_bf16 v[168:171], a[120:123], a[8:11], v[168:171]
    v_cvt_pk_bf16_f32 v60, v60, v61
    v_cvt_pk_bf16_f32 v61, v62, v63
    v_mfma_f32_16x16x32_bf16 v[168:171], a[124:127], a[12:15], v[168:171]
    v_add_f32 v162, v162, v192
    v_mfma_f32_16x16x32_bf16 v[172:175], a[140:143], a[12:15], v[192:195]
    ds_read_b128 a[68:71], v233 offset:16384
    v_add_f32 v163, v163, v192
    v_mfma_f32_16x16x32_bf16 v[172:175], a[136:139], a[8:11], v[172:175]
    ds_write_b64 v254, v[56:57] offset:4096
    v_mfma_f32_16x16x32_bf16 v[172:175], a[132:135], a[4:7], v[172:175]
    v_exp_f32 v160, v160
    v_mfma_f32_16x16x32_bf16 v[172:175], a[128:131], a[0:3], v[172:175]
    ds_write_b64 v255, v[60:61] offset:4096
    v_mfma_f32_16x16x32_bf16 v[128:131], a[144:147], v[184:187], v[128:131]
    v_exp_f32 v161, v161
    v_accvgpr_read_b32 v239, a216
    v_accvgpr_read_b32 v238, a217
    v_add_f32 v239, v239, v238
    v_cmp_nge_f32 s[62:63], s37, v239
    v_mfma_f32_16x16x32_bf16 v[128:131], a[176:179], v[188:191], v[128:131]
    ds_read_b64_tr_b16 a[144:145], v216 offset:0
    ds_read_b128 a[72:75], v234 offset:16384
    v_mfma_f32_16x16x32_bf16 v[132:135], a[180:183], v[188:191], v[132:135]
    v_exp_f32 v162, v162
    v_rcp_f32 v239, v239
    s_or_b64 s[40:41], s[40:41], s[62:63]
    v_mfma_f32_16x16x32_bf16 v[132:135], a[148:151], v[184:187], v[132:135]
    v_exp_f32 v163, v163
    v_mfma_f32_16x16x32_bf16 v[136:139], a[152:155], v[184:187], v[136:139]
    ds_read_b64_tr_b16 a[148:149], v217 offset:0
    v_cvt_pk_bf16_f32 v176, v160, v161
    v_mfma_f32_16x16x32_bf16 v[136:139], a[184:187], v[188:191], v[136:139]
    ds_read_b64_tr_b16 a[152:153], v218 offset:0
    ds_read_b128 a[76:79], v235 offset:16384
    v_pk_mul_f32 v[64:65], v[64:65], v[238:239] op_sel:[0,1] op_sel_hi:[1,1]
    v_pk_mul_f32 v[66:67], v[66:67], v[238:239] op_sel:[0,1] op_sel_hi:[1,1]
    v_pk_mul_f32 v[68:69], v[68:69], v[238:239] op_sel:[0,1] op_sel_hi:[1,1]
    v_pk_mul_f32 v[70:71], v[70:71], v[238:239] op_sel:[0,1] op_sel_hi:[1,1]
    v_pk_mul_f32 v[72:73], v[72:73], v[238:239] op_sel:[0,1] op_sel_hi:[1,1]
    v_pk_mul_f32 v[74:75], v[74:75], v[238:239] op_sel:[0,1] op_sel_hi:[1,1]
    v_pk_mul_f32 v[76:77], v[76:77], v[238:239] op_sel:[0,1] op_sel_hi:[1,1]
    v_pk_mul_f32 v[78:79], v[78:79], v[238:239] op_sel:[0,1] op_sel_hi:[1,1]
    v_pk_mul_f32 v[80:81], v[80:81], v[238:239] op_sel:[0,1] op_sel_hi:[1,1]
    v_pk_mul_f32 v[82:83], v[82:83], v[238:239] op_sel:[0,1] op_sel_hi:[1,1]
    v_pk_mul_f32 v[84:85], v[84:85], v[238:239] op_sel:[0,1] op_sel_hi:[1,1]
    v_pk_mul_f32 v[86:87], v[86:87], v[238:239] op_sel:[0,1] op_sel_hi:[1,1]
    v_pk_mul_f32 v[88:89], v[88:89], v[238:239] op_sel:[0,1] op_sel_hi:[1,1]
    v_pk_mul_f32 v[90:91], v[90:91], v[238:239] op_sel:[0,1] op_sel_hi:[1,1]
    v_pk_mul_f32 v[92:93], v[92:93], v[238:239] op_sel:[0,1] op_sel_hi:[1,1]
    v_pk_mul_f32 v[94:95], v[94:95], v[238:239] op_sel:[0,1] op_sel_hi:[1,1]
    v_mfma_f32_16x16x32_bf16 v[140:143], a[188:191], v[188:191], v[140:143]
    v_cvt_pk_bf16_f32 v177, v162, v163
    v_mfma_f32_16x16x32_bf16 v[140:143], a[156:159], v[184:187], v[140:143]
    v_cvt_pk_bf16_f32 v64, v64, v65
    v_cvt_pk_bf16_f32 v65, v66, v67
    v_mfma_f32_16x16x32_bf16 v[160:163], a[80:83], a[16:19], 0
    v_exp_f32 v168, v168
    v_mfma_f32_16x16x32_bf16 v[160:163], a[84:87], a[20:23], v[160:163]
    v_exp_f32 v169, v169
    v_mfma_f32_16x16x32_bf16 v[160:163], a[88:91], a[24:27], v[160:163]
    ds_read_b64_tr_b16 a[156:157], v219 offset:0
    ds_read_b64_tr_b16 a[176:177], v216 offset:8192
    v_cvt_pk_bf16_f32 v68, v68, v69
    v_cvt_pk_bf16_f32 v69, v70, v71
    v_mfma_f32_16x16x32_bf16 v[160:163], a[92:95], a[28:31], v[160:163]
    v_exp_f32 v170, v170
    v_mfma_f32_16x16x32_bf16 v[144:147], a[192:195], v[188:191], v[144:147]
    v_exp_f32 v171, v171
    v_mfma_f32_16x16x32_bf16 v[144:147], a[160:163], v[184:187], v[144:147]
    ds_write_b64 v248, v[64:65] offset:8192
    v_cvt_pk_bf16_f32 v180, v168, v169
    v_cvt_pk_bf16_f32 v181, v170, v171
    v_mfma_f32_16x16x32_bf16 v[148:151], a[164:167], v[184:187], v[148:151]
    v_exp_f32 v172, v172
    v_max3_f32 v236, v160, v161, v162
    v_max_f32 v236, v236, v163
    v_mfma_f32_16x16x32_bf16 v[148:151], a[196:199], v[188:191], v[148:151]
    v_exp_f32 v173, v173
    v_mov_b32 v237, v236
    s_nop 1
    v_permlane32_swap_b32 v236, v237
    v_mfma_f32_16x16x32_bf16 v[152:155], a[200:203], v[188:191], v[152:155]
    ds_read_b64_tr_b16 a[178:179], v216 offset:12288
    ds_read_b64_tr_b16 a[180:181], v217 offset:8192
    v_max_f32 v236, v236, v237
    v_mov_b32 v237, v236
    v_cvt_pk_bf16_f32 v72, v72, v73
    v_cvt_pk_bf16_f32 v73, v74, v75
    v_mfma_f32_16x16x32_bf16 v[152:155], a[168:171], v[184:187], v[152:155]
    v_exp_f32 v174, v174
    v_permlane16_swap_b32 v236, v237
    v_max_f32 v236, v236, v237
    v_mfma_f32_16x16x32_bf16 v[156:159], a[172:175], v[184:187], v[156:159]
    v_exp_f32 v175, v175
    v_sub_f32 v196, 0, v236
    v_sub_f32 v197, 0, v236
    v_mfma_f32_16x16x32_bf16 v[156:159], a[204:207], v[188:191], v[156:159]
    v_cvt_pk_bf16_f32 v182, v172, v173
    v_cvt_pk_bf16_f32 v183, v174, v175
    v_sub_f32 v198, 0, v236
    v_sub_f32 v199, 0, v236
    v_smfmac_f32_16x16x64_bf16 a[224:227], a[248:251], v[184:191], v231
    ds_read_b64_tr_b16 a[182:183], v217 offset:12288
    ds_write_b64 v249, v[68:69] offset:8192
    v_mfma_f32_16x16x32_bf16 v[168:171], a[112:115], a[16:19], v[196:199]
    ds_read_b64_tr_b16 a[184:185], v218 offset:8192
    ds_read_b64_tr_b16 a[186:187], v218 offset:12288
    v_add_f32 v160, v160, v196
    v_mfma_f32_16x16x32_bf16 v[168:171], a[116:119], a[20:23], v[168:171]
    ds_read_b64_tr_b16 a[188:189], v219 offset:8192
    ds_read_b64_tr_b16 a[190:191], v219 offset:12288
    v_add_f32 v161, v161, v196
    v_mfma_f32_16x16x32_bf16 v[168:171], a[120:123], a[24:27], v[168:171]
    ds_read_b64_tr_b16 a[160:161], v220 offset:0
    ds_read_b64_tr_b16 a[164:165], v221 offset:0
    v_cvt_pk_bf16_f32 v76, v76, v77
    v_cvt_pk_bf16_f32 v77, v78, v79
    v_mfma_f32_16x16x32_bf16 v[168:171], a[124:127], a[28:31], v[168:171]
    ds_read_b64_tr_b16 a[168:169], v222 offset:0
    ds_read_b64_tr_b16 a[172:173], v223 offset:0
    v_add_f32 v162, v162, v196
    v_mfma_f32_16x16x32_bf16 v[172:175], a[140:143], a[28:31], v[196:199]
    ds_read_b64_tr_b16 a[192:193], v220 offset:8192
    ds_read_b64_tr_b16 a[194:195], v220 offset:12288
    ds_write_b64 v250, v[72:73] offset:8192
    v_mfma_f32_16x16x32_bf16 v[172:175], a[136:139], a[24:27], v[172:175]
    ds_read_b64_tr_b16 a[196:197], v221 offset:8192
    ds_read_b64_tr_b16 a[198:199], v221 offset:12288
    v_mfma_f32_16x16x32_bf16 v[172:175], a[132:135], a[20:23], v[172:175]
    ds_read_b64_tr_b16 a[200:201], v222 offset:8192
    ds_read_b64_tr_b16 a[202:203], v222 offset:12288
    v_mfma_f32_16x16x32_bf16 v[172:175], a[128:131], a[16:19], v[172:175]
    s_waitcnt lgkmcnt(14)
    ds_read_b64_tr_b16 a[204:205], v223 offset:8192
    ds_read_b64_tr_b16 a[206:207], v223 offset:12288
    v_mfma_f32_16x16x16_bf16 v[0:3], a[144:145], v[176:177], 0
    s_waitcnt lgkmcnt(14)
    v_add_f32 v163, v163, v196
    v_cvt_pk_bf16_f32 v80, v80, v81
    v_cvt_pk_bf16_f32 v81, v82, v83
    v_mfma_f32_16x16x16_bf16 v[4:7], a[148:149], v[176:177], 0
    ds_write_b64 v251, v[76:77] offset:8192
    v_exp_f32 v160, v160
    v_mfma_f32_16x16x16_bf16 v[8:11], a[152:153], v[176:177], 0
    s_waitcnt lgkmcnt(14)
    v_exp_f32 v161, v161
    v_mfma_f32_16x16x16_bf16 v[12:15], a[156:157], v[176:177], 0
    v_exp_f32 v162, v162
    v_mfma_f32_16x16x16_bf16 a[208:211], a[228:229], v[176:177], 0
    v_exp_f32 v163, v163
    v_mfma_f32_16x16x32_bf16 v[0:3], a[176:179], v[180:183], v[0:3]
    v_cvt_pk_bf16_f32 v184, v160, v161
    v_cvt_pk_bf16_f32 v84, v84, v85
    v_cvt_pk_bf16_f32 v85, v86, v87
    v_mfma_f32_16x16x32_bf16 v[4:7], a[180:183], v[180:183], v[4:7]
    ds_write_b64 v252, v[80:81] offset:8192
    v_mfma_f32_16x16x32_bf16 v[8:11], a[184:187], v[180:183], v[8:11]
    s_waitcnt lgkmcnt(14)
    v_cvt_pk_bf16_f32 v185, v162, v163
    v_mfma_f32_16x16x32_bf16 v[12:15], a[188:191], v[180:183], v[12:15]
    v_cvt_pk_bf16_f32 v88, v88, v89
    v_cvt_pk_bf16_f32 v89, v90, v91
    v_mfma_f32_16x16x32_bf16 v[160:163], a[80:83], a[32:35], 0
    v_exp_f32 v168, v168
    v_mfma_f32_16x16x32_bf16 v[160:163], a[84:87], a[36:39], v[160:163]
    v_exp_f32 v169, v169
    v_mfma_f32_16x16x32_bf16 v[160:163], a[88:91], a[40:43], v[160:163]
    ds_write_b64 v253, v[84:85] offset:8192
    v_mfma_f32_16x16x32_bf16 v[160:163], a[92:95], a[44:47], v[160:163]
    s_waitcnt lgkmcnt(14)
    v_exp_f32 v170, v170
    v_mfma_f32_16x16x16_bf16 v[16:19], a[160:161], v[176:177], 0
    v_exp_f32 v171, v171
    v_cvt_pk_bf16_f32 v92, v92, v93
    v_cvt_pk_bf16_f32 v93, v94, v95
    v_mfma_f32_16x16x16_bf16 v[20:23], a[164:165], v[176:177], 0
    s_waitcnt lgkmcnt(13)
    v_cvt_pk_bf16_f32 v188, v168, v169
    v_cvt_pk_bf16_f32 v189, v170, v171
    v_mfma_f32_16x16x16_bf16 v[24:27], a[168:169], v[176:177], 0
    s_waitcnt lgkmcnt(12)
    v_exp_f32 v172, v172
    v_max3_f32 v236, v160, v161, v162
    v_max_f32 v236, v236, v163
    v_mfma_f32_16x16x16_bf16 v[28:31], a[172:173], v[176:177], 0
    v_exp_f32 v173, v173
    v_mov_b32 v237, v236
    s_nop 1
    v_permlane32_swap_b32 v236, v237
    v_mfma_f32_16x16x32_bf16 a[208:211], a[228:231], v[180:183], a[208:211]
    s_waitcnt lgkmcnt(10)
    ds_write_b64 v254, v[88:89] offset:8192
    v_max_f32 v236, v236, v237
    v_mov_b32 v237, v236
    v_mfma_f32_16x16x32_bf16 v[16:19], a[192:195], v[180:183], v[16:19]
    s_waitcnt lgkmcnt(8)
    v_exp_f32 v174, v174
    v_permlane16_swap_b32 v236, v237
    v_max_f32 v236, v236, v237
    v_mfma_f32_16x16x32_bf16 v[20:23], a[196:199], v[180:183], v[20:23]
    s_waitcnt lgkmcnt(6)
    ds_write_b64 v255, v[92:93] offset:8192
    v_exp_f32 v175, v175
    v_sub_f32 v200, 0, v236
    v_sub_f32 v201, 0, v236
    v_mfma_f32_16x16x32_bf16 v[24:27], a[200:203], v[180:183], v[24:27]
    s_waitcnt lgkmcnt(5)
    v_cvt_pk_bf16_f32 v190, v172, v173
    v_cvt_pk_bf16_f32 v191, v174, v175
    v_sub_f32 v202, 0, v236
    v_sub_f32 v203, 0, v236
    v_mfma_f32_16x16x32_bf16 v[28:31], a[204:207], v[180:183], v[28:31]
    s_waitcnt vmcnt(4)
    s_barrier
    v_mfma_f32_16x16x32_bf16 v[168:171], a[112:115], a[32:35], v[200:203]
    s_add_u32 s24, s24, 8192
    v_add_f32 v160, v160, v200
    v_mfma_f32_16x16x32_bf16 v[168:171], a[116:119], a[36:39], v[168:171]
    v_add_f32 v161, v161, v200
    v_mfma_f32_16x16x32_bf16 v[168:171], a[120:123], a[40:43], v[168:171]
    v_accvgpr_read_b32 v239, a220
    v_accvgpr_read_b32 v238, a221
    v_add_f32 v239, v239, v238
    v_cmp_nge_f32 s[62:63], s37, v239
    v_mfma_f32_16x16x32_bf16 v[168:171], a[124:127], a[44:47], v[168:171]
    s_add_u32 m0, s32, 0
    v_add_f32 v162, v162, v200
    v_mfma_f32_16x16x32_bf16 v[172:175], a[140:143], a[44:47], v[200:203]
    v_rcp_f32 v239, v239
    s_or_b64 s[40:41], s[40:41], s[62:63]
    v_pk_mul_f32 v[96:97], v[96:97], v[238:239] op_sel:[0,1] op_sel_hi:[1,1]
    v_pk_mul_f32 v[98:99], v[98:99], v[238:239] op_sel:[0,1] op_sel_hi:[1,1]
    v_pk_mul_f32 v[100:101], v[100:101], v[238:239] op_sel:[0,1] op_sel_hi:[1,1]
    v_pk_mul_f32 v[102:103], v[102:103], v[238:239] op_sel:[0,1] op_sel_hi:[1,1]
    v_pk_mul_f32 v[104:105], v[104:105], v[238:239] op_sel:[0,1] op_sel_hi:[1,1]
    v_pk_mul_f32 v[106:107], v[106:107], v[238:239] op_sel:[0,1] op_sel_hi:[1,1]
    v_pk_mul_f32 v[108:109], v[108:109], v[238:239] op_sel:[0,1] op_sel_hi:[1,1]
    v_pk_mul_f32 v[110:111], v[110:111], v[238:239] op_sel:[0,1] op_sel_hi:[1,1]
    v_pk_mul_f32 v[112:113], v[112:113], v[238:239] op_sel:[0,1] op_sel_hi:[1,1]
    v_pk_mul_f32 v[114:115], v[114:115], v[238:239] op_sel:[0,1] op_sel_hi:[1,1]
    v_pk_mul_f32 v[116:117], v[116:117], v[238:239] op_sel:[0,1] op_sel_hi:[1,1]
    v_pk_mul_f32 v[118:119], v[118:119], v[238:239] op_sel:[0,1] op_sel_hi:[1,1]
    v_pk_mul_f32 v[120:121], v[120:121], v[238:239] op_sel:[0,1] op_sel_hi:[1,1]
    v_pk_mul_f32 v[122:123], v[122:123], v[238:239] op_sel:[0,1] op_sel_hi:[1,1]
    v_pk_mul_f32 v[124:125], v[124:125], v[238:239] op_sel:[0,1] op_sel_hi:[1,1]
    v_pk_mul_f32 v[126:127], v[126:127], v[238:239] op_sel:[0,1] op_sel_hi:[1,1]
    v_mfma_f32_16x16x32_bf16 v[172:175], a[136:139], a[40:43], v[172:175]
    v_add_f32 v163, v163, v200
    v_mfma_f32_16x16x32_bf16 v[172:175], a[132:135], a[36:39], v[172:175]
    buffer_load_dwordx4 v224, s[4:7], s24 offen offset:0 lds
    v_cvt_pk_bf16_f32 v96, v96, v97
    v_cvt_pk_bf16_f32 v97, v98, v99
    v_mfma_f32_16x16x32_bf16 v[172:175], a[128:131], a[32:35], v[172:175]
    v_exp_f32 v160, v160
    v_mfma_f32_16x16x16_bf16 v[32:35], a[144:145], v[184:185], 0
    v_exp_f32 v161, v161
    v_mfma_f32_16x16x16_bf16 v[36:39], a[148:149], v[184:185], 0
    buffer_load_dwordx4 v225, s[4:7], s24 offen offset:1024 lds
    v_mfma_f32_16x16x16_bf16 v[40:43], a[152:153], v[184:185], 0
    v_exp_f32 v162, v162
    v_mfma_f32_16x16x16_bf16 v[44:47], a[156:157], v[184:185], 0
    v_exp_f32 v163, v163
    v_mfma_f32_16x16x16_bf16 a[212:215], a[228:229], v[184:185], 0
    s_add_u32 m0, s32, 40960
    v_cvt_pk_bf16_f32 v100, v100, v101
    v_cvt_pk_bf16_f32 v101, v102, v103
    v_mfma_f32_16x16x32_bf16 v[32:35], a[176:179], v[188:191], v[32:35]
    v_cvt_pk_bf16_f32 v176, v160, v161
    v_mfma_f32_16x16x32_bf16 v[36:39], a[180:183], v[188:191], v[36:39]
    ds_write_b64 v248, v[96:97] offset:12288
    v_mfma_f32_16x16x32_bf16 v[40:43], a[184:187], v[188:191], v[40:43]
    buffer_load_dwordx4 v226, s[8:11], s24 offen offset:0 lds
    v_mfma_f32_16x16x32_bf16 v[44:47], a[188:191], v[188:191], v[44:47]
    v_cvt_pk_bf16_f32 v177, v162, v163
    v_cvt_pk_bf16_f32 v104, v104, v105
    v_cvt_pk_bf16_f32 v105, v106, v107
    v_mfma_f32_16x16x32_bf16 v[160:163], a[80:83], a[48:51], 0
    ds_write_b64 v249, v[100:101] offset:12288
    v_exp_f32 v168, v168
    v_mfma_f32_16x16x32_bf16 v[160:163], a[84:87], a[52:55], v[160:163]
    v_exp_f32 v169, v169
    v_mfma_f32_16x16x32_bf16 v[160:163], a[88:91], a[56:59], v[160:163]
    buffer_load_dwordx4 v227, s[8:11], s24 offen offset:1024 lds
    v_mfma_f32_16x16x32_bf16 v[160:163], a[92:95], a[60:63], v[160:163]
    v_exp_f32 v170, v170
    v_cvt_pk_bf16_f32 v108, v108, v109
    v_cvt_pk_bf16_f32 v109, v110, v111
    v_mfma_f32_16x16x16_bf16 v[48:51], a[160:161], v[184:185], 0
    v_exp_f32 v171, v171
    v_mfma_f32_16x16x16_bf16 v[52:55], a[164:165], v[184:185], 0
    s_add_u32 s24, s24, 8192
    ds_write_b64 v250, v[104:105] offset:12288
    v_cvt_pk_bf16_f32 v180, v168, v169
    v_cvt_pk_bf16_f32 v181, v170, v171
    v_mfma_f32_16x16x16_bf16 v[56:59], a[168:169], v[184:185], 0
    v_exp_f32 v172, v172
    v_max3_f32 v236, v160, v161, v162
    v_max_f32 v236, v236, v163
    v_mfma_f32_16x16x16_bf16 v[60:63], a[172:173], v[184:185], 0
    v_exp_f32 v173, v173
    v_mov_b32 v237, v236
    s_nop 1
    v_permlane32_swap_b32 v236, v237
    v_mfma_f32_16x16x32_bf16 a[212:215], a[228:231], v[188:191], a[212:215]
    v_max_f32 v236, v236, v237
    v_mov_b32 v237, v236
    v_cvt_pk_bf16_f32 v112, v112, v113
    v_cvt_pk_bf16_f32 v113, v114, v115
    v_mfma_f32_16x16x32_bf16 v[48:51], a[192:195], v[188:191], v[48:51]
    s_add_u32 m0, s32, 8192
    v_exp_f32 v174, v174
    v_permlane16_swap_b32 v236, v237
    v_max_f32 v236, v236, v237
    v_mfma_f32_16x16x32_bf16 v[52:55], a[196:199], v[188:191], v[52:55]
    v_exp_f32 v175, v175
    v_sub_f32 v204, 0, v236
    v_sub_f32 v205, 0, v236
    v_mfma_f32_16x16x32_bf16 v[56:59], a[200:203], v[188:191], v[56:59]
    v_cvt_pk_bf16_f32 v182, v172, v173
    v_cvt_pk_bf16_f32 v183, v174, v175
    v_sub_f32 v206, 0, v236
    v_sub_f32 v207, 0, v236
    v_mfma_f32_16x16x32_bf16 v[60:63], a[204:207], v[188:191], v[60:63]
    ds_write_b64 v251, v[108:109] offset:12288
    v_mfma_f32_16x16x32_bf16 v[168:171], a[112:115], a[48:51], v[204:207]
    buffer_load_dwordx4 v224, s[4:7], s24 offen offset:0 lds
    v_mfma_f32_16x16x32_bf16 v[168:171], a[116:119], a[52:55], v[168:171]
    v_add_f32 v160, v160, v204
    v_add_f32 v161, v161, v204
    v_mfma_f32_16x16x32_bf16 v[168:171], a[120:123], a[56:59], v[168:171]
    v_cvt_pk_bf16_f32 v116, v116, v117
    v_cvt_pk_bf16_f32 v117, v118, v119
    v_mfma_f32_16x16x32_bf16 v[168:171], a[124:127], a[60:63], v[168:171]
    ds_write_b64 v252, v[112:113] offset:12288
    v_add_f32 v162, v162, v204
    v_mfma_f32_16x16x32_bf16 v[172:175], a[140:143], a[60:63], v[204:207]
    buffer_load_dwordx4 v225, s[4:7], s24 offen offset:1024 lds
    v_mfma_f32_16x16x32_bf16 v[172:175], a[136:139], a[56:59], v[172:175]
    v_add_f32 v163, v163, v204
    v_mfma_f32_16x16x32_bf16 v[172:175], a[132:135], a[52:55], v[172:175]
    v_exp_f32 v160, v160
    v_mfma_f32_16x16x32_bf16 v[172:175], a[128:131], a[48:51], v[172:175]
    v_cvt_pk_bf16_f32 v120, v120, v121
    v_cvt_pk_bf16_f32 v121, v122, v123
    v_mfma_f32_16x16x16_bf16 v[64:67], a[144:145], v[176:177], 0
    v_exp_f32 v161, v161
    v_mfma_f32_16x16x16_bf16 v[68:71], a[148:149], v[176:177], 0
    s_add_u32 m0, s32, 49152
    ds_write_b64 v253, v[116:117] offset:12288
    v_mfma_f32_16x16x16_bf16 v[72:75], a[152:153], v[176:177], 0
    v_exp_f32 v162, v162
    v_mfma_f32_16x16x16_bf16 v[76:79], a[156:157], v[176:177], 0
    v_exp_f32 v163, v163
    v_mfma_f32_16x16x16_bf16 a[216:219], a[228:229], v[176:177], 0
    v_cvt_pk_bf16_f32 v124, v124, v125
    v_cvt_pk_bf16_f32 v125, v126, v127
    v_mfma_f32_16x16x32_bf16 v[64:67], a[176:179], v[180:183], v[64:67]
    buffer_load_dwordx4 v226, s[8:11], s24 offen offset:0 lds
    v_mfma_f32_16x16x32_bf16 v[68:71], a[180:183], v[180:183], v[68:71]
    v_cvt_pk_bf16_f32 v184, v160, v161
    v_mfma_f32_16x16x32_bf16 v[72:75], a[184:187], v[180:183], v[72:75]
    v_cvt_pk_bf16_f32 v185, v162, v163
    v_mfma_f32_16x16x32_bf16 v[76:79], a[188:191], v[180:183], v[76:79]
    ds_write_b64 v254, v[120:121] offset:12288
    v_mfma_f32_16x16x32_bf16 v[160:163], a[80:83], a[64:67], 0
    ds_write_b64 v255, v[124:125] offset:12288
    v_exp_f32 v168, v168
    v_mfma_f32_16x16x32_bf16 v[160:163], a[84:87], a[68:71], v[160:163]
    v_exp_f32 v169, v169
    v_mfma_f32_16x16x32_bf16 v[160:163], a[88:91], a[72:75], v[160:163]
    buffer_load_dwordx4 v227, s[8:11], s24 offen offset:1024 lds
    v_accvgpr_read_b32 v239, a224
    v_accvgpr_read_b32 v238, a225
    v_add_f32 v239, v239, v238
    v_cmp_nge_f32 s[62:63], s37, v239
    v_mfma_f32_16x16x32_bf16 v[160:163], a[92:95], a[76:79], v[160:163]
    v_exp_f32 v170, v170
    v_mfma_f32_16x16x16_bf16 v[80:83], a[160:161], v[176:177], 0
    v_exp_f32 v171, v171
    v_rcp_f32 v239, v239
    s_or_b64 s[40:41], s[40:41], s[62:63]
    v_mfma_f32_16x16x16_bf16 v[84:87], a[164:165], v[176:177], 0
    v_cvt_pk_bf16_f32 v188, v168, v169
    v_cvt_pk_bf16_f32 v189, v170, v171
    v_mfma_f32_16x16x16_bf16 v[88:91], a[168:169], v[176:177], 0
    v_exp_f32 v172, v172
    v_max3_f32 v236, v160, v161, v162
    v_max3_f32 v236, v236, v163, s57
    v_mfma_f32_16x16x16_bf16 v[92:95], a[172:173], v[176:177], 0
    v_exp_f32 v173, v173
    v_mov_b32 v237, v236
    s_nop 1
    v_permlane32_swap_b32 v236, v237
    v_pk_mul_f32 v[128:129], v[128:129], v[238:239] op_sel:[0,1] op_sel_hi:[1,1]
    v_pk_mul_f32 v[130:131], v[130:131], v[238:239] op_sel:[0,1] op_sel_hi:[1,1]
    v_pk_mul_f32 v[132:133], v[132:133], v[238:239] op_sel:[0,1] op_sel_hi:[1,1]
    v_pk_mul_f32 v[134:135], v[134:135], v[238:239] op_sel:[0,1] op_sel_hi:[1,1]
    v_pk_mul_f32 v[136:137], v[136:137], v[238:239] op_sel:[0,1] op_sel_hi:[1,1]
    v_pk_mul_f32 v[138:139], v[138:139], v[238:239] op_sel:[0,1] op_sel_hi:[1,1]
    v_pk_mul_f32 v[140:141], v[140:141], v[238:239] op_sel:[0,1] op_sel_hi:[1,1]
    v_pk_mul_f32 v[142:143], v[142:143], v[238:239] op_sel:[0,1] op_sel_hi:[1,1]
    v_pk_mul_f32 v[144:145], v[144:145], v[238:239] op_sel:[0,1] op_sel_hi:[1,1]
    v_pk_mul_f32 v[146:147], v[146:147], v[238:239] op_sel:[0,1] op_sel_hi:[1,1]
    v_pk_mul_f32 v[148:149], v[148:149], v[238:239] op_sel:[0,1] op_sel_hi:[1,1]
    v_pk_mul_f32 v[150:151], v[150:151], v[238:239] op_sel:[0,1] op_sel_hi:[1,1]
    v_pk_mul_f32 v[152:153], v[152:153], v[238:239] op_sel:[0,1] op_sel_hi:[1,1]
    v_pk_mul_f32 v[154:155], v[154:155], v[238:239] op_sel:[0,1] op_sel_hi:[1,1]
    v_pk_mul_f32 v[156:157], v[156:157], v[238:239] op_sel:[0,1] op_sel_hi:[1,1]
    v_pk_mul_f32 v[158:159], v[158:159], v[238:239] op_sel:[0,1] op_sel_hi:[1,1]
    v_mfma_f32_16x16x32_bf16 a[216:219], a[228:231], v[180:183], a[216:219]
    ds_read_b128 a[80:83], v212 offset:16384
    ds_read_b128 a[84:87], v213 offset:16384
    v_max_f32 v236, v236, v237
    v_mov_b32 v237, v236
    v_mfma_f32_16x16x32_bf16 v[80:83], a[192:195], v[180:183], v[80:83]
    v_exp_f32 v174, v174
    v_permlane16_swap_b32 v236, v237
    v_max_f32 v236, v236, v237
    v_mfma_f32_16x16x32_bf16 v[84:87], a[196:199], v[180:183], v[84:87]
    v_exp_f32 v175, v175
    v_sub_f32 v208, 0, v236
    v_sub_f32 v209, 0, v236
    v_mfma_f32_16x16x32_bf16 v[88:91], a[200:203], v[180:183], v[88:91]
    v_cvt_pk_bf16_f32 v190, v172, v173
    v_cvt_pk_bf16_f32 v191, v174, v175
    v_sub_f32 v210, 0, v236
    v_sub_f32 v211, 0, v236
    v_mfma_f32_16x16x32_bf16 v[92:95], a[204:207], v[180:183], v[92:95]
    ds_read_b128 a[88:91], v214 offset:16384
    ds_read_b128 a[92:95], v215 offset:16384
    v_cvt_pk_bf16_f32 v128, v128, v129
    v_cvt_pk_bf16_f32 v129, v130, v131
    v_mfma_f32_16x16x32_bf16 v[168:171], a[112:115], a[64:67], v[208:211]
    v_add_f32 v160, v160, v208
    v_mfma_f32_16x16x32_bf16 v[168:171], a[116:119], a[68:71], v[168:171]
    ds_read_b128 a[96:99], v212 offset:20480
    v_add_f32 v161, v161, v208
    v_mfma_f32_16x16x32_bf16 v[168:171], a[120:123], a[72:75], v[168:171]
    v_cvt_pk_bf16_f32 v132, v132, v133
    v_cvt_pk_bf16_f32 v133, v134, v135
    v_mfma_f32_16x16x32_bf16 v[168:171], a[124:127], a[76:79], v[168:171]
    ds_read_b128 a[100:103], v213 offset:20480
    v_add_f32 v162, v162, v208
    v_mfma_f32_16x16x32_bf16 v[172:175], a[140:143], a[76:79], v[208:211]
    ds_write_b64 v248, v[128:129] offset:16384
    v_mfma_f32_16x16x32_bf16 v[172:175], a[136:139], a[72:75], v[172:175]
    v_add_f32 v163, v163, v208
    v_cvt_pk_bf16_f32 v136, v136, v137
    v_cvt_pk_bf16_f32 v137, v138, v139
    v_mfma_f32_16x16x32_bf16 v[172:175], a[132:135], a[68:71], v[172:175]
    ds_read_b128 a[104:107], v214 offset:20480
    v_mfma_f32_16x16x32_bf16 v[172:175], a[128:131], a[64:67], v[172:175]
    v_exp_f32 v160, v160
    v_mfma_f32_16x16x16_bf16 v[96:99], a[144:145], v[184:185], 0
    ds_read_b128 a[108:111], v215 offset:20480
    ds_read_b128 a[112:115], v212 offset:24576
    v_mfma_f32_16x16x16_bf16 v[100:103], a[148:149], v[184:185], 0
    v_exp_f32 v161, v161
    v_mfma_f32_16x16x16_bf16 v[104:107], a[152:153], v[184:185], 0
    ds_read_b128 a[116:119], v213 offset:24576
    ds_write_b64 v249, v[132:133] offset:16384
    v_mfma_f32_16x16x16_bf16 v[108:111], a[156:157], v[184:185], 0
    v_exp_f32 v162, v162
    v_cvt_pk_bf16_f32 v140, v140, v141
    v_cvt_pk_bf16_f32 v141, v142, v143
    v_mfma_f32_16x16x16_bf16 a[220:223], a[228:229], v[184:185], 0
    v_exp_f32 v163, v163
    v_mfma_f32_16x16x32_bf16 v[96:99], a[176:179], v[188:191], v[96:99]
    ds_read_b128 a[120:123], v214 offset:24576
    v_cvt_pk_bf16_f32 v176, v160, v161
    v_mfma_f32_16x16x32_bf16 v[100:103], a[180:183], v[188:191], v[100:103]
    ds_write_b64 v250, v[136:137] offset:16384
    v_mfma_f32_16x16x32_bf16 v[104:107], a[184:187], v[188:191], v[104:107]
    ds_read_b128 a[124:127], v215 offset:24576
    v_cvt_pk_bf16_f32 v177, v162, v163
    v_mfma_f32_16x16x32_bf16 v[108:111], a[188:191], v[188:191], v[108:111]
    s_waitcnt lgkmcnt(6)
    v_cvt_pk_bf16_f32 v144, v144, v145
    v_cvt_pk_bf16_f32 v145, v146, v147
    v_mfma_f32_16x16x32_bf16 v[160:163], a[80:83], a[0:3], v[192:195]
    v_exp_f32 v168, v168
    v_mfma_f32_16x16x32_bf16 v[160:163], a[84:87], a[4:7], v[160:163]
    ds_read_b128 a[128:131], v212 offset:28672
    ds_write_b64 v251, v[140:141] offset:16384
    v_mfma_f32_16x16x32_bf16 v[160:163], a[88:91], a[8:11], v[160:163]
    v_exp_f32 v169, v169
    v_mfma_f32_16x16x32_bf16 v[160:163], a[92:95], a[12:15], v[160:163]
    ds_read_b128 a[132:135], v213 offset:28672
    v_mfma_f32_16x16x32_bf16 v[164:167], a[108:111], a[12:15], v[192:195]
    v_exp_f32 v170, v170
    v_mfma_f32_16x16x32_bf16 v[164:167], a[104:107], a[8:11], v[164:167]
    v_cvt_pk_bf16_f32 v148, v148, v149
    v_cvt_pk_bf16_f32 v149, v150, v151
    v_mfma_f32_16x16x32_bf16 v[164:167], a[100:103], a[4:7], v[164:167]
    ds_write_b64 v252, v[144:145] offset:16384
    v_exp_f32 v171, v171
    v_mfma_f32_16x16x32_bf16 v[164:167], a[96:99], a[0:3], v[164:167]
    v_cvt_pk_bf16_f32 v180, v168, v169
    v_cvt_pk_bf16_f32 v181, v170, v171
    v_mfma_f32_16x16x16_bf16 v[112:115], a[160:161], v[184:185], 0
    v_exp_f32 v172, v172
    v_mfma_f32_16x16x16_bf16 v[116:119], a[164:165], v[184:185], 0
    ds_read_b128 a[136:139], v214 offset:28672
    ds_read_b128 a[140:143], v215 offset:28672
    v_mfma_f32_16x16x16_bf16 v[120:123], a[168:169], v[184:185], 0
    v_exp_f32 v173, v173
    v_mfma_f32_16x16x16_bf16 v[124:127], a[172:173], v[184:185], 0
    v_cvt_pk_bf16_f32 v152, v152, v153
    v_cvt_pk_bf16_f32 v153, v154, v155
    v_mfma_f32_16x16x32_bf16 a[220:223], a[228:231], v[188:191], a[220:223]
    v_exp_f32 v174, v174
    v_mfma_f32_16x16x32_bf16 v[112:115], a[192:195], v[188:191], v[112:115]
    ds_write_b64 v253, v[148:149] offset:16384
    v_mfma_f32_16x16x32_bf16 v[116:119], a[196:199], v[188:191], v[116:119]
    v_exp_f32 v175, v175
    v_mfma_f32_16x16x32_bf16 v[120:123], a[200:203], v[188:191], v[120:123]
    v_cvt_pk_bf16_f32 v182, v172, v173
    v_cvt_pk_bf16_f32 v183, v174, v175
    v_mfma_f32_16x16x32_bf16 v[124:127], a[204:207], v[188:191], v[124:127]
    s_waitcnt lgkmcnt(1)
    v_cvt_pk_bf16_f32 v156, v156, v157
    v_cvt_pk_bf16_f32 v157, v158, v159
    v_mfma_f32_16x16x32_bf16 v[168:171], a[112:115], a[0:3], v[192:195]
    v_exp_f32 v160, v160
    v_mfma_f32_16x16x32_bf16 v[168:171], a[116:119], a[4:7], v[168:171]
    ds_write_b64 v254, v[152:153] offset:16384
    v_mfma_f32_16x16x32_bf16 v[168:171], a[120:123], a[8:11], v[168:171]
    v_exp_f32 v161, v161
    v_mfma_f32_16x16x32_bf16 v[168:171], a[124:127], a[12:15], v[168:171]
    ds_write_b64 v255, v[156:157] offset:16384
    v_mfma_f32_16x16x32_bf16 v[172:175], a[140:143], a[12:15], v[192:195]
    v_exp_f32 v162, v162
    v_mfma_f32_16x16x32_bf16 v[172:175], a[136:139], a[8:11], v[172:175]
    v_mfma_f32_16x16x32_bf16 v[172:175], a[132:135], a[4:7], v[172:175]
    v_exp_f32 v163, v163
    v_mfma_f32_16x16x32_bf16 v[172:175], a[128:131], a[0:3], v[172:175]
    s_cmp_lg_u64 s[40:41], 0
    s_cselect_b32 s45, s42, 0
    s_or_b32 s36, s36, s45
    s_lshl_b32 s42, s42, 1
    s_mov_b64 s[40:41], 0
    v_cvt_pk_bf16_f32 v184, v160, v161
    v_cvt_pk_bf16_f32 v185, v162, v163
    v_mfma_f32_16x16x16_bf16 v[128:131], a[144:145], v[176:177], 0
    v_exp_f32 v164, v164
    v_mfma_f32_16x16x16_bf16 v[132:135], a[148:149], v[176:177], 0
    v_mfma_f32_16x16x16_bf16 v[136:139], a[152:153], v[176:177], 0
    v_exp_f32 v165, v165
    v_mfma_f32_16x16x16_bf16 v[140:143], a[156:157], v[176:177], 0
    v_mfma_f32_16x16x16_bf16 a[224:227], a[228:229], v[176:177], 0
    v_exp_f32 v166, v166
    s_nop 0
    v_mfma_f32_16x16x32_bf16 v[128:131], a[176:179], v[180:183], v[128:131]
    s_nop 0
    v_mfma_f32_16x16x32_bf16 v[132:135], a[180:183], v[180:183], v[132:135]
    v_exp_f32 v167, v167
    v_mfma_f32_16x16x32_bf16 v[136:139], a[184:187], v[180:183], v[136:139]
    v_cvt_pk_bf16_f32 v186, v164, v165
    v_cvt_pk_bf16_f32 v187, v166, v167
    v_mfma_f32_16x16x32_bf16 v[140:143], a[188:191], v[180:183], v[140:143]
    s_branch L_body
L_tail:
    v_mfma_f32_16x16x32_bf16 v[160:163], a[80:83], a[16:19], v[196:199]
    v_exp_f32 v168, v168
    v_add_u32 v232, s52, v212
    v_mfma_f32_16x16x32_bf16 v[160:163], a[84:87], a[20:23], v[160:163]
    ds_read_b64_tr_b16 a[148:149], v217 offset:24576
    ds_read_b64_tr_b16 a[150:151], v217 offset:28672
    v_mfma_f32_16x16x32_bf16 v[160:163], a[88:91], a[24:27], v[160:163]
    v_exp_f32 v169, v169
    v_add_u32 v233, s52, v213
    v_mfma_f32_16x16x32_bf16 v[160:163], a[92:95], a[28:31], v[160:163]
    ds_read_b64_tr_b16 a[152:153], v218 offset:24576
    ds_read_b64_tr_b16 a[154:155], v218 offset:28672
    v_mfma_f32_16x16x32_bf16 v[164:167], a[108:111], a[28:31], v[196:199]
    v_exp_f32 v170, v170
    v_add_u32 v234, s52, v214
    v_mfma_f32_16x16x32_bf16 v[164:167], a[104:107], a[24:27], v[164:167]
    ds_read_b64_tr_b16 a[184:185], v218 offset:32768
    ds_read_b64_tr_b16 a[186:187], v218 offset:36864
    v_mfma_f32_16x16x32_bf16 v[164:167], a[100:103], a[20:23], v[164:167]
    v_exp_f32 v171, v171
    v_add_u32 v235, s52, v215
    v_mfma_f32_16x16x32_bf16 v[164:167], a[96:99], a[16:19], v[164:167]
    v_cvt_pk_bf16_f32 v188, v168, v169
    v_cvt_pk_bf16_f32 v189, v170, v171
    v_mfma_f32_16x16x32_bf16 v[144:147], a[192:195], v[180:183], v[144:147]
    v_exp_f32 v172, v172
    v_mfma_f32_16x16x32_bf16 v[144:147], a[160:163], v[176:179], v[144:147]
    ds_read_b64_tr_b16 a[188:189], v219 offset:32768
    ds_read_b64_tr_b16 a[190:191], v219 offset:36864
    v_xor_b32 v249, 0x28, v232
    v_mfma_f32_16x16x32_bf16 v[148:151], a[164:167], v[176:179], v[148:151]
    v_exp_f32 v173, v173
    v_mfma_f32_16x16x32_bf16 v[148:151], a[196:199], v[180:183], v[148:151]
    ds_read_b64_tr_b16 a[156:157], v219 offset:24576
    ds_read_b64_tr_b16 a[158:159], v219 offset:28672
    v_mfma_f32_16x16x32_bf16 v[152:155], a[200:203], v[180:183], v[152:155]
    v_exp_f32 v174, v174
    v_mfma_f32_16x16x32_bf16 v[152:155], a[168:171], v[176:179], v[152:155]
    ds_read_b64_tr_b16 a[192:193], v220 offset:32768
    ds_read_b64_tr_b16 a[194:195], v220 offset:36864
    v_cndmask_b32 v248, v232, v249, s[58:59]
    v_mfma_f32_16x16x32_bf16 v[156:159], a[172:175], v[176:179], v[156:159]
    v_exp_f32 v175, v175
    v_mfma_f32_16x16x32_bf16 v[156:159], a[204:207], v[180:183], v[156:159]
    v_cvt_pk_bf16_f32 v190, v172, v173
    v_cvt_pk_bf16_f32 v191, v174, v175
    v_smfmac_f32_16x16x64_bf16 a[224:227], a[248:251], v[176:183], v231
    ds_read_b64_tr_b16 a[160:161], v220 offset:24576
    v_mfma_f32_16x16x32_bf16 v[168:171], a[112:115], a[16:19], v[196:199]
    v_exp_f32 v160, v160
    v_mfma_f32_16x16x32_bf16 v[168:171], a[116:119], a[20:23], v[168:171]
    ds_read_b64_tr_b16 a[162:163], v220 offset:28672
    ds_read_b64_tr_b16 a[164:165], v221 offset:24576
    v_xor_b32 v249, 32, v248
    v_mfma_f32_16x16x32_bf16 v[168:171], a[120:123], a[24:27], v[168:171]
    v_exp_f32 v161, v161
    v_mfma_f32_16x16x32_bf16 v[168:171], a[124:127], a[28:31], v[168:171]
    ds_read_b64_tr_b16 a[166:167], v221 offset:28672
    ds_read_b64_tr_b16 a[196:197], v221 offset:32768
    v_mfma_f32_16x16x32_bf16 v[172:175], a[140:143], a[28:31], v[196:199]
    v_exp_f32 v162, v162
    v_mfma_f32_16x16x32_bf16 v[172:175], a[136:139], a[24:27], v[172:175]
    ds_read_b64_tr_b16 a[198:199], v221 offset:36864
    ds_read_b64_tr_b16 a[200:201], v222 offset:32768
    v_xor_b32 v250, 64, v248
    v_mfma_f32_16x16x32_bf16 v[172:175], a[132:135], a[20:23], v[172:175]
    v_exp_f32 v163, v163
    v_mfma_f32_16x16x32_bf16 v[172:175], a[128:131], a[16:19], v[172:175]
    s_waitcnt lgkmcnt(14)
    v_cvt_pk_bf16_f32 v176, v160, v161
    v_cvt_pk_bf16_f32 v177, v162, v163
    v_mfma_f32_16x16x32_bf16 v[0:3], a[144:147], v[184:187], v[0:3]
    v_exp_f32 v164, v164
    v_mfma_f32_16x16x32_bf16 v[0:3], a[176:179], v[188:191], v[0:3]
    ds_read_b64_tr_b16 a[202:203], v222 offset:36864
    ds_read_b64_tr_b16 a[168:169], v222 offset:24576
    v_mfma_f32_16x16x32_bf16 v[4:7], a[180:183], v[188:191], v[4:7]
    s_waitcnt lgkmcnt(14)
    v_exp_f32 v165, v165
    v_xor_b32 v251, 96, v248
    v_mfma_f32_16x16x32_bf16 v[4:7], a[148:151], v[184:187], v[4:7]
    ds_read_b64_tr_b16 a[170:171], v222 offset:28672
    ds_read_b64_tr_b16 a[172:173], v223 offset:24576
    v_mfma_f32_16x16x32_bf16 v[8:11], a[152:155], v[184:187], v[8:11]
    s_waitcnt lgkmcnt(14)
    v_exp_f32 v166, v166
    v_mfma_f32_16x16x32_bf16 v[8:11], a[184:187], v[188:191], v[8:11]
    ds_read_b64_tr_b16 a[174:175], v223 offset:28672
    ds_read_b64_tr_b16 a[204:205], v223 offset:32768
    v_mfma_f32_16x16x32_bf16 v[12:15], a[188:191], v[188:191], v[12:15]
    s_waitcnt lgkmcnt(14)
    v_exp_f32 v167, v167
    v_mfma_f32_16x16x32_bf16 v[12:15], a[156:159], v[184:187], v[12:15]
    v_cvt_pk_bf16_f32 v178, v164, v165
    v_cvt_pk_bf16_f32 v179, v166, v167
    v_mfma_f32_16x16x32_bf16 v[160:163], a[80:83], a[32:35], v[200:203]
    s_add_u32 s16, s22, s35
    s_addc_u32 s17, s23, 0
    s_mov_b32 s18, 159744
    v_exp_f32 v168, v168
    v_mfma_f32_16x16x32_bf16 v[160:163], a[84:87], a[36:39], v[160:163]
    ds_read_b64_tr_b16 a[206:207], v223 offset:36864
    v_xor_b32 v252, 128, v248
    v_mfma_f32_16x16x32_bf16 v[160:163], a[88:91], a[40:43], v[160:163]
    v_exp_f32 v169, v169
    v_mfma_f32_16x16x32_bf16 v[160:163], a[92:95], a[44:47], v[160:163]
    v_xor_b32 v253, 160, v248
    v_mfma_f32_16x16x32_bf16 v[164:167], a[108:111], a[44:47], v[200:203]
    v_exp_f32 v170, v170
    v_mfma_f32_16x16x32_bf16 v[164:167], a[104:107], a[40:43], v[164:167]
    v_mfma_f32_16x16x32_bf16 v[164:167], a[100:103], a[36:39], v[164:167]
    v_exp_f32 v171, v171
    v_mfma_f32_16x16x32_bf16 v[164:167], a[96:99], a[32:35], v[164:167]
    s_waitcnt lgkmcnt(14)
    v_cvt_pk_bf16_f32 v180, v168, v169
    v_cvt_pk_bf16_f32 v181, v170, v171
    v_mfma_f32_16x16x32_bf16 v[16:19], a[192:195], v[188:191], v[16:19]
    s_waitcnt lgkmcnt(12)
    v_exp_f32 v172, v172
    v_mfma_f32_16x16x32_bf16 v[16:19], a[160:163], v[184:187], v[16:19]
    s_waitcnt lgkmcnt(10)
    v_xor_b32 v254, 192, v248
    v_mfma_f32_16x16x32_bf16 v[20:23], a[164:167], v[184:187], v[20:23]
    s_waitcnt lgkmcnt(8)
    v_exp_f32 v173, v173
    v_mfma_f32_16x16x32_bf16 v[20:23], a[196:199], v[188:191], v[20:23]
    s_waitcnt lgkmcnt(6)
    v_mfma_f32_16x16x32_bf16 v[24:27], a[200:203], v[188:191], v[24:27]
    s_waitcnt lgkmcnt(4)
    v_exp_f32 v174, v174
    v_mfma_f32_16x16x32_bf16 v[24:27], a[168:171], v[184:187], v[24:27]
    s_waitcnt lgkmcnt(2)
    v_xor_b32 v255, 224, v248
    v_mfma_f32_16x16x32_bf16 v[28:31], a[172:175], v[184:187], v[28:31]
    s_waitcnt lgkmcnt(0)
    v_exp_f32 v175, v175
    v_mfma_f32_16x16x32_bf16 v[28:31], a[204:207], v[188:191], v[28:31]
    v_cvt_pk_bf16_f32 v182, v172, v173
    v_cvt_pk_bf16_f32 v183, v174, v175
    v_smfmac_f32_16x16x64_bf16 a[208:211], a[248:251], v[184:191], v231
    v_mfma_f32_16x16x32_bf16 v[168:171], a[112:115], a[32:35], v[200:203]
    v_exp_f32 v160, v160
    v_mfma_f32_16x16x32_bf16 v[168:171], a[116:119], a[36:39], v[168:171]
    v_mfma_f32_16x16x32_bf16 v[168:171], a[120:123], a[40:43], v[168:171]
    v_exp_f32 v161, v161
    v_mfma_f32_16x16x32_bf16 v[168:171], a[124:127], a[44:47], v[168:171]
    s_nop 5
    v_accvgpr_read_b32 v239, a208
    v_accvgpr_read_b32 v238, a209
    v_add_f32 v239, v239, v238
    v_cmp_nge_f32 s[62:63], s37, v239
    v_mfma_f32_16x16x32_bf16 v[172:175], a[140:143], a[44:47], v[200:203]
    v_exp_f32 v162, v162
    v_mfma_f32_16x16x32_bf16 v[172:175], a[136:139], a[40:43], v[172:175]
    v_rcp_f32 v239, v239
    s_or_b64 s[40:41], s[40:41], s[62:63]
    v_mfma_f32_16x16x32_bf16 v[172:175], a[132:135], a[36:39], v[172:175]
    v_exp_f32 v163, v163
    v_pk_mul_f32 v[0:1], v[0:1], v[238:239] op_sel:[0,1] op_sel_hi:[1,1]
    v_pk_mul_f32 v[2:3], v[2:3], v[238:239] op_sel:[0,1] op_sel_hi:[1,1]
    v_pk_mul_f32 v[4:5], v[4:5], v[238:239] op_sel:[0,1] op_sel_hi:[1,1]
    v_pk_mul_f32 v[6:7], v[6:7], v[238:239] op_sel:[0,1] op_sel_hi:[1,1]
    v_pk_mul_f32 v[8:9], v[8:9], v[238:239] op_sel:[0,1] op_sel_hi:[1,1]
    v_pk_mul_f32 v[10:11], v[10:11], v[238:239] op_sel:[0,1] op_sel_hi:[1,1]
    v_pk_mul_f32 v[12:13], v[12:13], v[238:239] op_sel:[0,1] op_sel_hi:[1,1]
    v_pk_mul_f32 v[14:15], v[14:15], v[238:239] op_sel:[0,1] op_sel_hi:[1,1]
    v_pk_mul_f32 v[16:17], v[16:17], v[238:239] op_sel:[0,1] op_sel_hi:[1,1]
    v_pk_mul_f32 v[18:19], v[18:19], v[238:239] op_sel:[0,1] op_sel_hi:[1,1]
    v_pk_mul_f32 v[20:21], v[20:21], v[238:239] op_sel:[0,1] op_sel_hi:[1,1]
    v_pk_mul_f32 v[22:23], v[22:23], v[238:239] op_sel:[0,1] op_sel_hi:[1,1]
    v_pk_mul_f32 v[24:25], v[24:25], v[238:239] op_sel:[0,1] op_sel_hi:[1,1]
    v_pk_mul_f32 v[26:27], v[26:27], v[238:239] op_sel:[0,1] op_sel_hi:[1,1]
    v_pk_mul_f32 v[28:29], v[28:29], v[238:239] op_sel:[0,1] op_sel_hi:[1,1]
    v_pk_mul_f32 v[30:31], v[30:31], v[238:239] op_sel:[0,1] op_sel_hi:[1,1]
    v_mfma_f32_16x16x32_bf16 v[172:175], a[128:131], a[32:35], v[172:175]
    v_cvt_pk_bf16_f32 v184, v160, v161
    v_cvt_pk_bf16_f32 v185, v162, v163
    v_mfma_f32_16x16x32_bf16 v[32:35], a[144:147], v[176:179], v[32:35]
    v_exp_f32 v164, v164
    v_mfma_f32_16x16x32_bf16 v[32:35], a[176:179], v[180:183], v[32:35]
    v_cvt_pk_bf16_f32 v0, v0, v1
    v_cvt_pk_bf16_f32 v1, v2, v3
    v_mfma_f32_16x16x32_bf16 v[36:39], a[180:183], v[180:183], v[36:39]
    v_exp_f32 v165, v165
    v_mfma_f32_16x16x32_bf16 v[36:39], a[148:151], v[176:179], v[36:39]
    v_cvt_pk_bf16_f32 v4, v4, v5
    v_cvt_pk_bf16_f32 v5, v6, v7
    v_mfma_f32_16x16x32_bf16 v[40:43], a[152:155], v[176:179], v[40:43]
    v_exp_f32 v166, v166
    v_mfma_f32_16x16x32_bf16 v[40:43], a[184:187], v[180:183], v[40:43]
    ds_write_b64 v248, v[0:1] offset:0
    v_cvt_pk_bf16_f32 v8, v8, v9
    v_cvt_pk_bf16_f32 v9, v10, v11
    v_mfma_f32_16x16x32_bf16 v[44:47], a[188:191], v[180:183], v[44:47]
    v_exp_f32 v167, v167
    v_mfma_f32_16x16x32_bf16 v[44:47], a[156:159], v[176:179], v[44:47]
    v_cvt_pk_bf16_f32 v186, v164, v165
    v_cvt_pk_bf16_f32 v187, v166, v167
    v_mfma_f32_16x16x32_bf16 v[160:163], a[80:83], a[48:51], v[204:207]
    v_exp_f32 v168, v168
    v_mfma_f32_16x16x32_bf16 v[160:163], a[84:87], a[52:55], v[160:163]
    ds_write_b64 v249, v[4:5] offset:0
    v_mfma_f32_16x16x32_bf16 v[160:163], a[88:91], a[56:59], v[160:163]
    v_exp_f32 v169, v169
    v_mfma_f32_16x16x32_bf16 v[160:163], a[92:95], a[60:63], v[160:163]
    v_cvt_pk_bf16_f32 v12, v12, v13
    v_cvt_pk_bf16_f32 v13, v14, v15
    v_mfma_f32_16x16x32_bf16 v[164:167], a[108:111], a[60:63], v[204:207]
    v_exp_f32 v170, v170
    v_mfma_f32_16x16x32_bf16 v[164:167], a[104:107], a[56:59], v[164:167]
    ds_write_b64 v250, v[8:9] offset:0
    v_cvt_pk_bf16_f32 v16, v16, v17
    v_cvt_pk_bf16_f32 v17, v18, v19
    v_mfma_f32_16x16x32_bf16 v[164:167], a[100:103], a[52:55], v[164:167]
    v_exp_f32 v171, v171
    v_mfma_f32_16x16x32_bf16 v[164:167], a[96:99], a[48:51], v[164:167]
    v_cvt_pk_bf16_f32 v188, v168, v169
    v_cvt_pk_bf16_f32 v189, v170, v171
    v_mfma_f32_16x16x32_bf16 v[48:51], a[192:195], v[180:183], v[48:51]
    v_exp_f32 v172, v172
    v_mfma_f32_16x16x32_bf16 v[48:51], a[160:163], v[176:179], v[48:51]
    ds_write_b64 v251, v[12:13] offset:0
    v_mfma_f32_16x16x32_bf16 v[52:55], a[164:167], v[176:179], v[52:55]
    v_exp_f32 v173, v173
    v_mfma_f32_16x16x32_bf16 v[52:55], a[196:199], v[180:183], v[52:55]
    v_cvt_pk_bf16_f32 v20, v20, v21
    v_cvt_pk_bf16_f32 v21, v22, v23
    v_mfma_f32_16x16x32_bf16 v[56:59], a[200:203], v[180:183], v[56:59]
    v_exp_f32 v174, v174
    v_mfma_f32_16x16x32_bf16 v[56:59], a[168:171], v[176:179], v[56:59]
    ds_write_b64 v252, v[16:17] offset:0
    v_mfma_f32_16x16x32_bf16 v[60:63], a[172:175], v[176:179], v[60:63]
    v_exp_f32 v175, v175
    v_mfma_f32_16x16x32_bf16 v[60:63], a[204:207], v[180:183], v[60:63]
    v_cvt_pk_bf16_f32 v190, v172, v173
    v_cvt_pk_bf16_f32 v191, v174, v175
    v_smfmac_f32_16x16x64_bf16 a[212:215], a[248:251], v[176:183], v231
    v_cvt_pk_bf16_f32 v24, v24, v25
    v_cvt_pk_bf16_f32 v25, v26, v27
    v_mfma_f32_16x16x32_bf16 v[168:171], a[112:115], a[48:51], v[204:207]
    ds_write_b64 v253, v[20:21] offset:0
    v_exp_f32 v160, v160
    v_cvt_pk_bf16_f32 v28, v28, v29
    v_cvt_pk_bf16_f32 v29, v30, v31
    v_mfma_f32_16x16x32_bf16 v[168:171], a[116:119], a[52:55], v[168:171]
    ds_write_b64 v254, v[24:25] offset:0
    v_mfma_f32_16x16x32_bf16 v[168:171], a[120:123], a[56:59], v[168:171]
    ds_write_b64 v255, v[28:29] offset:0
    v_exp_f32 v161, v161
    ds_read_b128 a[0:3], v230 offset:0
    v_xor_b32 v240, 64, v230
    ds_read_b128 a[4:7], v240 offset:1024
    v_xor_b32 v240, 128, v230
    ds_read_b128 a[8:11], v240 offset:2048
    v_xor_b32 v240, 192, v230
    ds_read_b128 a[12:15], v240 offset:3072
    v_mfma_f32_16x16x32_bf16 v[168:171], a[124:127], a[60:63], v[168:171]
    v_accvgpr_read_b32 v239, a212
    v_accvgpr_read_b32 v238, a213
    v_add_f32 v239, v239, v238
    v_cmp_nge_f32 s[62:63], s37, v239
    v_mfma_f32_16x16x32_bf16 v[172:175], a[140:143], a[60:63], v[204:207]
    v_exp_f32 v162, v162
    v_mfma_f32_16x16x32_bf16 v[172:175], a[136:139], a[56:59], v[172:175]
    v_rcp_f32 v239, v239
    s_or_b64 s[40:41], s[40:41], s[62:63]
    s_waitcnt lgkmcnt(0)
    buffer_store_dwordx4 a[0:3], v228, s[16:19], 0 offen offset:0 nt
    buffer_store_dwordx4 a[4:7], v228, s[16:19], 0 offen offset:1024 nt
    buffer_store_dwordx4 a[8:11], v228, s[16:19], 0 offen offset:2048 nt
    buffer_store_dwordx4 a[12:15], v228, s[16:19], 0 offen offset:3072 nt
    v_mfma_f32_16x16x32_bf16 v[172:175], a[132:135], a[52:55], v[172:175]
    v_exp_f32 v163, v163
    v_pk_mul_f32 v[32:33], v[32:33], v[238:239] op_sel:[0,1] op_sel_hi:[1,1]
    v_pk_mul_f32 v[34:35], v[34:35], v[238:239] op_sel:[0,1] op_sel_hi:[1,1]
    v_pk_mul_f32 v[36:37], v[36:37], v[238:239] op_sel:[0,1] op_sel_hi:[1,1]
    v_pk_mul_f32 v[38:39], v[38:39], v[238:239] op_sel:[0,1] op_sel_hi:[1,1]
    v_pk_mul_f32 v[40:41], v[40:41], v[238:239] op_sel:[0,1] op_sel_hi:[1,1]
    v_pk_mul_f32 v[42:43], v[42:43], v[238:239] op_sel:[0,1] op_sel_hi:[1,1]
    v_pk_mul_f32 v[44:45], v[44:45], v[238:239] op_sel:[0,1] op_sel_hi:[1,1]
    v_pk_mul_f32 v[46:47], v[46:47], v[238:239] op_sel:[0,1] op_sel_hi:[1,1]
    v_pk_mul_f32 v[48:49], v[48:49], v[238:239] op_sel:[0,1] op_sel_hi:[1,1]
    v_pk_mul_f32 v[50:51], v[50:51], v[238:239] op_sel:[0,1] op_sel_hi:[1,1]
    v_pk_mul_f32 v[52:53], v[52:53], v[238:239] op_sel:[0,1] op_sel_hi:[1,1]
    v_pk_mul_f32 v[54:55], v[54:55], v[238:239] op_sel:[0,1] op_sel_hi:[1,1]
    v_pk_mul_f32 v[56:57], v[56:57], v[238:239] op_sel:[0,1] op_sel_hi:[1,1]
    v_pk_mul_f32 v[58:59], v[58:59], v[238:239] op_sel:[0,1] op_sel_hi:[1,1]
    v_pk_mul_f32 v[60:61], v[60:61], v[238:239] op_sel:[0,1] op_sel_hi:[1,1]
    v_pk_mul_f32 v[62:63], v[62:63], v[238:239] op_sel:[0,1] op_sel_hi:[1,1]
    v_mfma_f32_16x16x32_bf16 v[172:175], a[128:131], a[48:51], v[172:175]
    v_cvt_pk_bf16_f32 v176, v160, v161
    v_cvt_pk_bf16_f32 v177, v162, v163
    v_mfma_f32_16x16x32_bf16 v[64:67], a[144:147], v[184:187], v[64:67]
    v_exp_f32 v164, v164
    v_mfma_f32_16x16x32_bf16 v[64:67], a[176:179], v[188:191], v[64:67]
    v_cvt_pk_bf16_f32 v32, v32, v33
    v_cvt_pk_bf16_f32 v33, v34, v35
    v_mfma_f32_16x16x32_bf16 v[68:71], a[180:183], v[188:191], v[68:71]
    v_exp_f32 v165, v165
    v_mfma_f32_16x16x32_bf16 v[68:71], a[148:151], v[184:187], v[68:71]
    v_cvt_pk_bf16_f32 v36, v36, v37
    v_cvt_pk_bf16_f32 v37, v38, v39
    v_mfma_f32_16x16x32_bf16 v[72:75], a[152:155], v[184:187], v[72:75]
    v_exp_f32 v166, v166
    v_mfma_f32_16x16x32_bf16 v[72:75], a[184:187], v[188:191], v[72:75]
    ds_write_b64 v248, v[32:33] offset:4096
    v_cvt_pk_bf16_f32 v40, v40, v41
    v_cvt_pk_bf16_f32 v41, v42, v43
    v_mfma_f32_16x16x32_bf16 v[76:79], a[188:191], v[188:191], v[76:79]
    v_exp_f32 v167, v167
    v_mfma_f32_16x16x32_bf16 v[76:79], a[156:159], v[184:187], v[76:79]
    v_cvt_pk_bf16_f32 v178, v164, v165
    v_cvt_pk_bf16_f32 v179, v166, v167
    v_mfma_f32_16x16x32_bf16 v[160:163], a[80:83], a[64:67], v[208:211]
    v_exp_f32 v168, v168
    v_mfma_f32_16x16x32_bf16 v[160:163], a[84:87], a[68:71], v[160:163]
    ds_write_b64 v249, v[36:37] offset:4096
    v_mfma_f32_16x16x32_bf16 v[160:163], a[88:91], a[72:75], v[160:163]
    v_exp_f32 v169, v169
    v_mfma_f32_16x16x32_bf16 v[160:163], a[92:95], a[76:79], v[160:163]
    v_cvt_pk_bf16_f32 v44, v44, v45
    v_cvt_pk_bf16_f32 v45, v46, v47
    v_mfma_f32_16x16x32_bf16 v[164:167], a[108:111], a[76:79], v[208:211]
    v_exp_f32 v170, v170
    v_mfma_f32_16x16x32_bf16 v[164:167], a[104:107], a[72:75], v[164:167]
    ds_write_b64 v250, v[40:41] offset:4096
    v_cvt_pk_bf16_f32 v48, v48, v49
    v_cvt_pk_bf16_f32 v49, v50, v51
    v_mfma_f32_16x16x32_bf16 v[164:167], a[100:103], a[68:71], v[164:167]
    v_exp_f32 v171, v171
    v_mfma_f32_16x16x32_bf16 v[164:167], a[96:99], a[64:67], v[164:167]
    v_cvt_pk_bf16_f32 v180, v168, v169
    v_cvt_pk_bf16_f32 v181, v170, v171
    v_mfma_f32_16x16x32_bf16 v[80:83], a[192:195], v[188:191], v[80:83]
    v_exp_f32 v172, v172
    v_mfma_f32_16x16x32_bf16 v[80:83], a[160:163], v[184:187], v[80:83]
    ds_write_b64 v251, v[44:45] offset:4096
    v_mfma_f32_16x16x32_bf16 v[84:87], a[164:167], v[184:187], v[84:87]
    v_exp_f32 v173, v173
    v_mfma_f32_16x16x32_bf16 v[84:87], a[196:199], v[188:191], v[84:87]
    v_cvt_pk_bf16_f32 v52, v52, v53
    v_cvt_pk_bf16_f32 v53, v54, v55
    v_mfma_f32_16x16x32_bf16 v[88:91], a[200:203], v[188:191], v[88:91]
    v_exp_f32 v174, v174
    v_mfma_f32_16x16x32_bf16 v[88:91], a[168:171], v[184:187], v[88:91]
    ds_write_b64 v252, v[48:49] offset:4096
    v_mfma_f32_16x16x32_bf16 v[92:95], a[172:175], v[184:187], v[92:95]
    v_exp_f32 v175, v175
    v_mfma_f32_16x16x32_bf16 v[92:95], a[204:207], v[188:191], v[92:95]
    v_cvt_pk_bf16_f32 v182, v172, v173
    v_cvt_pk_bf16_f32 v183, v174, v175
    v_smfmac_f32_16x16x64_bf16 a[216:219], a[248:251], v[184:191], v231
    v_cvt_pk_bf16_f32 v56, v56, v57
    v_cvt_pk_bf16_f32 v57, v58, v59
    v_mfma_f32_16x16x32_bf16 v[168:171], a[112:115], a[64:67], v[208:211]
    ds_write_b64 v253, v[52:53] offset:4096
    v_exp_f32 v160, v160
    v_cvt_pk_bf16_f32 v60, v60, v61
    v_cvt_pk_bf16_f32 v61, v62, v63
    v_mfma_f32_16x16x32_bf16 v[168:171], a[116:119], a[68:71], v[168:171]
    ds_write_b64 v254, v[56:57] offset:4096
    v_mfma_f32_16x16x32_bf16 v[168:171], a[120:123], a[72:75], v[168:171]
    ds_write_b64 v255, v[60:61] offset:4096
    v_exp_f32 v161, v161
    ds_read_b128 a[16:19], v230 offset:4096
    v_xor_b32 v240, 64, v230
    ds_read_b128 a[20:23], v240 offset:5120
    v_xor_b32 v240, 128, v230
    ds_read_b128 a[24:27], v240 offset:6144
    v_xor_b32 v240, 192, v230
    ds_read_b128 a[28:31], v240 offset:7168
    v_mfma_f32_16x16x32_bf16 v[168:171], a[124:127], a[76:79], v[168:171]
    v_accvgpr_read_b32 v239, a216
    v_accvgpr_read_b32 v238, a217
    v_add_f32 v239, v239, v238
    v_cmp_nge_f32 s[62:63], s37, v239
    v_mfma_f32_16x16x32_bf16 v[172:175], a[140:143], a[76:79], v[208:211]
    v_exp_f32 v162, v162
    v_mfma_f32_16x16x32_bf16 v[172:175], a[136:139], a[72:75], v[172:175]
    v_rcp_f32 v239, v239
    s_or_b64 s[40:41], s[40:41], s[62:63]
    s_waitcnt lgkmcnt(0)
    buffer_store_dwordx4 a[16:19], v228, s[16:19], s26 offen offset:0 nt
    buffer_store_dwordx4 a[20:23], v228, s[16:19], s26 offen offset:1024 nt
    buffer_store_dwordx4 a[24:27], v228, s[16:19], s26 offen offset:2048 nt
    buffer_store_dwordx4 a[28:31], v228, s[16:19], s26 offen offset:3072 nt
    v_pk_mul_f32 v[64:65], v[64:65], v[238:239] op_sel:[0,1] op_sel_hi:[1,1]
    v_pk_mul_f32 v[66:67], v[66:67], v[238:239] op_sel:[0,1] op_sel_hi:[1,1]
    v_pk_mul_f32 v[68:69], v[68:69], v[238:239] op_sel:[0,1] op_sel_hi:[1,1]
    v_pk_mul_f32 v[70:71], v[70:71], v[238:239] op_sel:[0,1] op_sel_hi:[1,1]
    v_pk_mul_f32 v[72:73], v[72:73], v[238:239] op_sel:[0,1] op_sel_hi:[1,1]
    v_pk_mul_f32 v[74:75], v[74:75], v[238:239] op_sel:[0,1] op_sel_hi:[1,1]
    v_pk_mul_f32 v[76:77], v[76:77], v[238:239] op_sel:[0,1] op_sel_hi:[1,1]
    v_pk_mul_f32 v[78:79], v[78:79], v[238:239] op_sel:[0,1] op_sel_hi:[1,1]
    v_pk_mul_f32 v[80:81], v[80:81], v[238:239] op_sel:[0,1] op_sel_hi:[1,1]
    v_pk_mul_f32 v[82:83], v[82:83], v[238:239] op_sel:[0,1] op_sel_hi:[1,1]
    v_pk_mul_f32 v[84:85], v[84:85], v[238:239] op_sel:[0,1] op_sel_hi:[1,1]
    v_pk_mul_f32 v[86:87], v[86:87], v[238:239] op_sel:[0,1] op_sel_hi:[1,1]
    v_pk_mul_f32 v[88:89], v[88:89], v[238:239] op_sel:[0,1] op_sel_hi:[1,1]
    v_pk_mul_f32 v[90:91], v[90:91], v[238:239] op_sel:[0,1] op_sel_hi:[1,1]
    v_pk_mul_f32 v[92:93], v[92:93], v[238:239] op_sel:[0,1] op_sel_hi:[1,1]
    v_pk_mul_f32 v[94:95], v[94:95], v[238:239] op_sel:[0,1] op_sel_hi:[1,1]
    v_mfma_f32_16x16x32_bf16 v[172:175], a[132:135], a[68:71], v[172:175]
    v_exp_f32 v163, v163
    v_mfma_f32_16x16x32_bf16 v[172:175], a[128:131], a[64:67], v[172:175]
    v_cvt_pk_bf16_f32 v184, v160, v161
    v_cvt_pk_bf16_f32 v185, v162, v163
    v_mfma_f32_16x16x32_bf16 v[96:99], a[144:147], v[176:179], v[96:99]
    v_exp_f32 v164, v164
    v_mfma_f32_16x16x32_bf16 v[96:99], a[176:179], v[180:183], v[96:99]
    v_cvt_pk_bf16_f32 v64, v64, v65
    v_cvt_pk_bf16_f32 v65, v66, v67
    v_mfma_f32_16x16x32_bf16 v[100:103], a[180:183], v[180:183], v[100:103]
    v_exp_f32 v165, v165
    v_mfma_f32_16x16x32_bf16 v[100:103], a[148:151], v[176:179], v[100:103]
    v_cvt_pk_bf16_f32 v68, v68, v69
    v_cvt_pk_bf16_f32 v69, v70, v71
    v_mfma_f32_16x16x32_bf16 v[104:107], a[152:155], v[176:179], v[104:107]
    v_exp_f32 v166, v166
    v_mfma_f32_16x16x32_bf16 v[104:107], a[184:187], v[180:183], v[104:107]
    ds_write_b64 v248, v[64:65] offset:8192
    v_cvt_pk_bf16_f32 v72, v72, v73
    v_cvt_pk_bf16_f32 v73, v74, v75
    v_mfma_f32_16x16x32_bf16 v[108:111], a[188:191], v[180:183], v[108:111]
    ds_write_b64 v249, v[68:69] offset:8192
    v_exp_f32 v167, v167
    v_mfma_f32_16x16x32_bf16 v[108:111], a[156:159], v[176:179], v[108:111]
    v_cvt_pk_bf16_f32 v186, v164, v165
    v_cvt_pk_bf16_f32 v187, v166, v167
    v_cvt_pk_bf16_f32 v76, v76, v77
    v_cvt_pk_bf16_f32 v77, v78, v79
    v_exp_f32 v168, v168
    v_exp_f32 v169, v169
    ds_write_b64 v250, v[72:73] offset:8192
    v_cvt_pk_bf16_f32 v80, v80, v81
    v_cvt_pk_bf16_f32 v81, v82, v83
    ds_write_b64 v251, v[76:77] offset:8192
    v_exp_f32 v170, v170
    v_mfma_f32_16x16x32_bf16 v[112:115], a[192:195], v[180:183], v[112:115]
    v_exp_f32 v171, v171
    v_cvt_pk_bf16_f32 v84, v84, v85
    v_cvt_pk_bf16_f32 v85, v86, v87
    v_mfma_f32_16x16x32_bf16 v[112:115], a[160:163], v[176:179], v[112:115]
    v_cvt_pk_bf16_f32 v188, v168, v169
    v_cvt_pk_bf16_f32 v189, v170, v171
    v_mfma_f32_16x16x32_bf16 v[116:119], a[164:167], v[176:179], v[116:119]
    v_exp_f32 v172, v172
    v_mfma_f32_16x16x32_bf16 v[116:119], a[196:199], v[180:183], v[116:119]
    v_exp_f32 v173, v173
    v_mfma_f32_16x16x32_bf16 v[120:123], a[200:203], v[180:183], v[120:123]
    ds_write_b64 v252, v[80:81] offset:8192
    v_cvt_pk_bf16_f32 v88, v88, v89
    v_cvt_pk_bf16_f32 v89, v90, v91
    v_mfma_f32_16x16x32_bf16 v[120:123], a[168:171], v[176:179], v[120:123]
    v_exp_f32 v174, v174
    v_mfma_f32_16x16x32_bf16 v[124:127], a[172:175], v[176:179], v[124:127]
    v_exp_f32 v175, v175
    v_mfma_f32_16x16x32_bf16 v[124:127], a[204:207], v[180:183], v[124:127]
    v_cvt_pk_bf16_f32 v190, v172, v173
    v_cvt_pk_bf16_f32 v191, v174, v175
    v_smfmac_f32_16x16x64_bf16 a[220:223], a[248:251], v[176:183], v231
    ds_write_b64 v253, v[84:85] offset:8192
    v_cvt_pk_bf16_f32 v92, v92, v93
    v_cvt_pk_bf16_f32 v93, v94, v95
    ds_write_b64 v254, v[88:89] offset:8192
    ds_write_b64 v255, v[92:93] offset:8192
    ds_read_b128 a[32:35], v230 offset:8192
    v_xor_b32 v240, 64, v230
    ds_read_b128 a[36:39], v240 offset:9216
    v_xor_b32 v240, 128, v230
    ds_read_b128 a[40:43], v240 offset:10240
    v_xor_b32 v240, 192, v230
    ds_read_b128 a[44:47], v240 offset:11264
    v_accvgpr_read_b32 v239, a220
    v_accvgpr_read_b32 v238, a221
    v_add_f32 v239, v239, v238
    v_cmp_nge_f32 s[62:63], s37, v239
    v_rcp_f32 v239, v239
    s_or_b64 s[40:41], s[40:41], s[62:63]
    s_waitcnt lgkmcnt(0)
    buffer_store_dwordx4 a[32:35], v228, s[16:19], s27 offen offset:0 nt
    buffer_store_dwordx4 a[36:39], v228, s[16:19], s27 offen offset:1024 nt
    buffer_store_dwordx4 a[40:43], v228, s[16:19], s27 offen offset:2048 nt
    buffer_store_dwordx4 a[44:47], v228, s[16:19], s27 offen offset:3072 nt
    v_pk_mul_f32 v[96:97], v[96:97], v[238:239] op_sel:[0,1] op_sel_hi:[1,1]
    v_pk_mul_f32 v[98:99], v[98:99], v[238:239] op_sel:[0,1] op_sel_hi:[1,1]
    v_pk_mul_f32 v[100:101], v[100:101], v[238:239] op_sel:[0,1] op_sel_hi:[1,1]
    v_pk_mul_f32 v[102:103], v[102:103], v[238:239] op_sel:[0,1] op_sel_hi:[1,1]
    v_pk_mul_f32 v[104:105], v[104:105], v[238:239] op_sel:[0,1] op_sel_hi:[1,1]
    v_pk_mul_f32 v[106:107], v[106:107], v[238:239] op_sel:[0,1] op_sel_hi:[1,1]
    v_pk_mul_f32 v[108:109], v[108:109], v[238:239] op_sel:[0,1] op_sel_hi:[1,1]
    v_pk_mul_f32 v[110:111], v[110:111], v[238:239] op_sel:[0,1] op_sel_hi:[1,1]
    v_pk_mul_f32 v[112:113], v[112:113], v[238:239] op_sel:[0,1] op_sel_hi:[1,1]
    v_pk_mul_f32 v[114:115], v[114:115], v[238:239] op_sel:[0,1] op_sel_hi:[1,1]
    v_pk_mul_f32 v[116:117], v[116:117], v[238:239] op_sel:[0,1] op_sel_hi:[1,1]
    v_pk_mul_f32 v[118:119], v[118:119], v[238:239] op_sel:[0,1] op_sel_hi:[1,1]
    v_pk_mul_f32 v[120:121], v[120:121], v[238:239] op_sel:[0,1] op_sel_hi:[1,1]
    v_pk_mul_f32 v[122:123], v[122:123], v[238:239] op_sel:[0,1] op_sel_hi:[1,1]
    v_pk_mul_f32 v[124:125], v[124:125], v[238:239] op_sel:[0,1] op_sel_hi:[1,1]
    v_pk_mul_f32 v[126:127], v[126:127], v[238:239] op_sel:[0,1] op_sel_hi:[1,1]
    v_cvt_pk_bf16_f32 v96, v96, v97
    v_cvt_pk_bf16_f32 v97, v98, v99
    v_mfma_f32_16x16x32_bf16 v[128:131], a[144:147], v[184:187], v[128:131]
    v_cvt_pk_bf16_f32 v100, v100, v101
    v_cvt_pk_bf16_f32 v101, v102, v103
    v_mfma_f32_16x16x32_bf16 v[128:131], a[176:179], v[188:191], v[128:131]
    v_mfma_f32_16x16x32_bf16 v[132:135], a[180:183], v[188:191], v[132:135]
    ds_write_b64 v248, v[96:97] offset:12288
    v_mfma_f32_16x16x32_bf16 v[132:135], a[148:151], v[184:187], v[132:135]
    v_cvt_pk_bf16_f32 v104, v104, v105
    v_cvt_pk_bf16_f32 v105, v106, v107
    v_mfma_f32_16x16x32_bf16 v[136:139], a[152:155], v[184:187], v[136:139]
    v_mfma_f32_16x16x32_bf16 v[136:139], a[184:187], v[188:191], v[136:139]
    ds_write_b64 v249, v[100:101] offset:12288
    v_mfma_f32_16x16x32_bf16 v[140:143], a[188:191], v[188:191], v[140:143]
    v_cvt_pk_bf16_f32 v108, v108, v109
    v_cvt_pk_bf16_f32 v109, v110, v111
    v_mfma_f32_16x16x32_bf16 v[140:143], a[156:159], v[184:187], v[140:143]
    ds_write_b64 v250, v[104:105] offset:12288
    v_cvt_pk_bf16_f32 v112, v112, v113
    v_cvt_pk_bf16_f32 v113, v114, v115
    ds_write_b64 v251, v[108:109] offset:12288
    v_mfma_f32_16x16x32_bf16 v[144:147], a[192:195], v[188:191], v[144:147]
    v_cvt_pk_bf16_f32 v116, v116, v117
    v_cvt_pk_bf16_f32 v117, v118, v119
    v_mfma_f32_16x16x32_bf16 v[144:147], a[160:163], v[184:187], v[144:147]
    v_mfma_f32_16x16x32_bf16 v[148:151], a[164:167], v[184:187], v[148:151]
    ds_write_b64 v252, v[112:113] offset:12288
    v_mfma_f32_16x16x32_bf16 v[148:151], a[196:199], v[188:191], v[148:151]
    v_cvt_pk_bf16_f32 v120, v120, v121
    v_cvt_pk_bf16_f32 v121, v122, v123
    v_mfma_f32_16x16x32_bf16 v[152:155], a[200:203], v[188:191], v[152:155]
    v_mfma_f32_16x16x32_bf16 v[152:155], a[168:171], v[184:187], v[152:155]
    ds_write_b64 v253, v[116:117] offset:12288
    v_mfma_f32_16x16x32_bf16 v[156:159], a[172:175], v[184:187], v[156:159]
    v_cvt_pk_bf16_f32 v124, v124, v125
    v_cvt_pk_bf16_f32 v125, v126, v127
    v_mfma_f32_16x16x32_bf16 v[156:159], a[204:207], v[188:191], v[156:159]
    v_smfmac_f32_16x16x64_bf16 a[224:227], a[248:251], v[184:191], v231
    ds_write_b64 v254, v[120:121] offset:12288
    ds_write_b64 v255, v[124:125] offset:12288
    ds_read_b128 a[48:51], v230 offset:12288
    v_xor_b32 v240, 64, v230
    ds_read_b128 a[52:55], v240 offset:13312
    v_xor_b32 v240, 128, v230
    ds_read_b128 a[56:59], v240 offset:14336
    v_xor_b32 v240, 192, v230
    ds_read_b128 a[60:63], v240 offset:15360
    s_nop 2
    v_accvgpr_read_b32 v239, a224
    v_accvgpr_read_b32 v238, a225
    v_add_f32 v239, v239, v238
    v_cmp_nge_f32 s[62:63], s37, v239
    v_rcp_f32 v239, v239
    s_or_b64 s[40:41], s[40:41], s[62:63]
    s_waitcnt lgkmcnt(0)
    buffer_store_dwordx4 a[48:51], v228, s[16:19], s28 offen offset:0 nt
    buffer_store_dwordx4 a[52:55], v228, s[16:19], s28 offen offset:1024 nt
    buffer_store_dwordx4 a[56:59], v228, s[16:19], s28 offen offset:2048 nt
    buffer_store_dwordx4 a[60:63], v228, s[16:19], s28 offen offset:3072 nt
    v_pk_mul_f32 v[128:129], v[128:129], v[238:239] op_sel:[0,1] op_sel_hi:[1,1]
    v_pk_mul_f32 v[130:131], v[130:131], v[238:239] op_sel:[0,1] op_sel_hi:[1,1]
    v_pk_mul_f32 v[132:133], v[132:133], v[238:239] op_sel:[0,1] op_sel_hi:[1,1]
    v_pk_mul_f32 v[134:135], v[134:135], v[238:239] op_sel:[0,1] op_sel_hi:[1,1]
    v_pk_mul_f32 v[136:137], v[136:137], v[238:239] op_sel:[0,1] op_sel_hi:[1,1]
    v_pk_mul_f32 v[138:139], v[138:139], v[238:239] op_sel:[0,1] op_sel_hi:[1,1]
    v_pk_mul_f32 v[140:141], v[140:141], v[238:239] op_sel:[0,1] op_sel_hi:[1,1]
    v_pk_mul_f32 v[142:143], v[142:143], v[238:239] op_sel:[0,1] op_sel_hi:[1,1]
    v_pk_mul_f32 v[144:145], v[144:145], v[238:239] op_sel:[0,1] op_sel_hi:[1,1]
    v_pk_mul_f32 v[146:147], v[146:147], v[238:239] op_sel:[0,1] op_sel_hi:[1,1]
    v_pk_mul_f32 v[148:149], v[148:149], v[238:239] op_sel:[0,1] op_sel_hi:[1,1]
    v_pk_mul_f32 v[150:151], v[150:151], v[238:239] op_sel:[0,1] op_sel_hi:[1,1]
    v_pk_mul_f32 v[152:153], v[152:153], v[238:239] op_sel:[0,1] op_sel_hi:[1,1]
    v_pk_mul_f32 v[154:155], v[154:155], v[238:239] op_sel:[0,1] op_sel_hi:[1,1]
    v_pk_mul_f32 v[156:157], v[156:157], v[238:239] op_sel:[0,1] op_sel_hi:[1,1]
    v_pk_mul_f32 v[158:159], v[158:159], v[238:239] op_sel:[0,1] op_sel_hi:[1,1]
    v_cvt_pk_bf16_f32 v128, v128, v129
    v_cvt_pk_bf16_f32 v129, v130, v131
    v_cvt_pk_bf16_f32 v132, v132, v133
    v_cvt_pk_bf16_f32 v133, v134, v135
    ds_write_b64 v248, v[128:129] offset:16384
    v_cvt_pk_bf16_f32 v136, v136, v137
    v_cvt_pk_bf16_f32 v137, v138, v139
    ds_write_b64 v249, v[132:133] offset:16384
    v_cvt_pk_bf16_f32 v140, v140, v141
    v_cvt_pk_bf16_f32 v141, v142, v143
    ds_write_b64 v250, v[136:137] offset:16384
    v_cvt_pk_bf16_f32 v144, v144, v145
    v_cvt_pk_bf16_f32 v145, v146, v147
    ds_write_b64 v251, v[140:141] offset:16384
    v_cvt_pk_bf16_f32 v148, v148, v149
    v_cvt_pk_bf16_f32 v149, v150, v151
    ds_write_b64 v252, v[144:145] offset:16384
    v_cvt_pk_bf16_f32 v152, v152, v153
    v_cvt_pk_bf16_f32 v153, v154, v155
    ds_write_b64 v253, v[148:149] offset:16384
    v_cvt_pk_bf16_f32 v156, v156, v157
    v_cvt_pk_bf16_f32 v157, v158, v159
    ds_write_b64 v254, v[152:153] offset:16384
    ds_write_b64 v255, v[156:157] offset:16384
    ds_read_b128 a[64:67], v230 offset:16384
    v_xor_b32 v240, 64, v230
    ds_read_b128 a[68:71], v240 offset:17408
    v_xor_b32 v240, 128, v230
    ds_read_b128 a[72:75], v240 offset:18432
    v_xor_b32 v240, 192, v230
    ds_read_b128 a[76:79], v240 offset:19456
    s_waitcnt lgkmcnt(0)
    buffer_store_dwordx4 a[64:67], v228, s[16:19], s29 offen offset:0 nt
    buffer_store_dwordx4 a[68:71], v228, s[16:19], s29 offen offset:1024 nt
    buffer_store_dwordx4 a[72:75], v228, s[16:19], s29 offen offset:2048 nt
    buffer_store_dwordx4 a[76:79], v228, s[16:19], s29 offen offset:3072 nt
    s_cmp_lg_u64 s[40:41], 0
    s_cselect_b32 s45, s42, 0
    s_or_b32 s36, s36, s45
    s_lshl_b32 s42, s42, 1
    s_mov_b64 s[40:41], 0
    s_cmp_lg_u32 s43, 0
    s_cbranch_scc1 L_redo
    v_mov_b32 v252, s36
    v_mov_b32 v253, 81920
    s_waitcnt lgkmcnt(0)
    ds_write_b32 v230, v252
    s_waitcnt lgkmcnt(0)
    s_barrier
    ds_read_b32 v248, v253
    ds_read_b32 v249, v253 offset:20480
    ds_read_b32 v250, v253 offset:40960
    ds_read_b32 v251, v253 offset:61440
    s_waitcnt lgkmcnt(0)
    v_or_b32 v248, v248, v249
    v_or3_b32 v248, v248, v250, v251
    s_nop 1
    v_readfirstlane_b32 s56, v248
    s_mov_b32 s43, 1
    s_nop 3
L_redo:
    s_and_b32 s56, s56, 15
    s_cbranch_scc0 L_end
    s_ff1_i32_b32 s45, s56
    s_bitset0_b32 s56, s45
    s_mul_i32 s45, s45, 20447232
    s_add_u32 s34, s51, s45
    s_mov_b32 s33, 1
    s_waitcnt vmcnt(0) lgkmcnt(0)
    s_barrier
    s_branch L_start
L_maxpass:
    buffer_load_dwordx4 v[112:115], v228, s[12:15], s27 offen offset:0 nt
    buffer_load_dwordx4 v[116:119], v228, s[12:15], s27 offen offset:1024 nt
    buffer_load_dwordx4 v[120:123], v228, s[12:15], s27 offen offset:2048 nt
    buffer_load_dwordx4 v[124:127], v228, s[12:15], s27 offen offset:3072 nt
    buffer_load_dwordx4 v[128:131], v228, s[12:15], s28 offen offset:0 nt
    buffer_load_dwordx4 v[132:135], v228, s[12:15], s28 offen offset:1024 nt
    buffer_load_dwordx4 v[136:139], v228, s[12:15], s28 offen offset:2048 nt
    buffer_load_dwordx4 v[140:143], v228, s[12:15], s28 offen offset:3072 nt
    buffer_load_dwordx4 v[144:147], v228, s[12:15], s29 offen offset:0 nt
    buffer_load_dwordx4 v[148:151], v228, s[12:15], s29 offen offset:1024 nt
    buffer_load_dwordx4 v[152:155], v228, s[12:15], s29 offen offset:2048 nt
    buffer_load_dwordx4 v[156:159], v228, s[12:15], s29 offen offset:3072 nt
    s_waitcnt vmcnt(0)
    v_add_u32 v232, s52, v212
    v_add_u32 v233, s52, v213
    v_add_u32 v234, s52, v214
    v_add_u32 v235, s52, v215
    v_lshlrev_b32 v248, 16, v80
    v_and_b32 v249, s31, v80
    v_lshlrev_b32 v250, 16, v81
    v_and_b32 v251, s31, v81
    v_lshlrev_b32 v252, 16, v82
    v_and_b32 v253, s31, v82
    v_lshlrev_b32 v254, 16, v83
    v_and_b32 v255, s31, v83
    v_pk_mul_f32 v[248:249], v[248:249], s[84:85]
    v_pk_mul_f32 v[250:251], v[250:251], s[84:85]
    v_pk_mul_f32 v[252:253], v[252:253], s[84:85]
    v_pk_mul_f32 v[254:255], v[254:255], s[84:85]
    v_cvt_pk_bf16_f32 v248, v248, v249
    v_cvt_pk_bf16_f32 v249, v250, v251
    v_cvt_pk_bf16_f32 v250, v252, v253
    v_cvt_pk_bf16_f32 v251, v254, v255
    ds_write_b128 v230, v[248:251] offset:0
    v_xor_b32 v229, 64, v230
    v_lshlrev_b32 v248, 16, v84
    v_and_b32 v249, s31, v84
    v_lshlrev_b32 v250, 16, v85
    v_and_b32 v251, s31, v85
    v_lshlrev_b32 v252, 16, v86
    v_and_b32 v253, s31, v86
    v_lshlrev_b32 v254, 16, v87
    v_and_b32 v255, s31, v87
    v_pk_mul_f32 v[248:249], v[248:249], s[84:85]
    v_pk_mul_f32 v[250:251], v[250:251], s[84:85]
    v_pk_mul_f32 v[252:253], v[252:253], s[84:85]
    v_pk_mul_f32 v[254:255], v[254:255], s[84:85]
    v_cvt_pk_bf16_f32 v248, v248, v249
    v_cvt_pk_bf16_f32 v249, v250, v251
    v_cvt_pk_bf16_f32 v250, v252, v253
    v_cvt_pk_bf16_f32 v251, v254, v255
    ds_write_b128 v229, v[248:251] offset:1024
    v_xor_b32 v229, 128, v230
    v_lshlrev_b32 v248, 16, v88
    v_and_b32 v249, s31, v88
    v_lshlrev_b32 v250, 16, v89
    v_and_b32 v251, s31, v89
    v_lshlrev_b32 v252, 16, v90
    v_and_b32 v253, s31, v90
    v_lshlrev_b32 v254, 16, v91
    v_and_b32 v255, s31, v91
    v_pk_mul_f32 v[248:249], v[248:249], s[84:85]
    v_pk_mul_f32 v[250:251], v[250:251], s[84:85]
    v_pk_mul_f32 v[252:253], v[252:253], s[84:85]
    v_pk_mul_f32 v[254:255], v[254:255], s[84:85]
    v_cvt_pk_bf16_f32 v248, v248, v249
    v_cvt_pk_bf16_f32 v249, v250, v251
    v_cvt_pk_bf16_f32 v250, v252, v253
    v_cvt_pk_bf16_f32 v251, v254, v255
    ds_write_b128 v229, v[248:251] offset:2048
    v_xor_b32 v229, 192, v230
    v_lshlrev_b32 v248, 16, v92
    v_and_b32 v249, s31, v92
    v_lshlrev_b32 v250, 16, v93
    v_and_b32 v251, s31, v93
    v_lshlrev_b32 v252, 16, v94
    v_and_b32 v253, s31, v94
    v_lshlrev_b32 v254, 16, v95
    v_and_b32 v255, s31, v95
    v_pk_mul_f32 v[248:249], v[248:249], s[84:85]
    v_pk_mul_f32 v[250:251], v[250:251], s[84:85]
    v_pk_mul_f32 v[252:253], v[252:253], s[84:85]
    v_pk_mul_f32 v[254:255], v[254:255], s[84:85]
    v_cvt_pk_bf16_f32 v248, v248, v249
    v_cvt_pk_bf16_f32 v249, v250, v251
    v_cvt_pk_bf16_f32 v250, v252, v253
    v_cvt_pk_bf16_f32 v251, v254, v255
    ds_write_b128 v229, v[248:251] offset:3072
    v_lshlrev_b32 v248, 16, v96
    v_and_b32 v249, s31, v96
    v_lshlrev_b32 v250, 16, v97
    v_and_b32 v251, s31, v97
    v_lshlrev_b32 v252, 16, v98
    v_and_b32 v253, s31, v98
    v_lshlrev_b32 v254, 16, v99
    v_and_b32 v255, s31, v99
    v_pk_mul_f32 v[248:249], v[248:249], s[84:85]
    v_pk_mul_f32 v[250:251], v[250:251], s[84:85]
    v_pk_mul_f32 v[252:253], v[252:253], s[84:85]
    v_pk_mul_f32 v[254:255], v[254:255], s[84:85]
    v_cvt_pk_bf16_f32 v248, v248, v249
    v_cvt_pk_bf16_f32 v249, v250, v251
    v_cvt_pk_bf16_f32 v250, v252, v253
    v_cvt_pk_bf16_f32 v251, v254, v255
    ds_write_b128 v230, v[248:251] offset:4096
    v_xor_b32 v229, 64, v230
    v_lshlrev_b32 v248, 16, v100
    v_and_b32 v249, s31, v100
    v_lshlrev_b32 v250, 16, v101
    v_and_b32 v251, s31, v101
    v_lshlrev_b32 v252, 16, v102
    v_and_b32 v253, s31, v102
    v_lshlrev_b32 v254, 16, v103
    v_and_b32 v255, s31, v103
    v_pk_mul_f32 v[248:249], v[248:249], s[84:85]
    v_pk_mul_f32 v[250:251], v[250:251], s[84:85]
    v_pk_mul_f32 v[252:253], v[252:253], s[84:85]
    v_pk_mul_f32 v[254:255], v[254:255], s[84:85]
    v_cvt_pk_bf16_f32 v248, v248, v249
    v_cvt_pk_bf16_f32 v249, v250, v251
    v_cvt_pk_bf16_f32 v250, v252, v253
    v_cvt_pk_bf16_f32 v251, v254, v255
    ds_write_b128 v229, v[248:251] offset:5120
    v_xor_b32 v229, 128, v230
    v_lshlrev_b32 v248, 16, v104
    v_and_b32 v249, s31, v104
    v_lshlrev_b32 v250, 16, v105
    v_and_b32 v251, s31, v105
    v_lshlrev_b32 v252, 16, v106
    v_and_b32 v253, s31, v106
    v_lshlrev_b32 v254, 16, v107
    v_and_b32 v255, s31, v107
    v_pk_mul_f32 v[248:249], v[248:249], s[84:85]
    v_pk_mul_f32 v[250:251], v[250:251], s[84:85]
    v_pk_mul_f32 v[252:253], v[252:253], s[84:85]
    v_pk_mul_f32 v[254:255], v[254:255], s[84:85]
    v_cvt_pk_bf16_f32 v248, v248, v249
    v_cvt_pk_bf16_f32 v249, v250, v251
    v_cvt_pk_bf16_f32 v250, v252, v253
    v_cvt_pk_bf16_f32 v251, v254, v255
    ds_write_b128 v229, v[248:251] offset:6144
    v_xor_b32 v229, 192, v230
    v_lshlrev_b32 v248, 16, v108
    v_and_b32 v249, s31, v108
    v_lshlrev_b32 v250, 16, v109
    v_and_b32 v251, s31, v109
    v_lshlrev_b32 v252, 16, v110
    v_and_b32 v253, s31, v110
    v_lshlrev_b32 v254, 16, v111
    v_and_b32 v255, s31, v111
    v_pk_mul_f32 v[248:249], v[248:249], s[84:85]
    v_pk_mul_f32 v[250:251], v[250:251], s[84:85]
    v_pk_mul_f32 v[252:253], v[252:253], s[84:85]
    v_pk_mul_f32 v[254:255], v[254:255], s[84:85]
    v_cvt_pk_bf16_f32 v248, v248, v249
    v_cvt_pk_bf16_f32 v249, v250, v251
    v_cvt_pk_bf16_f32 v250, v252, v253
    v_cvt_pk_bf16_f32 v251, v254, v255
    ds_write_b128 v229, v[248:251] offset:7168
    v_lshlrev_b32 v248, 16, v112
    v_and_b32 v249, s31, v112
    v_lshlrev_b32 v250, 16, v113
    v_and_b32 v251, s31, v113
    v_lshlrev_b32 v252, 16, v114
    v_and_b32 v253, s31, v114
    v_lshlrev_b32 v254, 16, v115
    v_and_b32 v255, s31, v115
    v_pk_mul_f32 v[248:249], v[248:249], s[84:85]
    v_pk_mul_f32 v[250:251], v[250:251], s[84:85]
    v_pk_mul_f32 v[252:253], v[252:253], s[84:85]
    v_pk_mul_f32 v[254:255], v[254:255], s[84:85]
    v_cvt_pk_bf16_f32 v248, v248, v249
    v_cvt_pk_bf16_f32 v249, v250, v251
    v_cvt_pk_bf16_f32 v250, v252, v253
    v_cvt_pk_bf16_f32 v251, v254, v255
    ds_write_b128 v230, v[248:251] offset:8192
    v_xor_b32 v229, 64, v230
    v_lshlrev_b32 v248, 16, v116
    v_and_b32 v249, s31, v116
    v_lshlrev_b32 v250, 16, v117
    v_and_b32 v251, s31, v117
    v_lshlrev_b32 v252, 16, v118
    v_and_b32 v253, s31, v118
    v_lshlrev_b32 v254, 16, v119
    v_and_b32 v255, s31, v119
    v_pk_mul_f32 v[248:249], v[248:249], s[84:85]
    v_pk_mul_f32 v[250:251], v[250:251], s[84:85]
    v_pk_mul_f32 v[252:253], v[252:253], s[84:85]
    v_pk_mul_f32 v[254:255], v[254:255], s[84:85]
    v_cvt_pk_bf16_f32 v248, v248, v249
    v_cvt_pk_bf16_f32 v249, v250, v251
    v_cvt_pk_bf16_f32 v250, v252, v253
    v_cvt_pk_bf16_f32 v251, v254, v255
    ds_write_b128 v229, v[248:251] offset:9216
    v_xor_b32 v229, 128, v230
    v_lshlrev_b32 v248, 16, v120
    v_and_b32 v249, s31, v120
    v_lshlrev_b32 v250, 16, v121
    v_and_b32 v251, s31, v121
    v_lshlrev_b32 v252, 16, v122
    v_and_b32 v253, s31, v122
    v_lshlrev_b32 v254, 16, v123
    v_and_b32 v255, s31, v123
    v_pk_mul_f32 v[248:249], v[248:249], s[84:85]
    v_pk_mul_f32 v[250:251], v[250:251], s[84:85]
    v_pk_mul_f32 v[252:253], v[252:253], s[84:85]
    v_pk_mul_f32 v[254:255], v[254:255], s[84:85]
    v_cvt_pk_bf16_f32 v248, v248, v249
    v_cvt_pk_bf16_f32 v249, v250, v251
    v_cvt_pk_bf16_f32 v250, v252, v253
    v_cvt_pk_bf16_f32 v251, v254, v255
    ds_write_b128 v229, v[248:251] offset:10240
    v_xor_b32 v229, 192, v230
    v_lshlrev_b32 v248, 16, v124
    v_and_b32 v249, s31, v124
    v_lshlrev_b32 v250, 16, v125
    v_and_b32 v251, s31, v125
    v_lshlrev_b32 v252, 16, v126
    v_and_b32 v253, s31, v126
    v_lshlrev_b32 v254, 16, v127
    v_and_b32 v255, s31, v127
    v_pk_mul_f32 v[248:249], v[248:249], s[84:85]
    v_pk_mul_f32 v[250:251], v[250:251], s[84:85]
    v_pk_mul_f32 v[252:253], v[252:253], s[84:85]
    v_pk_mul_f32 v[254:255], v[254:255], s[84:85]
    v_cvt_pk_bf16_f32 v248, v248, v249
    v_cvt_pk_bf16_f32 v249, v250, v251
    v_cvt_pk_bf16_f32 v250, v252, v253
    v_cvt_pk_bf16_f32 v251, v254, v255
    ds_write_b128 v229, v[248:251] offset:11264
    v_lshlrev_b32 v248, 16, v128
    v_and_b32 v249, s31, v128
    v_lshlrev_b32 v250, 16, v129
    v_and_b32 v251, s31, v129
    v_lshlrev_b32 v252, 16, v130
    v_and_b32 v253, s31, v130
    v_lshlrev_b32 v254, 16, v131
    v_and_b32 v255, s31, v131
    v_pk_mul_f32 v[248:249], v[248:249], s[84:85]
    v_pk_mul_f32 v[250:251], v[250:251], s[84:85]
    v_pk_mul_f32 v[252:253], v[252:253], s[84:85]
    v_pk_mul_f32 v[254:255], v[254:255], s[84:85]
    v_cvt_pk_bf16_f32 v248, v248, v249
    v_cvt_pk_bf16_f32 v249, v250, v251
    v_cvt_pk_bf16_f32 v250, v252, v253
    v_cvt_pk_bf16_f32 v251, v254, v255
    ds_write_b128 v230, v[248:251] offset:12288
    v_xor_b32 v229, 64, v230
    v_lshlrev_b32 v248, 16, v132
    v_and_b32 v249, s31, v132
    v_lshlrev_b32 v250, 16, v133
    v_and_b32 v251, s31, v133
    v_lshlrev_b32 v252, 16, v134
    v_and_b32 v253, s31, v134
    v_lshlrev_b32 v254, 16, v135
    v_and_b32 v255, s31, v135
    v_pk_mul_f32 v[248:249], v[248:249], s[84:85]
    v_pk_mul_f32 v[250:251], v[250:251], s[84:85]
    v_pk_mul_f32 v[252:253], v[252:253], s[84:85]
    v_pk_mul_f32 v[254:255], v[254:255], s[84:85]
    v_cvt_pk_bf16_f32 v248, v248, v249
    v_cvt_pk_bf16_f32 v249, v250, v251
    v_cvt_pk_bf16_f32 v250, v252, v253
    v_cvt_pk_bf16_f32 v251, v254, v255
    ds_write_b128 v229, v[248:251] offset:13312
    v_xor_b32 v229, 128, v230
    v_lshlrev_b32 v248, 16, v136
    v_and_b32 v249, s31, v136
    v_lshlrev_b32 v250, 16, v137
    v_and_b32 v251, s31, v137
    v_lshlrev_b32 v252, 16, v138
    v_and_b32 v253, s31, v138
    v_lshlrev_b32 v254, 16, v139
    v_and_b32 v255, s31, v139
    v_pk_mul_f32 v[248:249], v[248:249], s[84:85]
    v_pk_mul_f32 v[250:251], v[250:251], s[84:85]
    v_pk_mul_f32 v[252:253], v[252:253], s[84:85]
    v_pk_mul_f32 v[254:255], v[254:255], s[84:85]
    v_cvt_pk_bf16_f32 v248, v248, v249
    v_cvt_pk_bf16_f32 v249, v250, v251
    v_cvt_pk_bf16_f32 v250, v252, v253
    v_cvt_pk_bf16_f32 v251, v254, v255
    ds_write_b128 v229, v[248:251] offset:14336
    v_xor_b32 v229, 192, v230
    v_lshlrev_b32 v248, 16, v140
    v_and_b32 v249, s31, v140
    v_lshlrev_b32 v250, 16, v141
    v_and_b32 v251, s31, v141
    v_lshlrev_b32 v252, 16, v142
    v_and_b32 v253, s31, v142
    v_lshlrev_b32 v254, 16, v143
    v_and_b32 v255, s31, v143
    v_pk_mul_f32 v[248:249], v[248:249], s[84:85]
    v_pk_mul_f32 v[250:251], v[250:251], s[84:85]
    v_pk_mul_f32 v[252:253], v[252:253], s[84:85]
    v_pk_mul_f32 v[254:255], v[254:255], s[84:85]
    v_cvt_pk_bf16_f32 v248, v248, v249
    v_cvt_pk_bf16_f32 v249, v250, v251
    v_cvt_pk_bf16_f32 v250, v252, v253
    v_cvt_pk_bf16_f32 v251, v254, v255
    ds_write_b128 v229, v[248:251] offset:15360
    v_lshlrev_b32 v248, 16, v144
    v_and_b32 v249, s31, v144
    v_lshlrev_b32 v250, 16, v145
    v_and_b32 v251, s31, v145
    v_lshlrev_b32 v252, 16, v146
    v_and_b32 v253, s31, v146
    v_lshlrev_b32 v254, 16, v147
    v_and_b32 v255, s31, v147
    v_pk_mul_f32 v[248:249], v[248:249], s[84:85]
    v_pk_mul_f32 v[250:251], v[250:251], s[84:85]
    v_pk_mul_f32 v[252:253], v[252:253], s[84:85]
    v_pk_mul_f32 v[254:255], v[254:255], s[84:85]
    v_cvt_pk_bf16_f32 v248, v248, v249
    v_cvt_pk_bf16_f32 v249, v250, v251
    v_cvt_pk_bf16_f32 v250, v252, v253
    v_cvt_pk_bf16_f32 v251, v254, v255
    ds_write_b128 v230, v[248:251] offset:16384
    v_xor_b32 v229, 64, v230
    v_lshlrev_b32 v248, 16, v148
    v_and_b32 v249, s31, v148
    v_lshlrev_b32 v250, 16, v149
    v_and_b32 v251, s31, v149
    v_lshlrev_b32 v252, 16, v150
    v_and_b32 v253, s31, v150
    v_lshlrev_b32 v254, 16, v151
    v_and_b32 v255, s31, v151
    v_pk_mul_f32 v[248:249], v[248:249], s[84:85]
    v_pk_mul_f32 v[250:251], v[250:251], s[84:85]
    v_pk_mul_f32 v[252:253], v[252:253], s[84:85]
    v_pk_mul_f32 v[254:255], v[254:255], s[84:85]
    v_cvt_pk_bf16_f32 v248, v248, v249
    v_cvt_pk_bf16_f32 v249, v250, v251
    v_cvt_pk_bf16_f32 v250, v252, v253
    v_cvt_pk_bf16_f32 v251, v254, v255
    ds_write_b128 v229, v[248:251] offset:17408
    v_xor_b32 v229, 128, v230
    v_lshlrev_b32 v248, 16, v152
    v_and_b32 v249, s31, v152
    v_lshlrev_b32 v250, 16, v153
    v_and_b32 v251, s31, v153
    v_lshlrev_b32 v252, 16, v154
    v_and_b32 v253, s31, v154
    v_lshlrev_b32 v254, 16, v155
    v_and_b32 v255, s31, v155
    v_pk_mul_f32 v[248:249], v[248:249], s[84:85]
    v_pk_mul_f32 v[250:251], v[250:251], s[84:85]
    v_pk_mul_f32 v[252:253], v[252:253], s[84:85]
    v_pk_mul_f32 v[254:255], v[254:255], s[84:85]
    v_cvt_pk_bf16_f32 v248, v248, v249
    v_cvt_pk_bf16_f32 v249, v250, v251
    v_cvt_pk_bf16_f32 v250, v252, v253
    v_cvt_pk_bf16_f32 v251, v254, v255
    ds_write_b128 v229, v[248:251] offset:18432
    v_xor_b32 v229, 192, v230
    v_lshlrev_b32 v248, 16, v156
    v_and_b32 v249, s31, v156
    v_lshlrev_b32 v250, 16, v157
    v_and_b32 v251, s31, v157
    v_lshlrev_b32 v252, 16, v158
    v_and_b32 v253, s31, v158
    v_lshlrev_b32 v254, 16, v159
    v_and_b32 v255, s31, v159
    v_pk_mul_f32 v[248:249], v[248:249], s[84:85]
    v_pk_mul_f32 v[250:251], v[250:251], s[84:85]
    v_pk_mul_f32 v[252:253], v[252:253], s[84:85]
    v_pk_mul_f32 v[254:255], v[254:255], s[84:85]
    v_cvt_pk_bf16_f32 v248, v248, v249
    v_cvt_pk_bf16_f32 v249, v250, v251
    v_cvt_pk_bf16_f32 v250, v252, v253
    v_cvt_pk_bf16_f32 v251, v254, v255
    ds_write_b128 v229, v[248:251] offset:19456
    ds_read_b128 a[0:3], v232 offset:0
    ds_read_b128 a[4:7], v233 offset:0
    ds_read_b128 a[8:11], v234 offset:0
    ds_read_b128 a[12:15], v235 offset:0
    ds_read_b128 a[16:19], v232 offset:4096
    ds_read_b128 a[20:23], v233 offset:4096
    ds_read_b128 a[24:27], v234 offset:4096
    ds_read_b128 a[28:31], v235 offset:4096
    ds_read_b128 a[32:35], v232 offset:8192
    ds_read_b128 a[36:39], v233 offset:8192
    ds_read_b128 a[40:43], v234 offset:8192
    ds_read_b128 a[44:47], v235 offset:8192
    ds_read_b128 a[48:51], v232 offset:12288
    ds_read_b128 a[52:55], v233 offset:12288
    ds_read_b128 a[56:59], v234 offset:12288
    ds_read_b128 a[60:63], v235 offset:12288
    ds_read_b128 a[64:67], v232 offset:16384
    ds_read_b128 a[68:71], v233 offset:16384
    ds_read_b128 a[72:75], v234 offset:16384
    ds_read_b128 a[76:79], v235 offset:16384
    v_mbcnt_lo_u32_b32 v40, -1, 0
    v_mbcnt_hi_u32_b32 v40, -1, v40
    v_and_b32 v41, 15, v40
    v_and_b32 v40, 48, v40
    v_lshl_add_u32 v40, v41, 8, v40
    s_mov_b32 s54, s34
    s_mov_b32 s55, 39
L_mp:
    buffer_load_dwordx4 v[0:3], v40, s[4:7], s54 offen offset:0
    buffer_load_dwordx4 v[4:7], v40, s[4:7], s54 offen offset:64
    buffer_load_dwordx4 v[8:11], v40, s[4:7], s54 offen offset:128
    buffer_load_dwordx4 v[12:15], v40, s[4:7], s54 offen offset:192
    s_waitcnt vmcnt(0) lgkmcnt(0)
    v_mfma_f32_16x16x32_bf16 v[16:19], v[0:3], a[0:3], 0
    v_mfma_f32_16x16x32_bf16 v[16:19], v[4:7], a[4:7], v[16:19]
    v_mfma_f32_16x16x32_bf16 v[16:19], v[8:11], a[8:11], v[16:19]
    v_mfma_f32_16x16x32_bf16 v[16:19], v[12:15], a[12:15], v[16:19]
    v_mfma_f32_16x16x32_bf16 v[20:23], v[0:3], a[16:19], 0
    v_mfma_f32_16x16x32_bf16 v[20:23], v[4:7], a[20:23], v[20:23]
    v_mfma_f32_16x16x32_bf16 v[20:23], v[8:11], a[24:27], v[20:23]
    v_mfma_f32_16x16x32_bf16 v[20:23], v[12:15], a[28:31], v[20:23]
    v_mfma_f32_16x16x32_bf16 v[24:27], v[0:3], a[32:35], 0
    v_mfma_f32_16x16x32_bf16 v[24:27], v[4:7], a[36:39], v[24:27]
    v_mfma_f32_16x16x32_bf16 v[24:27], v[8:11], a[40:43], v[24:27]
    v_mfma_f32_16x16x32_bf16 v[24:27], v[12:15], a[44:47], v[24:27]
    v_mfma_f32_16x16x32_bf16 v[28:31], v[0:3], a[48:51], 0
    v_mfma_f32_16x16x32_bf16 v[28:31], v[4:7], a[52:55], v[28:31]
    v_mfma_f32_16x16x32_bf16 v[28:31], v[8:11], a[56:59], v[28:31]
    v_mfma_f32_16x16x32_bf16 v[28:31], v[12:15], a[60:63], v[28:31]
    v_mfma_f32_16x16x32_bf16 v[32:35], v[0:3], a[64:67], 0
    v_mfma_f32_16x16x32_bf16 v[32:35], v[4:7], a[68:71], v[32:35]
    v_mfma_f32_16x16x32_bf16 v[32:35], v[8:11], a[72:75], v[32:35]
    v_mfma_f32_16x16x32_bf16 v[32:35], v[12:15], a[76:79], v[32:35]
    v_max3_f32 v241, v241, v16, v17
    v_max3_f32 v241, v241, v18, v19
    v_max3_f32 v242, v242, v20, v21
    v_max3_f32 v242, v242, v22, v23
    v_max3_f32 v243, v243, v24, v25
    v_max3_f32 v243, v243, v26, v27
    v_max3_f32 v244, v244, v28, v29
    v_max3_f32 v244, v244, v30, v31
    v_max3_f32 v245, v245, v32, v33
    v_max3_f32 v245, v245, v34, v35
    s_add_u32 s54, s54, 4096
    s_sub_u32 s55, s55, 1
    s_cmp_lg_u32 s55, 0
    s_cbranch_scc1 L_mp
    s_branch L_go
L_end:
s_endpgm
.section .rodata,"a"
.p2align 6
.amdhsa_kernel standalone__gqa_softmax__near_ridge_kernel
  .amdhsa_next_free_vgpr 512
  .amdhsa_next_free_sgpr 102
  .amdhsa_accum_offset 256
  .amdhsa_group_segment_fixed_size 0
  .amdhsa_kernarg_size 48
  .amdhsa_user_sgpr_count 2
  .amdhsa_user_sgpr_kernarg_segment_ptr 1
  .amdhsa_system_sgpr_workgroup_id_x 1
.end_amdhsa_kernel
```
